```python
import torch

def _softmax(x, axis=-1):
    return torch.softmax(x, dim=axis)

def _gelu(x):
    return torch.nn.functional.gelu(x, approximate='tanh')

def _silu(x):
    return torch.nn.functional.silu(x)

def _sigmoid(x):
    return torch.sigmoid(x)

def _layernorm(x, axis=-1, eps=1e-05):
    m = x.mean(dim=axis, keepdim=True)
    v = x.var(dim=axis, keepdim=True, unbiased=False)
    return (x - m) / torch.sqrt(v + eps)

def _scatter_add(tgt, idx, src, axis=0):
    return tgt.clone().index_add_(axis, idx, src)

def _segment_sum(src, seg, n):
    out = torch.zeros((n,) + src.shape[1:], dtype=src.dtype)
    return out.index_add_(0, seg, src)

def _pad(x, pw):
    flat = tuple((v for pair in reversed(pw) for v in pair))
    return torch.nn.functional.pad(x, flat)
kernel_name = 'adaLN_cond__spectral_fnet__mixer_gmlp__prompt'

def setup_inputs():

    _w = lambda a: (lambda t: t.to(torch.bfloat16) if t.is_floating_point() else t)(torch.as_tensor(a))

    def _A_setup():
        B, S, D = (1, 2048, 640)
        ns = torch.arange(S)[:, None] * torch.arange(S)[None, :]
        nd = torch.arange(D)[:, None] * torch.arange(D)[None, :]
        Ws_re = torch.cos(-2.0 * torch.pi * ns / S).to(float)
        Ws_im = torch.sin(-2.0 * torch.pi * ns / S).to(float)
        Wd_re = torch.cos(-2.0 * torch.pi * nd / D).to(float)
        Wd_im = torch.sin(-2.0 * torch.pi * nd / D).to(float)
        return {'x': _w((lambda *s: torch.randn(*s, dtype=torch.bfloat16) * 0.1)(B, S, D)), 'dft_seq_re': _w(Ws_re), 'dft_seq_im': _w(Ws_im), 'dft_hid_re': _w(Wd_re), 'dft_hid_im': _w(Wd_im)}
    _A_in = _A_setup()

    def _B_setup():
        B, S, D, F = (1, 2048, 640, 1728)
        Fh = F // 2
        return {'x': _w((lambda *s: torch.randn(*s, dtype=torch.bfloat16) * 0.1)(B, S, D)), 'w_in': _w((lambda *s: torch.randn(*s, dtype=torch.bfloat16) * 3.2)(D, 2 * Fh)), 'w_sp': _w(0.01 * (lambda *s: torch.randn(*s, dtype=torch.bfloat16) * 3.2)(S, S)), 'b_sp': _w(1.0 + 0.01 * (lambda *s: torch.randn(*s, dtype=torch.bfloat16) * 1.6)(S)), 'w_out': _w((lambda *s: torch.randn(*s, dtype=torch.bfloat16) * 1.6)(Fh, D))}
    _B_in = _B_setup()
    return {'A_x': _A_in['x'], 'A_dft_seq_re': _A_in['dft_seq_re'], 'A_dft_seq_im': _A_in['dft_seq_im'], 'A_dft_hid_re': _A_in['dft_hid_re'], 'A_dft_hid_im': _A_in['dft_hid_im'], 'B_x': _B_in['x'], 'B_w_in': _B_in['w_in'], 'B_w_sp': _B_in['w_sp'], 'B_b_sp': _B_in['b_sp'], 'B_w_out': _B_in['w_out'], 'c': _w((lambda *s: torch.randn(*s, dtype=torch.bfloat16) * 0.2)(1, 640) * 8.0), 'w_mod': _w((lambda *s: torch.randn(*s, dtype=torch.bfloat16) * 0.2)(640, 6 * 640) * 640 ** (-0.5) * 8.0)}

def reference(A_x, A_dft_seq_re, A_dft_seq_im, A_dft_hid_re, A_dft_hid_im, B_x, B_w_in, B_w_sp, B_b_sp, B_w_out, c, w_mod):

    def _A_ref(x, dft_seq_re, dft_seq_im, dft_hid_re, dft_hid_im):
        a = torch.einsum('bsd,ed->bse', x, dft_hid_re)
        b = torch.einsum('bsd,ed->bse', x, dft_hid_im)
        y = torch.einsum('ts,bse->bte', dft_seq_re, a) - torch.einsum('ts,bse->bte', dft_seq_im, b)
        return y

    def _B_ref(x, w_in, w_sp, b_sp, w_out):
        B, S, D = x.shape
        F = w_in.shape[-1]
        Fh = F // 2
        z = _gelu(torch.einsum('bsd,df->bsf', x, w_in))
        z1 = z[..., :Fh].clone()
        z2 = _layernorm(z[..., Fh:], axis=-1)
        g = torch.einsum('ts,bsf->btf', w_sp, z2) + b_sp[None, :, None]
        return torch.einsum('bsf,fd->bsd', z1 * g, w_out)
    x = A_x
    mod = (_silu(c) @ w_mod).reshape(c.shape[0], 6, 1, -1)
    sa, ca, ga, sb, cb, gb = (mod[:, 0].clone(), mod[:, 1].clone(), mod[:, 2].clone(), mod[:, 3].clone(), mod[:, 4].clone(), mod[:, 5].clone())
    h = _layernorm(x, axis=-1) * (1 + ca) + sa
    x = x + ga * _A_ref(h, A_dft_seq_re, A_dft_seq_im, A_dft_hid_re, A_dft_hid_im)
    h = _layernorm(x, axis=-1) * (1 + cb) + sb
    x = x + gb * _B_ref(h, B_w_in, B_w_sp, B_b_sp, B_w_out)
    return x
```

```asm
; @launch kernel=adaLN_cond__spectral_fnet__mixer_gmlp__prompt_kernel grid=(256,1,1) block=(768,1,1) lds=163840
.amdgcn_target "amdgcn-amd-amdhsa--gfx950"
.text
.globl adaLN_cond__spectral_fnet__mixer_gmlp__prompt_kernel
.p2align 8
.type adaLN_cond__spectral_fnet__mixer_gmlp__prompt_kernel,@function
adaLN_cond__spectral_fnet__mixer_gmlp__prompt_kernel:
  s_cmp_ge_u32 s2, 256
  s_cbranch_scc1 Lad_end
  s_load_dwordx2 s[4:5], s[0:1], 0
  s_load_dwordx4 s[12:15], s[0:1], 80
  s_load_dwordx4 s[8:11], s[0:1], 104
  s_load_dwordx4 s[52:55], s[0:1], 48
  s_load_dwordx2 s[56:57], s[0:1], 72
  s_load_dwordx2 s[60:61], s[0:1], 64
  s_load_dwordx2 s[62:63], s[0:1], 96
  v_and_b32 v1, 63, v0
  v_lshrrev_b32 v2, 6, v0
  s_nop 0
  v_readfirstlane_b32 s3, v2
  s_nop 1
  s_cmp_ge_u32 s3, 8
  s_cbranch_scc1 Lad_loader
  s_cmp_ge_u32 s2, 160
  s_cbranch_scc1 Lad_notfft
  s_and_b32 s16, s2, 7
  s_lshr_b32 s17, s2, 3
  s_mul_i32 s18, s17, 205
  s_lshr_b32 s18, s18, 10
  s_mul_i32 s19, s18, 5
  s_sub_u32 s19, s17, s19
  s_lshl_b32 s16, s16, 2
  s_add_u32 s18, s16, s18
  v_add_u32 v10, 0, v1
  v_mul_u32_u24 v11, 205, v10
  v_lshrrev_b32 v11, 14, v11
  v_mul_u32_u24 v12, 80, v11
  v_sub_u32 v12, v10, v12
  v_lshlrev_b32 v10, 1, v11
  v_xor_b32 v12, v12, v10
  v_lshlrev_b32 v12, 4, v12
  v_mul_u32_u24 v11, 40960, v11
  v_add_u32 v4, v11, v12
  v_add_u32 v10, 64, v1
  v_mul_u32_u24 v11, 205, v10
  v_lshrrev_b32 v11, 14, v11
  v_mul_u32_u24 v12, 80, v11
  v_sub_u32 v12, v10, v12
  v_lshlrev_b32 v10, 1, v11
  v_xor_b32 v12, v12, v10
  v_lshlrev_b32 v12, 4, v12
  v_mul_u32_u24 v11, 40960, v11
  v_add_u32 v5, v11, v12
  v_add_u32 v10, 128, v1
  v_mul_u32_u24 v11, 205, v10
  v_lshrrev_b32 v11, 14, v11
  v_mul_u32_u24 v12, 80, v11
  v_sub_u32 v12, v10, v12
  v_lshlrev_b32 v10, 1, v11
  v_xor_b32 v12, v12, v10
  v_lshlrev_b32 v12, 4, v12
  v_mul_u32_u24 v11, 40960, v11
  v_add_u32 v6, v11, v12
  v_add_u32 v10, 192, v1
  v_mul_u32_u24 v11, 205, v10
  v_lshrrev_b32 v11, 14, v11
  v_mul_u32_u24 v12, 80, v11
  v_sub_u32 v12, v10, v12
  v_lshlrev_b32 v10, 1, v11
  v_xor_b32 v12, v12, v10
  v_lshlrev_b32 v12, 4, v12
  v_mul_u32_u24 v11, 40960, v11
  v_add_u32 v7, v11, v12
  v_add_u32 v10, 256, v1
  v_mul_u32_u24 v11, 205, v10
  v_lshrrev_b32 v11, 14, v11
  v_mul_u32_u24 v12, 80, v11
  v_sub_u32 v12, v10, v12
  v_lshlrev_b32 v10, 1, v11
  v_xor_b32 v12, v12, v10
  v_lshlrev_b32 v12, 4, v12
  v_mul_u32_u24 v11, 40960, v11
  v_add_u32 v8, v11, v12
  s_mul_i32 s20, s18, 1280
  s_mul_i32 s21, s3, 327680
  s_add_u32 s20, s20, s21
  s_mul_i32 s21, s3, 10240
  s_add_u32 s21, s21, 73984
  s_waitcnt lgkmcnt(0)
  s_mov_b32 s24, s4
  s_mov_b32 s25, s5
  s_mov_b32 s26, 0x280000
  s_mov_b32 s27, 0x20000
  s_add_u32 m0, s21, 0
  s_nop 0
  buffer_load_dwordx4 v4, s[24:27], s20 offen lds
  s_add_u32 m0, s21, 1024
  s_nop 0
  buffer_load_dwordx4 v5, s[24:27], s20 offen lds
  s_add_u32 m0, s21, 2048
  s_nop 0
  buffer_load_dwordx4 v6, s[24:27], s20 offen lds
  s_add_u32 m0, s21, 3072
  s_nop 0
  buffer_load_dwordx4 v7, s[24:27], s20 offen lds
  s_add_u32 m0, s21, 4096
  s_nop 0
  buffer_load_dwordx4 v8, s[24:27], s20 offen lds
  v_xor_b32 v4, 128, v4
  v_xor_b32 v5, 128, v5
  v_xor_b32 v6, 128, v6
  v_xor_b32 v7, 128, v7
  v_xor_b32 v8, 128, v8
  s_add_u32 s22, s20, 163840
  s_add_u32 m0, s21, 5120
  s_nop 0
  buffer_load_dwordx4 v4, s[24:27], s22 offen lds
  s_add_u32 m0, s21, 6144
  s_nop 0
  buffer_load_dwordx4 v5, s[24:27], s22 offen lds
  s_add_u32 m0, s21, 7168
  s_nop 0
  buffer_load_dwordx4 v6, s[24:27], s22 offen lds
  s_add_u32 m0, s21, 8192
  s_nop 0
  buffer_load_dwordx4 v7, s[24:27], s22 offen lds
  s_add_u32 m0, s21, 9216
  s_nop 0
  buffer_load_dwordx4 v8, s[24:27], s22 offen lds
  s_add_u32 s28, s10, 0x100000
  s_addc_u32 s29, s11, 0
  s_mov_b32 s30, 0x280000
  s_mov_b32 s31, 0x20000
  v_and_b32 v10, 15, v1
  v_lshrrev_b32 v11, 4, v1
  s_lshr_b32 s23, s3, 2
  s_lshl_b32 s23, s23, 4
  v_add_u32 v12, s23, v10
  v_cmp_eq_u32 vcc, 0, v12
  v_cvt_f32_u32 v13, v12
  v_mul_f32 v13, 0x3c800000, v13
  v_mov_b32 v14, 0.5
  v_cndmask_b32 v14, v13, v14, vcc
  v_mov_b32 v15, 0x3e800000
  v_cndmask_b32 v15, v15, 0, vcc
  v_lshlrev_b32 v16, 2, v11
  v_cvt_f32_u32 v16, v16
  v_mul_f32 v17, v13, v16
  v_fma_f32 v18, v14, v16, v15
  v_fmamk_f32 v32, v13, 0x00000000, v17
  v_fmamk_f32 v48, v14, 0x00000000, v18
  v_fmamk_f32 v33, v13, 0x3f800000, v17
  v_fmamk_f32 v49, v14, 0x3f800000, v18
  v_fmamk_f32 v34, v13, 0x40000000, v17
  v_fmamk_f32 v50, v14, 0x40000000, v18
  v_fmamk_f32 v35, v13, 0x40400000, v17
  v_fmamk_f32 v51, v14, 0x40400000, v18
  v_fmamk_f32 v36, v13, 0x41800000, v17
  v_fmamk_f32 v52, v14, 0x41800000, v18
  v_fmamk_f32 v37, v13, 0x41880000, v17
  v_fmamk_f32 v53, v14, 0x41880000, v18
  v_fmamk_f32 v38, v13, 0x41900000, v17
  v_fmamk_f32 v54, v14, 0x41900000, v18
  v_fmamk_f32 v39, v13, 0x41980000, v17
  v_fmamk_f32 v55, v14, 0x41980000, v18
  v_fmamk_f32 v40, v13, 0x42000000, v17
  v_fmamk_f32 v56, v14, 0x42000000, v18
  v_fmamk_f32 v41, v13, 0x42040000, v17
  v_fmamk_f32 v57, v14, 0x42040000, v18
  v_fmamk_f32 v42, v13, 0x42080000, v17
  v_fmamk_f32 v58, v14, 0x42080000, v18
  v_fmamk_f32 v43, v13, 0x420c0000, v17
  v_fmamk_f32 v59, v14, 0x420c0000, v18
  v_fmamk_f32 v44, v13, 0x42400000, v17
  v_fmamk_f32 v60, v14, 0x42400000, v18
  v_fmamk_f32 v45, v13, 0x42440000, v17
  v_fmamk_f32 v61, v14, 0x42440000, v18
  v_fmamk_f32 v46, v13, 0x42480000, v17
  v_fmamk_f32 v62, v14, 0x42480000, v18
  v_fmamk_f32 v47, v13, 0x424c0000, v17
  v_fmamk_f32 v63, v14, 0x424c0000, v18
  v_cos_f32 v32, v32
  v_cos_f32 v48, v48
  v_cos_f32 v33, v33
  v_cos_f32 v49, v49
  v_cos_f32 v34, v34
  v_cos_f32 v50, v50
  v_cos_f32 v35, v35
  v_cos_f32 v51, v51
  v_cos_f32 v36, v36
  v_cos_f32 v52, v52
  v_cos_f32 v37, v37
  v_cos_f32 v53, v53
  v_cos_f32 v38, v38
  v_cos_f32 v54, v54
  v_cos_f32 v39, v39
  v_cos_f32 v55, v55
  v_cos_f32 v40, v40
  v_cos_f32 v56, v56
  v_cos_f32 v41, v41
  v_cos_f32 v57, v57
  v_cos_f32 v42, v42
  v_cos_f32 v58, v58
  v_cos_f32 v43, v43
  v_cos_f32 v59, v59
  v_cos_f32 v44, v44
  v_cos_f32 v60, v60
  v_cos_f32 v45, v45
  v_cos_f32 v61, v61
  v_cos_f32 v46, v46
  v_cos_f32 v62, v62
  v_cos_f32 v47, v47
  v_cos_f32 v63, v63
  v_lshrrev_b32 v20, 3, v1
  v_and_b32 v21, 7, v1
  v_bfe_u32 v22, v20, 1, 1
  v_lshlrev_b32 v22, 3, v22
  v_add_u32 v22, v22, v21
  v_lshlrev_b32 v22, 4, v22
  v_mul_u32_u24 v23, 1280, v20
  v_add_u32 v22, v22, v23
  v_add_u32 v22, s21, v22
  v_xor_b32 v23, 128, v22
  v_mov_b32 v24, 0x3f803f80
  v_mov_b32 v26, 0
  v_mov_b32 v27, 0
  v_mov_b32 v28, 0
  v_mov_b32 v29, 0
  s_waitcnt vmcnt(0)
  ds_read_b128 v[64:67], v22 offset:0
  ds_read_b128 v[68:71], v23 offset:0
  ds_read_b128 v[72:75], v22 offset:256
  ds_read_b128 v[76:79], v23 offset:256
  ds_read_b128 v[80:83], v22 offset:512
  ds_read_b128 v[84:87], v23 offset:512
  ds_read_b128 v[88:91], v22 offset:768
  ds_read_b128 v[92:95], v23 offset:768
  ds_read_b128 v[96:99], v22 offset:1024
  ds_read_b128 v[100:103], v23 offset:1024
  s_waitcnt lgkmcnt(9)
  v_dot2_f32_bf16 v26, v64, v24, v26
  v_dot2_f32_bf16 v28, v64, v64, v28
  v_dot2_f32_bf16 v27, v65, v24, v27
  v_dot2_f32_bf16 v29, v65, v65, v29
  v_dot2_f32_bf16 v26, v66, v24, v26
  v_dot2_f32_bf16 v28, v66, v66, v28
  v_dot2_f32_bf16 v27, v67, v24, v27
  v_dot2_f32_bf16 v29, v67, v67, v29
  s_waitcnt lgkmcnt(8)
  v_dot2_f32_bf16 v26, v68, v24, v26
  v_dot2_f32_bf16 v28, v68, v68, v28
  v_dot2_f32_bf16 v27, v69, v24, v27
  v_dot2_f32_bf16 v29, v69, v69, v29
  v_dot2_f32_bf16 v26, v70, v24, v26
  v_dot2_f32_bf16 v28, v70, v70, v28
  v_dot2_f32_bf16 v27, v71, v24, v27
  v_dot2_f32_bf16 v29, v71, v71, v29
  s_waitcnt lgkmcnt(7)
  v_dot2_f32_bf16 v26, v72, v24, v26
  v_dot2_f32_bf16 v28, v72, v72, v28
  v_dot2_f32_bf16 v27, v73, v24, v27
  v_dot2_f32_bf16 v29, v73, v73, v29
  v_dot2_f32_bf16 v26, v74, v24, v26
  v_dot2_f32_bf16 v28, v74, v74, v28
  v_dot2_f32_bf16 v27, v75, v24, v27
  v_dot2_f32_bf16 v29, v75, v75, v29
  s_waitcnt lgkmcnt(6)
  v_dot2_f32_bf16 v26, v76, v24, v26
  v_dot2_f32_bf16 v28, v76, v76, v28
  v_dot2_f32_bf16 v27, v77, v24, v27
  v_dot2_f32_bf16 v29, v77, v77, v29
  v_dot2_f32_bf16 v26, v78, v24, v26
  v_dot2_f32_bf16 v28, v78, v78, v28
  v_dot2_f32_bf16 v27, v79, v24, v27
  v_dot2_f32_bf16 v29, v79, v79, v29
  s_waitcnt lgkmcnt(5)
  v_dot2_f32_bf16 v26, v80, v24, v26
  v_dot2_f32_bf16 v28, v80, v80, v28
  v_dot2_f32_bf16 v27, v81, v24, v27
  v_dot2_f32_bf16 v29, v81, v81, v29
  v_dot2_f32_bf16 v26, v82, v24, v26
  v_dot2_f32_bf16 v28, v82, v82, v28
  v_dot2_f32_bf16 v27, v83, v24, v27
  v_dot2_f32_bf16 v29, v83, v83, v29
  s_waitcnt lgkmcnt(4)
  v_dot2_f32_bf16 v26, v84, v24, v26
  v_dot2_f32_bf16 v28, v84, v84, v28
  v_dot2_f32_bf16 v27, v85, v24, v27
  v_dot2_f32_bf16 v29, v85, v85, v29
  v_dot2_f32_bf16 v26, v86, v24, v26
  v_dot2_f32_bf16 v28, v86, v86, v28
  v_dot2_f32_bf16 v27, v87, v24, v27
  v_dot2_f32_bf16 v29, v87, v87, v29
  s_waitcnt lgkmcnt(3)
  v_dot2_f32_bf16 v26, v88, v24, v26
  v_dot2_f32_bf16 v28, v88, v88, v28
  v_dot2_f32_bf16 v27, v89, v24, v27
  v_dot2_f32_bf16 v29, v89, v89, v29
  v_dot2_f32_bf16 v26, v90, v24, v26
  v_dot2_f32_bf16 v28, v90, v90, v28
  v_dot2_f32_bf16 v27, v91, v24, v27
  v_dot2_f32_bf16 v29, v91, v91, v29
  s_waitcnt lgkmcnt(2)
  v_dot2_f32_bf16 v26, v92, v24, v26
  v_dot2_f32_bf16 v28, v92, v92, v28
  v_dot2_f32_bf16 v27, v93, v24, v27
  v_dot2_f32_bf16 v29, v93, v93, v29
  v_dot2_f32_bf16 v26, v94, v24, v26
  v_dot2_f32_bf16 v28, v94, v94, v28
  v_dot2_f32_bf16 v27, v95, v24, v27
  v_dot2_f32_bf16 v29, v95, v95, v29
  s_waitcnt lgkmcnt(1)
  v_dot2_f32_bf16 v26, v96, v24, v26
  v_dot2_f32_bf16 v28, v96, v96, v28
  v_dot2_f32_bf16 v27, v97, v24, v27
  v_dot2_f32_bf16 v29, v97, v97, v29
  v_dot2_f32_bf16 v26, v98, v24, v26
  v_dot2_f32_bf16 v28, v98, v98, v28
  v_dot2_f32_bf16 v27, v99, v24, v27
  v_dot2_f32_bf16 v29, v99, v99, v29
  s_waitcnt lgkmcnt(0)
  v_dot2_f32_bf16 v26, v100, v24, v26
  v_dot2_f32_bf16 v28, v100, v100, v28
  v_dot2_f32_bf16 v27, v101, v24, v27
  v_dot2_f32_bf16 v29, v101, v101, v29
  v_dot2_f32_bf16 v26, v102, v24, v26
  v_dot2_f32_bf16 v28, v102, v102, v28
  v_dot2_f32_bf16 v27, v103, v24, v27
  v_dot2_f32_bf16 v29, v103, v103, v29
  s_nop 2
  v_add_f32 v26, v26, v27
  v_add_f32 v28, v28, v29
  s_nop 0
  v_add_f32_dpp v26, v26, v26 quad_perm:[1,0,3,2] row_mask:0xf bank_mask:0xf
  v_add_f32_dpp v28, v28, v28 quad_perm:[1,0,3,2] row_mask:0xf bank_mask:0xf
  s_nop 0
  v_add_f32_dpp v26, v26, v26 quad_perm:[2,3,0,1] row_mask:0xf bank_mask:0xf
  v_add_f32_dpp v28, v28, v28 quad_perm:[2,3,0,1] row_mask:0xf bank_mask:0xf
  s_nop 0
  v_add_f32_dpp v26, v26, v26 row_half_mirror row_mask:0xf bank_mask:0xf
  v_add_f32_dpp v28, v28, v28 row_half_mirror row_mask:0xf bank_mask:0xf
  v_mul_f32 v26, 0x3acccccd, v26
  v_mul_f32 v28, 0x3acccccd, v28
  v_fma_f32 v28, -v26, v26, v28
  v_max_f32 v28, 0, v28
  v_add_f32 v28, 0x3727c5ac, v28
  v_rsq_f32 v28, v28
  v_sub_f32 v26, 0, v26
  v_cvt_pk_bf16_f32 v26, v26, v26
  s_lshl_b32 s22, s3, 3
  v_add_u32 v20, s22, v20
  v_lshlrev_b32 v21, 2, v20
  v_lshlrev_b32 v20, 1, v20
  ds_write_b32 v21, v28 offset:0
  ds_write_b16 v20, v26 offset:256
  v_bfe_u32 v20, v1, 2, 2
  v_and_b32 v21, 3, v1
  v_lshl_add_u32 v20, v11, 2, v20
  s_and_b32 s22, s3, 3
  s_lshl_b32 s22, s22, 2
  s_lshl_b32 s23, s19, 4
  s_add_u32 s22, s22, s23
  v_add_u32 v21, s22, v21
  v_and_b32 v22, 7, v20
  v_lshlrev_b32 v22, 1, v22
  v_xor_b32 v21, v21, v22
  v_lshlrev_b32 v21, 4, v21
  v_mul_u32_u24 v20, 1280, v20
  v_add_u32 v21, 73984, v21
  v_add_u32 v20, v20, v21
  v_lshlrev_b32 v21, 4, v11
  v_lshlrev_b32 v22, 3, v11
  s_waitcnt lgkmcnt(0)
  s_barrier
  ds_read_b128 v[64:67], v21 offset:0
  ds_read_b128 v[68:71], v21 offset:64
  ds_read_b128 v[72:75], v21 offset:128
  ds_read_b128 v[76:79], v21 offset:192
  ds_read_b64 v[80:81], v22 offset:256
  ds_read_b64 v[82:83], v22 offset:288
  ds_read_b64 v[84:85], v22 offset:320
  ds_read_b64 v[86:87], v22 offset:352
  ds_read_b64_tr_b16 v[88:89], v20 offset:0
  ds_read_b64_tr_b16 v[90:91], v20 offset:20480
  ds_read_b64_tr_b16 v[92:93], v20 offset:40960
  ds_read_b64_tr_b16 v[94:95], v20 offset:61440
  ds_read_b64_tr_b16 v[96:97], v20 offset:8
  ds_read_b64_tr_b16 v[98:99], v20 offset:20488
  ds_read_b64_tr_b16 v[100:101], v20 offset:40968
  ds_read_b64_tr_b16 v[102:103], v20 offset:61448
  s_waitcnt lgkmcnt(12)
  v_mul_f32 v32, v32, v64
  v_mul_f32 v48, v48, v64
  v_mul_f32 v33, v33, v65
  v_mul_f32 v49, v49, v65
  v_mul_f32 v34, v34, v66
  v_mul_f32 v50, v50, v66
  v_mul_f32 v35, v35, v67
  v_mul_f32 v51, v51, v67
  v_mul_f32 v36, v36, v68
  v_mul_f32 v52, v52, v68
  v_mul_f32 v37, v37, v69
  v_mul_f32 v53, v53, v69
  v_mul_f32 v38, v38, v70
  v_mul_f32 v54, v54, v70
  v_mul_f32 v39, v39, v71
  v_mul_f32 v55, v55, v71
  v_mul_f32 v40, v40, v72
  v_mul_f32 v56, v56, v72
  v_mul_f32 v41, v41, v73
  v_mul_f32 v57, v57, v73
  v_mul_f32 v42, v42, v74
  v_mul_f32 v58, v58, v74
  v_mul_f32 v43, v43, v75
  v_mul_f32 v59, v59, v75
  v_mul_f32 v44, v44, v76
  v_mul_f32 v60, v60, v76
  v_mul_f32 v45, v45, v77
  v_mul_f32 v61, v61, v77
  v_mul_f32 v46, v46, v78
  v_mul_f32 v62, v62, v78
  v_mul_f32 v47, v47, v79
  v_mul_f32 v63, v63, v79
  v_cvt_pk_bf16_f32 v104, v32, v33
  v_cvt_pk_bf16_f32 v112, v48, v49
  v_cvt_pk_bf16_f32 v105, v34, v35
  v_cvt_pk_bf16_f32 v113, v50, v51
  v_cvt_pk_bf16_f32 v106, v36, v37
  v_cvt_pk_bf16_f32 v114, v52, v53
  v_cvt_pk_bf16_f32 v107, v38, v39
  v_cvt_pk_bf16_f32 v115, v54, v55
  v_cvt_pk_bf16_f32 v108, v40, v41
  v_cvt_pk_bf16_f32 v116, v56, v57
  v_cvt_pk_bf16_f32 v109, v42, v43
  v_cvt_pk_bf16_f32 v117, v58, v59
  v_cvt_pk_bf16_f32 v110, v44, v45
  v_cvt_pk_bf16_f32 v118, v60, v61
  v_cvt_pk_bf16_f32 v111, v46, v47
  v_cvt_pk_bf16_f32 v119, v62, v63
  s_waitcnt lgkmcnt(8)
  v_mfma_f32_16x16x32_bf16 v[120:123], v[80:83], v[104:107], 0
  v_mfma_f32_16x16x32_bf16 v[124:127], v[80:83], v[112:115], 0
  v_mfma_f32_16x16x32_bf16 v[120:123], v[84:87], v[108:111], v[120:123]
  v_mfma_f32_16x16x32_bf16 v[124:127], v[84:87], v[116:119], v[124:127]
  s_waitcnt lgkmcnt(0)
  v_mfma_f32_16x16x32_bf16 v[32:35], v[88:91], v[104:107], v[120:123]
  v_mfma_f32_16x16x32_bf16 v[40:43], v[88:91], v[112:115], v[124:127]
  v_mfma_f32_16x16x32_bf16 v[36:39], v[96:99], v[104:107], v[120:123]
  v_mfma_f32_16x16x32_bf16 v[44:47], v[96:99], v[112:115], v[124:127]
  v_mfma_f32_16x16x32_bf16 v[32:35], v[92:95], v[108:111], v[32:35]
  v_mfma_f32_16x16x32_bf16 v[40:43], v[92:95], v[116:119], v[40:43]
  v_mfma_f32_16x16x32_bf16 v[36:39], v[100:103], v[108:111], v[36:39]
  v_mfma_f32_16x16x32_bf16 v[44:47], v[100:103], v[116:119], v[44:47]
  v_and_b32 v20, 7, v12
  v_lshlrev_b32 v20, 1, v20
  s_and_b32 s22, s3, 3
  s_lshl_b32 s22, s22, 2
  v_add_u32 v21, s22, v11
  v_xor_b32 v21, v21, v20
  v_lshlrev_b32 v21, 4, v21
  v_lshl_add_u32 v21, v12, 9, v21
  v_cvt_pk_bf16_f32 v48, v32, v33
  v_cvt_pk_bf16_f32 v49, v34, v35
  v_cvt_pk_bf16_f32 v50, v36, v37
  v_cvt_pk_bf16_f32 v51, v38, v39
  v_cvt_pk_bf16_f32 v52, v40, v41
  v_cvt_pk_bf16_f32 v53, v42, v43
  v_cvt_pk_bf16_f32 v54, v44, v45
  v_cvt_pk_bf16_f32 v55, v46, v47
  ds_write_b128 v21, v[48:51] offset:512
  ds_write_b128 v21, v[52:55] offset:768
  s_lshl_b32 s22, s3, 3
  v_add_u32 v22, s22, v11
  s_and_b32 s23, s18, 7
  s_lshl_b32 s23, s23, 1
  v_xor_b32 v28, s23, v10
  v_bfe_u32 v23, v22, 1, 3
  v_lshlrev_b32 v23, 1, v23
  v_xor_b32 v23, v23, v10
  v_lshlrev_b32 v23, 4, v23
  v_lshl_add_u32 v24, v22, 8, v23
  v_mul_u32_u24 v23, 40960, v22
  v_lshl_add_u32 v26, v28, 4, v23
  v_add_u32 v22, 4, v22
  v_bfe_u32 v23, v22, 1, 3
  v_lshlrev_b32 v23, 1, v23
  v_xor_b32 v23, v23, v10
  v_lshlrev_b32 v23, 4, v23
  v_lshl_add_u32 v25, v22, 8, v23
  v_mul_u32_u24 v23, 40960, v22
  v_lshl_add_u32 v27, v28, 4, v23
  s_mul_i32 s22, s18, 1280
  s_lshl_b32 s23, s19, 8
  s_add_u32 s22, s22, s23
  s_waitcnt lgkmcnt(0)
  s_barrier
  ds_read_b128 v[56:59], v24 offset:512
  ds_read_b128 v[60:63], v25 offset:512
  s_waitcnt lgkmcnt(1)
  buffer_store_dwordx4 v[56:59], v26, s[28:31], s22 offen sc1
  s_waitcnt lgkmcnt(0)
  buffer_store_dwordx4 v[60:63], v27, s[28:31], s22 offen sc1
  s_branch Lad_p1done
Lad_notfft:
  s_cmp_ge_u32 s2, 220
  s_cbranch_scc1 Lad_notmod
  s_sub_u32 s16, s2, 160
  v_lshrrev_b32 v10, 3, v1
  v_and_b32 v11, 7, v1
  s_mul_i32 s17, s3, 80
  v_add_u32 v12, s17, v10
  v_mul_u32_u24 v13, 7680, v12
  v_lshl_add_u32 v13, v11, 4, v13
  v_lshlrev_b32 v12, 1, v12
  s_lshl_b32 s17, s16, 7
  s_waitcnt lgkmcnt(0)
  s_mov_b32 s24, s12
  s_mov_b32 s25, s13
  s_mov_b32 s26, 0x500
  s_mov_b32 s27, 0x20000
  s_mov_b32 s28, s14
  s_mov_b32 s29, s15
  s_mov_b32 s30, 0x4b0000
  s_mov_b32 s31, 0x20000
  buffer_load_ushort v20, v12, s[24:27], 0 offen offset:0
  buffer_load_ushort v21, v12, s[24:27], 0 offen offset:16
  buffer_load_ushort v22, v12, s[24:27], 0 offen offset:32
  buffer_load_ushort v23, v12, s[24:27], 0 offen offset:48
  buffer_load_ushort v24, v12, s[24:27], 0 offen offset:64
  buffer_load_ushort v25, v12, s[24:27], 0 offen offset:80
  buffer_load_ushort v26, v12, s[24:27], 0 offen offset:96
  buffer_load_ushort v27, v12, s[24:27], 0 offen offset:112
  buffer_load_ushort v28, v12, s[24:27], 0 offen offset:128
  buffer_load_ushort v29, v12, s[24:27], 0 offen offset:144
  s_add_u32 s18, s17, 0
  buffer_load_dwordx4 v[64:67], v13, s[28:31], s18 offen
  s_add_u32 s18, s17, 61440
  buffer_load_dwordx4 v[68:71], v13, s[28:31], s18 offen
  s_add_u32 s18, s17, 122880
  buffer_load_dwordx4 v[72:75], v13, s[28:31], s18 offen
  s_add_u32 s18, s17, 184320
  buffer_load_dwordx4 v[76:79], v13, s[28:31], s18 offen
  s_add_u32 s18, s17, 245760
  buffer_load_dwordx4 v[80:83], v13, s[28:31], s18 offen
  s_add_u32 s18, s17, 307200
  buffer_load_dwordx4 v[84:87], v13, s[28:31], s18 offen
  s_add_u32 s18, s17, 368640
  buffer_load_dwordx4 v[88:91], v13, s[28:31], s18 offen
  s_add_u32 s18, s17, 430080
  buffer_load_dwordx4 v[92:95], v13, s[28:31], s18 offen
  s_add_u32 s18, s17, 491520
  buffer_load_dwordx4 v[96:99], v13, s[28:31], s18 offen
  s_add_u32 s18, s17, 552960
  buffer_load_dwordx4 v[100:103], v13, s[28:31], s18 offen
  s_mov_b32 s32, s10
  s_mov_b32 s33, s11
  s_mov_b32 s34, 0x3c00
  s_mov_b32 s35, 0x20000
  v_mov_b32 v50, 0
  v_mov_b32 v51, 0
  v_mov_b32 v52, 0
  v_mov_b32 v53, 0
  v_mov_b32 v54, 0
  v_mov_b32 v55, 0
  v_mov_b32 v56, 0
  v_mov_b32 v57, 0
  s_waitcnt vmcnt(10)
  v_lshlrev_b32 v20, 16, v20
  v_lshlrev_b32 v21, 16, v21
  v_lshlrev_b32 v22, 16, v22
  v_lshlrev_b32 v23, 16, v23
  v_lshlrev_b32 v24, 16, v24
  v_lshlrev_b32 v25, 16, v25
  v_lshlrev_b32 v26, 16, v26
  v_lshlrev_b32 v27, 16, v27
  v_lshlrev_b32 v28, 16, v28
  v_lshlrev_b32 v29, 16, v29
  v_mul_f32 v30, 0xbfb8aa3b, v20
  v_mul_f32 v31, 0xbfb8aa3b, v21
  v_mul_f32 v32, 0xbfb8aa3b, v22
  v_mul_f32 v33, 0xbfb8aa3b, v23
  v_mul_f32 v34, 0xbfb8aa3b, v24
  v_mul_f32 v35, 0xbfb8aa3b, v25
  v_mul_f32 v36, 0xbfb8aa3b, v26
  v_mul_f32 v37, 0xbfb8aa3b, v27
  v_mul_f32 v38, 0xbfb8aa3b, v28
  v_mul_f32 v39, 0xbfb8aa3b, v29
  v_exp_f32 v30, v30
  v_exp_f32 v31, v31
  v_exp_f32 v32, v32
  v_exp_f32 v33, v33
  v_exp_f32 v34, v34
  v_exp_f32 v35, v35
  v_exp_f32 v36, v36
  v_exp_f32 v37, v37
  v_exp_f32 v38, v38
  v_exp_f32 v39, v39
  v_add_f32 v30, 1.0, v30
  v_add_f32 v31, 1.0, v31
  v_add_f32 v32, 1.0, v32
  v_add_f32 v33, 1.0, v33
  v_add_f32 v34, 1.0, v34
  v_add_f32 v35, 1.0, v35
  v_add_f32 v36, 1.0, v36
  v_add_f32 v37, 1.0, v37
  v_add_f32 v38, 1.0, v38
  v_add_f32 v39, 1.0, v39
  v_rcp_f32 v30, v30
  v_rcp_f32 v31, v31
  v_rcp_f32 v32, v32
  v_rcp_f32 v33, v33
  v_rcp_f32 v34, v34
  v_rcp_f32 v35, v35
  v_rcp_f32 v36, v36
  v_rcp_f32 v37, v37
  v_rcp_f32 v38, v38
  v_rcp_f32 v39, v39
  v_mul_f32 v20, v20, v30
  v_mul_f32 v21, v21, v31
  v_mul_f32 v22, v22, v32
  v_mul_f32 v23, v23, v33
  v_mul_f32 v24, v24, v34
  v_mul_f32 v25, v25, v35
  v_mul_f32 v26, v26, v36
  v_mul_f32 v27, v27, v37
  v_mul_f32 v28, v28, v38
  v_mul_f32 v29, v29, v39
  v_cvt_pk_bf16_f32 v30, v20, 0
  v_cvt_pk_bf16_f32 v40, 0, v20
  v_cvt_pk_bf16_f32 v31, v21, 0
  v_cvt_pk_bf16_f32 v41, 0, v21
  v_cvt_pk_bf16_f32 v32, v22, 0
  v_cvt_pk_bf16_f32 v42, 0, v22
  v_cvt_pk_bf16_f32 v33, v23, 0
  v_cvt_pk_bf16_f32 v43, 0, v23
  v_cvt_pk_bf16_f32 v34, v24, 0
  v_cvt_pk_bf16_f32 v44, 0, v24
  v_cvt_pk_bf16_f32 v35, v25, 0
  v_cvt_pk_bf16_f32 v45, 0, v25
  v_cvt_pk_bf16_f32 v36, v26, 0
  v_cvt_pk_bf16_f32 v46, 0, v26
  v_cvt_pk_bf16_f32 v37, v27, 0
  v_cvt_pk_bf16_f32 v47, 0, v27
  v_cvt_pk_bf16_f32 v38, v28, 0
  v_cvt_pk_bf16_f32 v48, 0, v28
  v_cvt_pk_bf16_f32 v39, v29, 0
  v_cvt_pk_bf16_f32 v49, 0, v29
  s_waitcnt vmcnt(9)
  v_dot2_f32_bf16 v50, v64, v30, v50
  v_dot2_f32_bf16 v51, v64, v40, v51
  v_dot2_f32_bf16 v52, v65, v30, v52
  v_dot2_f32_bf16 v53, v65, v40, v53
  v_dot2_f32_bf16 v54, v66, v30, v54
  v_dot2_f32_bf16 v55, v66, v40, v55
  v_dot2_f32_bf16 v56, v67, v30, v56
  v_dot2_f32_bf16 v57, v67, v40, v57
  s_waitcnt vmcnt(8)
  v_dot2_f32_bf16 v50, v68, v31, v50
  v_dot2_f32_bf16 v51, v68, v41, v51
  v_dot2_f32_bf16 v52, v69, v31, v52
  v_dot2_f32_bf16 v53, v69, v41, v53
  v_dot2_f32_bf16 v54, v70, v31, v54
  v_dot2_f32_bf16 v55, v70, v41, v55
  v_dot2_f32_bf16 v56, v71, v31, v56
  v_dot2_f32_bf16 v57, v71, v41, v57
  s_waitcnt vmcnt(7)
  v_dot2_f32_bf16 v50, v72, v32, v50
  v_dot2_f32_bf16 v51, v72, v42, v51
  v_dot2_f32_bf16 v52, v73, v32, v52
  v_dot2_f32_bf16 v53, v73, v42, v53
  v_dot2_f32_bf16 v54, v74, v32, v54
  v_dot2_f32_bf16 v55, v74, v42, v55
  v_dot2_f32_bf16 v56, v75, v32, v56
  v_dot2_f32_bf16 v57, v75, v42, v57
  s_waitcnt vmcnt(6)
  v_dot2_f32_bf16 v50, v76, v33, v50
  v_dot2_f32_bf16 v51, v76, v43, v51
  v_dot2_f32_bf16 v52, v77, v33, v52
  v_dot2_f32_bf16 v53, v77, v43, v53
  v_dot2_f32_bf16 v54, v78, v33, v54
  v_dot2_f32_bf16 v55, v78, v43, v55
  v_dot2_f32_bf16 v56, v79, v33, v56
  v_dot2_f32_bf16 v57, v79, v43, v57
  s_waitcnt vmcnt(5)
  v_dot2_f32_bf16 v50, v80, v34, v50
  v_dot2_f32_bf16 v51, v80, v44, v51
  v_dot2_f32_bf16 v52, v81, v34, v52
  v_dot2_f32_bf16 v53, v81, v44, v53
  v_dot2_f32_bf16 v54, v82, v34, v54
  v_dot2_f32_bf16 v55, v82, v44, v55
  v_dot2_f32_bf16 v56, v83, v34, v56
  v_dot2_f32_bf16 v57, v83, v44, v57
  s_waitcnt vmcnt(4)
  v_dot2_f32_bf16 v50, v84, v35, v50
  v_dot2_f32_bf16 v51, v84, v45, v51
  v_dot2_f32_bf16 v52, v85, v35, v52
  v_dot2_f32_bf16 v53, v85, v45, v53
  v_dot2_f32_bf16 v54, v86, v35, v54
  v_dot2_f32_bf16 v55, v86, v45, v55
  v_dot2_f32_bf16 v56, v87, v35, v56
  v_dot2_f32_bf16 v57, v87, v45, v57
  s_waitcnt vmcnt(3)
  v_dot2_f32_bf16 v50, v88, v36, v50
  v_dot2_f32_bf16 v51, v88, v46, v51
  v_dot2_f32_bf16 v52, v89, v36, v52
  v_dot2_f32_bf16 v53, v89, v46, v53
  v_dot2_f32_bf16 v54, v90, v36, v54
  v_dot2_f32_bf16 v55, v90, v46, v55
  v_dot2_f32_bf16 v56, v91, v36, v56
  v_dot2_f32_bf16 v57, v91, v46, v57
  s_waitcnt vmcnt(2)
  v_dot2_f32_bf16 v50, v92, v37, v50
  v_dot2_f32_bf16 v51, v92, v47, v51
  v_dot2_f32_bf16 v52, v93, v37, v52
  v_dot2_f32_bf16 v53, v93, v47, v53
  v_dot2_f32_bf16 v54, v94, v37, v54
  v_dot2_f32_bf16 v55, v94, v47, v55
  v_dot2_f32_bf16 v56, v95, v37, v56
  v_dot2_f32_bf16 v57, v95, v47, v57
  s_waitcnt vmcnt(1)
  v_dot2_f32_bf16 v50, v96, v38, v50
  v_dot2_f32_bf16 v51, v96, v48, v51
  v_dot2_f32_bf16 v52, v97, v38, v52
  v_dot2_f32_bf16 v53, v97, v48, v53
  v_dot2_f32_bf16 v54, v98, v38, v54
  v_dot2_f32_bf16 v55, v98, v48, v55
  v_dot2_f32_bf16 v56, v99, v38, v56
  v_dot2_f32_bf16 v57, v99, v48, v57
  s_waitcnt vmcnt(0)
  v_dot2_f32_bf16 v50, v100, v39, v50
  v_dot2_f32_bf16 v51, v100, v49, v51
  v_dot2_f32_bf16 v52, v101, v39, v52
  v_dot2_f32_bf16 v53, v101, v49, v53
  v_dot2_f32_bf16 v54, v102, v39, v54
  v_dot2_f32_bf16 v55, v102, v49, v55
  v_dot2_f32_bf16 v56, v103, v39, v56
  v_dot2_f32_bf16 v57, v103, v49, v57
  s_nop 2
  v_permlane32_swap_b32 v50, v54
  v_permlane32_swap_b32 v51, v55
  v_permlane32_swap_b32 v52, v56
  v_permlane32_swap_b32 v53, v57
  v_add_f32 v50, v50, v54
  v_add_f32 v51, v51, v55
  v_add_f32 v52, v52, v56
  v_add_f32 v53, v53, v57
  s_nop 0
  v_permlane16_swap_b32 v50, v52
  v_permlane16_swap_b32 v51, v53
  v_add_f32 v50, v50, v52
  v_add_f32 v51, v51, v53
  v_bfe_u32 v14, v1, 3, 1
  s_lshl_b32 s18, s3, 1
  v_add_u32 v14, s18, v14
  v_lshlrev_b32 v14, 8, v14
  v_lshrrev_b32 v15, 4, v1
  v_lshlrev_b32 v15, 3, v15
  v_lshl_add_u32 v15, v11, 5, v15
  v_add_u32 v14, v14, v15
  ds_write_b64 v14, v[50:51]
  s_waitcnt lgkmcnt(0)
  s_barrier
  s_cmp_lg_u32 s3, 0
  s_cbranch_scc1 Lad_p1done
  v_lshlrev_b32 v14, 2, v1
  ds_read_b32 v64, v14 offset:0
  ds_read_b32 v65, v14 offset:256
  ds_read_b32 v66, v14 offset:512
  ds_read_b32 v67, v14 offset:768
  ds_read_b32 v68, v14 offset:1024
  ds_read_b32 v69, v14 offset:1280
  ds_read_b32 v70, v14 offset:1536
  ds_read_b32 v71, v14 offset:1792
  ds_read_b32 v72, v14 offset:2048
  ds_read_b32 v73, v14 offset:2304
  ds_read_b32 v74, v14 offset:2560
  ds_read_b32 v75, v14 offset:2816
  ds_read_b32 v76, v14 offset:3072
  ds_read_b32 v77, v14 offset:3328
  ds_read_b32 v78, v14 offset:3584
  ds_read_b32 v79, v14 offset:3840
  s_waitcnt lgkmcnt(0)
  v_add_f32 v64, v64, v72
  v_add_f32 v65, v65, v73
  v_add_f32 v66, v66, v74
  v_add_f32 v67, v67, v75
  v_add_f32 v68, v68, v76
  v_add_f32 v69, v69, v77
  v_add_f32 v70, v70, v78
  v_add_f32 v71, v71, v79
  v_add_f32 v64, v64, v68
  v_add_f32 v65, v65, v69
  v_add_f32 v66, v66, v70
  v_add_f32 v67, v67, v71
  v_add_f32 v64, v64, v66
  v_add_f32 v65, v65, v67
  v_add_f32 v64, v64, v65
  v_cvt_pk_bf16_f32 v64, 0, v64
  s_mul_i32 s18, s16, 205
  s_lshr_b32 s18, s18, 11
  s_cmp_eq_u32 s18, 1
  s_cselect_b32 s19, 1.0, 0
  s_cmp_eq_u32 s18, 4
  s_cselect_b32 s19, 1.0, s19
  v_add_f32 v64, s19, v64
  v_cvt_pk_bf16_f32 v64, 0, v64
  s_lshl_b32 s18, s16, 8
  buffer_store_dword v64, v14, s[32:35], s18 offen sc1
  s_branch Lad_p1done
Lad_notmod:
  s_waitcnt lgkmcnt(0)
  s_cmp_ge_u32 s2, 228
  s_cbranch_scc1 Lad_p1done
  s_sub_u32 s16, s2, 220
  s_mul_i32 s16, s16, 9216
  v_lshlrev_b32 v10, 4, v0
  v_mov_b32 v12, 0
  v_mov_b32 v13, 0
  v_mov_b32 v14, 0
  v_mov_b32 v15, 0
  s_add_u32 s24, s10, 0x4000
  s_addc_u32 s25, s11, 0
  s_mov_b32 s26, 0x12000
  s_mov_b32 s27, 0x20000
  buffer_store_dwordx4 v[12:15], v10, s[24:27], s16 offen sc1
  s_cmp_lg_u32 s3, 0
  s_cbranch_scc1 Lad_hk1
  s_add_u32 s16, s16, 8192
  buffer_store_dwordx4 v[12:15], v10, s[24:27], s16 offen sc1
Lad_hk1:
  s_mov_b32 s28, s8
  s_mov_b32 s29, s9
  s_mov_b32 s30, 0x100
  s_mov_b32 s31, 0x20000
  v_mov_b32 v16, 1
  s_waitcnt vmcnt(0)
  s_barrier
  s_cmp_lg_u32 s3, 0
  s_cbranch_scc1 Lad_p1done
  s_mov_b64 exec, 1
  buffer_atomic_add v16, v12, s[28:31], 0 offen sc1
  s_mov_b64 exec, -1
Lad_p1done:
  s_and_b32 s14, s2, 7
  s_lshr_b32 s15, s2, 3
  s_add_u32 s28, s10, 0x8000
  s_addc_u32 s29, s11, 0
  s_mov_b32 s30, 0xe000
  s_mov_b32 s31, 0x20000
  s_mov_b32 s32, s8
  s_mov_b32 s33, s9
  s_mov_b32 s34, 0x100
  s_mov_b32 s35, 0x20000
  s_and_b32 s22, s15, 15
  s_lshl_b32 s22, s22, 7
  v_lshl_add_u32 v46, v1, 11, s22
  s_lshl_b32 s22, s14, 11
  v_lshl_add_u32 v47, v1, 7, s22
  v_mov_b32 v48, 1
  v_mov_b32 v49, 0
  s_waitcnt vmcnt(0)
  s_barrier
  s_cmp_lg_u32 s3, 0
  s_cbranch_scc1 Lad_h1s
  s_mov_b32 s46, 0
  s_mov_b32 s47, 8192
  s_mov_b64 exec, 1
Lad_h1z:
  buffer_load_dword v2, v49, s[32:35], 0 offen sc0 sc1
  s_add_u32 s46, s46, 1
  s_waitcnt vmcnt(0)
  v_cmp_gt_u32 vcc, 8, v2
  s_cbranch_vccz Lad_h1zd
  s_cmp_lt_u32 s46, 0x400000
  s_cbranch_scc1 Lad_h1z
Lad_h1zd:
  s_mov_b64 exec, 0xff
  buffer_atomic_add v48, v46, s[28:31], s47 offen sc1
  s_mov_b64 exec, -1
  s_cmp_lt_u32 s2, 228
  s_cbranch_scc1 Lad_h1s
  s_mov_b32 s36, s52
  s_mov_b32 s37, s53
  s_mov_b32 s38, 0x21c000
  s_mov_b32 s39, 0x20000
  s_mov_b32 s40, s56
  s_mov_b32 s41, s57
  s_mov_b32 s42, 0x10e000
  s_mov_b32 s43, 0x20000
  s_sub_u32 s22, s2, 228
  s_lshl_b32 s22, s22, 13
  v_lshlrev_b32 v2, 7, v1
  s_add_u32 s23, s22, 0
  buffer_load_dword v55, v2, s[36:39], s23 offen
  buffer_load_dword v55, v2, s[40:43], s23 offen
  s_add_u32 s23, s22, 229376
  buffer_load_dword v55, v2, s[36:39], s23 offen
  buffer_load_dword v55, v2, s[40:43], s23 offen
  s_add_u32 s23, s22, 458752
  buffer_load_dword v55, v2, s[36:39], s23 offen
  buffer_load_dword v55, v2, s[40:43], s23 offen
  s_add_u32 s23, s22, 688128
  buffer_load_dword v55, v2, s[36:39], s23 offen
  buffer_load_dword v55, v2, s[40:43], s23 offen
  s_add_u32 s23, s22, 917504
  buffer_load_dword v55, v2, s[36:39], s23 offen
  buffer_load_dword v55, v2, s[40:43], s23 offen
  s_add_u32 s23, s22, 1146880
  buffer_load_dword v55, v2, s[36:39], s23 offen
  s_add_u32 s23, s22, 1376256
  buffer_load_dword v55, v2, s[36:39], s23 offen
  s_add_u32 s23, s22, 1605632
  buffer_load_dword v55, v2, s[36:39], s23 offen
  s_add_u32 s23, s22, 1835008
  buffer_load_dword v55, v2, s[36:39], s23 offen
  s_add_u32 s23, s22, 2064384
  buffer_load_dword v55, v2, s[36:39], s23 offen
Lad_h1s:
  s_lshl_b32 s16, s14, 2
  s_lshr_b32 s18, s15, 3
  s_add_u32 s16, s16, s18
  s_and_b32 s17, s15, 7
  v_lshlrev_b32 v9, 4, v1
  s_mov_b32 s36, s4
  s_mov_b32 s37, s5
  s_mov_b32 s38, 0x280000
  s_mov_b32 s39, 0x20000
  s_lshl_b32 s18, s17, 8
  s_add_u32 s18, s18, s16
  s_mov_b32 s19, 1.0
  s_mov_b32 s20, 1.0
  s_mov_b32 s21, 0xbe800000
  s_cmp_lg_u32 s16, 0
  s_cbranch_scc1 Lad_par
  s_cmp_ge_u32 s17, 4
  s_cselect_b32 s19, 0, 1.0
  s_cselect_b32 s20, 1.0, 0
  s_cselect_b32 s22, 992, 0
  s_sub_u32 s18, s18, s22
  s_mov_b32 s21, 0
Lad_par:
  s_and_b32 s44, s3, 3
  s_lshl_b32 s42, s44, 6
  s_add_u32 s42, s42, s18
  s_lshr_b32 s43, s3, 2
  s_sub_u32 s45, 2048, s42
  s_cmp_eq_u32 s43, 1
  s_cselect_b32 s42, s45, s42
  s_cmp_eq_u32 s42, 2048
  s_cselect_b32 s42, 1024, s42
  s_cselect_b32 s43, 0, s43
  s_cselect_b32 s44, 4, s44
  s_mul_i32 s45, s42, 1280
  v_lshlrev_b32 v44, 3, v1
  v_lshlrev_b32 v43, 2, v1
  buffer_load_dwordx2 v[50:51], v44, s[36:39], s45 offen
  buffer_load_dwordx2 v[52:53], v44, s[36:39], s45 offen offset:512
  buffer_load_dword v54, v43, s[36:39], s45 offen offset:1024
  v_and_b32 v10, 15, v1
  v_lshrrev_b32 v11, 4, v1
  v_lshrrev_b32 v14, 2, v10
  v_and_b32 v15, 3, v10
  s_lshl_b32 s22, s3, 3
  v_add_u32 v16, s22, v15
  v_add_u32 v17, 4, v16
  s_cmp_lt_u32 s3, 5
  s_cbranch_scc1 Lad_pa
  s_sub_u32 s22, s3, 5
  s_lshl_b32 s22, s22, 4
  v_mov_b32 v14, 4
  v_add_u32 v16, s22, v10
  v_min_u32 v16, 39, v16
  v_mov_b32 v17, v16
Lad_pa:
  v_lshlrev_b32 v18, 7, v16
  v_lshl_add_u32 v24, v11, 4, v18
  v_mul_u32_u24 v18, 3200, v14
  v_mul_u32_u24 v19, 80, v16
  v_add_u32 v18, v18, v19
  v_lshl_add_u32 v20, v11, 4, v18
  v_mul_u32_u24 v18, 3104, v14
  v_mul_u32_u24 v19, 384, v11
  v_add_u32 v18, v18, v19
  v_lshl_add_u32 v22, v16, 2, v18
  v_lshlrev_b32 v18, 7, v17
  v_lshl_add_u32 v25, v11, 4, v18
  v_mul_u32_u24 v18, 3200, v14
  v_mul_u32_u24 v19, 80, v17
  v_add_u32 v18, v18, v19
  v_lshl_add_u32 v21, v11, 4, v18
  v_mul_u32_u24 v18, 3104, v14
  v_mul_u32_u24 v19, 384, v11
  v_add_u32 v18, v18, v19
  v_lshl_add_u32 v23, v17, 2, v18
  s_add_u32 s22, s3, 0
  s_min_u32 s22, s22, 14
  s_mul_i32 s23, s22, 86
  s_lshr_b32 s23, s23, 8
  s_mul_i32 s40, s23, 3
  s_sub_u32 s40, s22, s40
  s_mul_i32 s41, s40, 3072
  v_add_u32 v6, s41, v9
  s_lshl_b32 s41, s23, 2
  v_lshrrev_b32 v2, 2, v10
  v_and_b32 v3, 3, v10
  v_add_u32 v3, s41, v3
  s_cmp_lt_u32 s23, 4
  s_cbranch_scc1 Lad_pb0
  v_mov_b32 v2, 4
  v_mov_b32 v3, v10
Lad_pb0:
  v_lshlrev_b32 v19, 8, v11
  v_lshl_add_u32 v19, v3, 2, v19
  s_lshl_b32 s41, s40, 10
  v_add_u32 v19, s41, v19
  v_mul_u32_u24 v18, 3088, v2
  v_add_u32 v4, v18, v19
  v_sub_u32 v18, v18, v19
  v_add_u32 v30, 134208, v18
  v_mul_u32_u24 v2, 3104, v2
  v_mul_u32_u24 v3, 192, v3
  v_add_u32 v2, v2, v3
  v_lshl_add_u32 v26, v11, 4, v2
  v_and_b32 v3, 1, v11
  v_lshl_add_u32 v28, v3, 4, v2
  s_add_u32 s22, s3, 8
  s_min_u32 s22, s22, 14
  s_mul_i32 s23, s22, 86
  s_lshr_b32 s23, s23, 8
  s_mul_i32 s40, s23, 3
  s_sub_u32 s40, s22, s40
  s_mul_i32 s41, s40, 3072
  v_add_u32 v7, s41, v9
  s_lshl_b32 s41, s23, 2
  v_lshrrev_b32 v2, 2, v10
  v_and_b32 v3, 3, v10
  v_add_u32 v3, s41, v3
  s_cmp_lt_u32 s23, 4
  s_cbranch_scc1 Lad_pb1
  v_mov_b32 v2, 4
  v_mov_b32 v3, v10
Lad_pb1:
  v_lshlrev_b32 v19, 8, v11
  v_lshl_add_u32 v19, v3, 2, v19
  s_lshl_b32 s41, s40, 10
  v_add_u32 v19, s41, v19
  v_mul_u32_u24 v18, 3088, v2
  v_add_u32 v5, v18, v19
  v_sub_u32 v18, v18, v19
  v_add_u32 v31, 134208, v18
  v_mul_u32_u24 v2, 3104, v2
  v_mul_u32_u24 v3, 192, v3
  v_add_u32 v2, v2, v3
  v_lshl_add_u32 v27, v11, 4, v2
  v_and_b32 v3, 1, v11
  v_lshl_add_u32 v29, v3, 4, v2
  v_lshrrev_b32 v2, 1, v10
  v_and_b32 v3, 1, v10
  v_lshlrev_b32 v12, 6, v2
  v_add_u32 v12, s18, v12
  v_cmp_eq_u32 vcc, 4, v2
  v_mov_b32 v13, 1024
  s_nop 0
  v_cndmask_b32 v12, v12, v13, vcc
  v_cvt_f32_u32 v12, v12
  v_mul_f32 v12, 0x3a000000, v12
  v_cvt_f32_u32 v3, v3
  v_mul_f32 v3, 0x3e800000, v3
  v_lshlrev_b32 v13, 2, v11
  v_cvt_f32_u32 v13, v13
  v_fma_f32 v13, v12, v13, v3
  v_fmamk_f32 v64, v12, 0x00000000, v13
  v_add_f32 v72, s21, v64
  v_fmamk_f32 v65, v12, 0x3f800000, v13
  v_add_f32 v73, s21, v65
  v_fmamk_f32 v66, v12, 0x40000000, v13
  v_add_f32 v74, s21, v66
  v_fmamk_f32 v67, v12, 0x40400000, v13
  v_add_f32 v75, s21, v67
  v_fmamk_f32 v68, v12, 0x41800000, v13
  v_add_f32 v76, s21, v68
  v_fmamk_f32 v69, v12, 0x41880000, v13
  v_add_f32 v77, s21, v69
  v_fmamk_f32 v70, v12, 0x41900000, v13
  v_add_f32 v78, s21, v70
  v_fmamk_f32 v71, v12, 0x41980000, v13
  v_add_f32 v79, s21, v71
  v_cos_f32 v64, v64
  v_cos_f32 v65, v65
  v_cos_f32 v66, v66
  v_cos_f32 v67, v67
  v_cos_f32 v68, v68
  v_cos_f32 v69, v69
  v_cos_f32 v70, v70
  v_cos_f32 v71, v71
  v_cos_f32 v72, v72
  v_cos_f32 v73, v73
  v_cos_f32 v74, v74
  v_cos_f32 v75, v75
  v_cos_f32 v76, v76
  v_cos_f32 v77, v77
  v_cos_f32 v78, v78
  v_cos_f32 v79, v79
  v_mul_f32 v64, s19, v64
  v_mul_f32 v65, s19, v65
  v_mul_f32 v66, s19, v66
  v_mul_f32 v67, s19, v67
  v_mul_f32 v68, s19, v68
  v_mul_f32 v69, s19, v69
  v_mul_f32 v70, s19, v70
  v_mul_f32 v71, s19, v71
  v_mul_f32 v72, s20, v72
  v_mul_f32 v73, s20, v73
  v_mul_f32 v74, s20, v74
  v_mul_f32 v75, s20, v75
  v_mul_f32 v76, s20, v76
  v_mul_f32 v77, s20, v77
  v_mul_f32 v78, s20, v78
  v_mul_f32 v79, s20, v79
  v_cvt_pk_bf16_f32 v56, v64, v65
  v_cvt_pk_bf16_f32 v57, v66, v67
  v_cvt_pk_bf16_f32 v58, v68, v69
  v_cvt_pk_bf16_f32 v59, v70, v71
  v_cvt_pk_bf16_f32 v60, v72, v73
  v_cvt_pk_bf16_f32 v61, v74, v75
  v_cvt_pk_bf16_f32 v62, v76, v77
  v_cvt_pk_bf16_f32 v63, v78, v79
  v_lshrrev_b32 v2, 2, v1
  v_and_b32 v3, 3, v1
  v_and_b32 v12, 7, v2
  v_lshlrev_b32 v12, 1, v12
  v_mul_u32_u24 v2, 1280, v2
  v_and_b32 v13, 1, v3
  v_lshl_add_u32 v2, v13, 3, v2
  v_add_u32 v2, 73984, v2
  s_mul_i32 s22, s3, 10
  v_lshrrev_b32 v3, 1, v3
  v_add_u32 v3, s22, v3
  v_add_u32 v13, 0, v3
  v_xor_b32 v13, v13, v12
  v_lshl_add_u32 v32, v13, 4, v2
  v_add_u32 v13, 2, v3
  v_xor_b32 v13, v13, v12
  v_lshl_add_u32 v33, v13, 4, v2
  v_add_u32 v13, 4, v3
  v_xor_b32 v13, v13, v12
  v_lshl_add_u32 v34, v13, 4, v2
  v_add_u32 v13, 6, v3
  v_xor_b32 v13, v13, v12
  v_lshl_add_u32 v35, v13, 4, v2
  v_add_u32 v13, 8, v3
  v_xor_b32 v13, v13, v12
  v_lshl_add_u32 v36, v13, 4, v2
  s_mul_i32 s22, s3, 80
  v_add_u32 v2, s22, v10
  v_mul_u32_u24 v3, 6400, v11
  v_lshlrev_b32 v8, 2, v2
  v_add_u32 v8, 57600, v8
  v_add_u32 v42, 57600, v9
  v_add_u32 v15, 57600, v44
  v_add_u32 v12, 0, v2
  v_mul_u32_u24 v13, 205, v12
  v_lshrrev_b32 v13, 13, v13
  v_mul_u32_u24 v18, 40, v13
  v_sub_u32 v12, v12, v18
  v_mul_u32_u24 v12, 80, v12
  v_lshl_add_u32 v12, v13, 2, v12
  v_add_u32 v37, v12, v3
  v_add_u32 v12, 16, v2
  v_mul_u32_u24 v13, 205, v12
  v_lshrrev_b32 v13, 13, v13
  v_mul_u32_u24 v18, 40, v13
  v_sub_u32 v12, v12, v18
  v_mul_u32_u24 v12, 80, v12
  v_lshl_add_u32 v12, v13, 2, v12
  v_add_u32 v38, v12, v3
  v_add_u32 v12, 32, v2
  v_mul_u32_u24 v13, 205, v12
  v_lshrrev_b32 v13, 13, v13
  v_mul_u32_u24 v18, 40, v13
  v_sub_u32 v12, v12, v18
  v_mul_u32_u24 v12, 80, v12
  v_lshl_add_u32 v12, v13, 2, v12
  v_add_u32 v39, v12, v3
  v_add_u32 v12, 48, v2
  v_mul_u32_u24 v13, 205, v12
  v_lshrrev_b32 v13, 13, v13
  v_mul_u32_u24 v18, 40, v13
  v_sub_u32 v12, v12, v18
  v_mul_u32_u24 v12, 80, v12
  v_lshl_add_u32 v12, v13, 2, v12
  v_add_u32 v40, v12, v3
  v_add_u32 v12, 64, v2
  v_mul_u32_u24 v13, 205, v12
  v_lshrrev_b32 v13, 13, v13
  v_mul_u32_u24 v18, 40, v13
  v_sub_u32 v12, v12, v18
  v_mul_u32_u24 v12, 80, v12
  v_lshl_add_u32 v12, v13, 2, v12
  v_add_u32 v41, v12, v3
  s_cmp_eq_u32 s2, 0
  s_cselect_b32 s22, 0x45000000, 0
  v_cmp_eq_u32 vcc, 0, v11
  v_mov_b32 v2, s22
  s_nop 0
  v_cndmask_b32 v45, 0, v2, vcc
  s_mul_i32 s22, s44, 3088
  s_cmp_eq_u32 s43, 1
  s_cselect_b32 s40, 131840, 0
  s_add_u32 s22, s22, s40
  v_add_u32 v16, s22, v9
  v_add_u32 v17, s22, v44
  s_add_u32 s24, s10, 0x380000
  s_addc_u32 s25, s11, 0
  s_mov_b32 s26, 0x280000
  s_mov_b32 s27, 0x20000
  s_add_u32 s36, s10, 0x600000
  s_addc_u32 s37, s11, 0
  s_mov_b32 s38, 0x280000
  s_mov_b32 s39, 0x20000
  s_cmp_lg_u32 s3, 0
  s_cbranch_scc1 Lad_h1go
  s_mov_b64 exec, 0xffff
Lad_h1p:
  buffer_load_dword v49, v47, s[28:31], s47 offen sc0 sc1
  s_add_u32 s46, s46, 1
  s_waitcnt vmcnt(0)
  v_cmp_gt_u32 vcc, 16, v49
  s_cbranch_vccz Lad_h1d
  s_cmp_lt_u32 s46, 0x400000
  s_cbranch_scc1 Lad_h1p
Lad_h1d:
  s_mov_b64 exec, -1
Lad_h1go:
  s_waitcnt vmcnt(0)
  s_barrier
  s_barrier
  ds_read_b64_tr_b16 v[64:65], v32 offset:0
  ds_read_b64_tr_b16 v[66:67], v32 offset:20480
  ds_read_b64_tr_b16 v[72:73], v33 offset:0
  ds_read_b64_tr_b16 v[74:75], v33 offset:20480
  ds_read_b64_tr_b16 v[80:81], v34 offset:0
  ds_read_b64_tr_b16 v[82:83], v34 offset:20480
  ds_read_b64_tr_b16 v[88:89], v35 offset:0
  ds_read_b64_tr_b16 v[90:91], v35 offset:20480
  ds_read_b64_tr_b16 v[96:97], v36 offset:0
  ds_read_b64_tr_b16 v[98:99], v36 offset:20480
  ds_read_b128 v[136:139], v9 offset:41216
  ds_read_b128 v[140:143], v9 offset:42240
  s_waitcnt lgkmcnt(10)
  v_mfma_f32_16x16x32_bf16 v[116:119], v[56:59], v[64:67], 0
  s_waitcnt lgkmcnt(8)
  v_mfma_f32_16x16x32_bf16 v[120:123], v[56:59], v[72:75], 0
  s_waitcnt lgkmcnt(6)
  v_mfma_f32_16x16x32_bf16 v[124:127], v[56:59], v[80:83], 0
  s_waitcnt lgkmcnt(4)
  v_mfma_f32_16x16x32_bf16 v[128:131], v[56:59], v[88:91], 0
  s_waitcnt lgkmcnt(2)
  v_mfma_f32_16x16x32_bf16 v[132:135], v[56:59], v[96:99], 0
  ds_read_b128 v[144:147], v24 offset:43264
  ds_read_b128 v[148:151], v24 offset:43328
  ds_read_b128 v[152:155], v25 offset:43264
  ds_read_b128 v[156:159], v25 offset:43328
  s_waitcnt lgkmcnt(0)
  s_barrier
  ds_read_b64_tr_b16 v[68:69], v32 offset:40960
  ds_read_b64_tr_b16 v[70:71], v32 offset:61440
  ds_read2st64_b32 v[104:105], v8 offset0:0 offset1:10
  v_add_u32 v8, 64, v8
  ds_read_b64_tr_b16 v[76:77], v33 offset:40960
  ds_read_b64_tr_b16 v[78:79], v33 offset:61440
  ds_read2st64_b32 v[106:107], v8 offset0:0 offset1:10
  v_add_u32 v8, 64, v8
  ds_read_b64_tr_b16 v[84:85], v34 offset:40960
  ds_read_b64_tr_b16 v[86:87], v34 offset:61440
  ds_read2st64_b32 v[108:109], v8 offset0:0 offset1:10
  v_add_u32 v8, 64, v8
  ds_read_b64_tr_b16 v[92:93], v35 offset:40960
  ds_read_b64_tr_b16 v[94:95], v35 offset:61440
  ds_read2st64_b32 v[110:111], v8 offset0:0 offset1:10
  v_add_u32 v8, 64, v8
  ds_read_b64_tr_b16 v[100:101], v36 offset:40960
  ds_read_b64_tr_b16 v[102:103], v36 offset:61440
  ds_read2st64_b32 v[112:113], v8 offset0:0 offset1:10
  s_waitcnt lgkmcnt(12)
  v_mfma_f32_16x16x32_bf16 v[116:119], v[60:63], v[68:71], v[116:119]
  s_waitcnt lgkmcnt(9)
  v_mfma_f32_16x16x32_bf16 v[120:123], v[60:63], v[76:79], v[120:123]
  s_waitcnt lgkmcnt(6)
  v_mfma_f32_16x16x32_bf16 v[124:127], v[60:63], v[84:87], v[124:127]
  s_waitcnt lgkmcnt(3)
  v_mfma_f32_16x16x32_bf16 v[128:131], v[60:63], v[92:95], v[128:131]
  s_waitcnt lgkmcnt(0)
  v_mfma_f32_16x16x32_bf16 v[132:135], v[60:63], v[100:103], v[132:135]
  v_mul_f32 v104, v104, v45
  v_fma_f32 v116, v116, v105, v104
  v_mul_f32 v117, v117, v105
  v_mul_f32 v118, v118, v105
  v_mul_f32 v119, v119, v105
  v_cvt_pk_bf16_f32 v116, v116, v117
  v_cvt_pk_bf16_f32 v118, v118, v119
  v_mul_f32 v106, v106, v45
  v_fma_f32 v120, v120, v107, v106
  v_mul_f32 v121, v121, v107
  v_mul_f32 v122, v122, v107
  v_mul_f32 v123, v123, v107
  v_cvt_pk_bf16_f32 v120, v120, v121
  v_cvt_pk_bf16_f32 v122, v122, v123
  v_mul_f32 v108, v108, v45
  v_fma_f32 v124, v124, v109, v108
  v_mul_f32 v125, v125, v109
  v_mul_f32 v126, v126, v109
  v_mul_f32 v127, v127, v109
  v_cvt_pk_bf16_f32 v124, v124, v125
  v_cvt_pk_bf16_f32 v126, v126, v127
  v_mul_f32 v110, v110, v45
  v_fma_f32 v128, v128, v111, v110
  v_mul_f32 v129, v129, v111
  v_mul_f32 v130, v130, v111
  v_mul_f32 v131, v131, v111
  v_cvt_pk_bf16_f32 v128, v128, v129
  v_cvt_pk_bf16_f32 v130, v130, v131
  v_mul_f32 v112, v112, v45
  v_fma_f32 v132, v132, v113, v112
  v_mul_f32 v133, v133, v113
  v_mul_f32 v134, v134, v113
  v_mul_f32 v135, v135, v113
  v_cvt_pk_bf16_f32 v132, v132, v133
  v_cvt_pk_bf16_f32 v134, v134, v135
  s_mov_b32 exec_hi, 0xffff
  ds_write_b32 v37, v116 offset:0
  ds_write_b32 v38, v120 offset:0
  ds_write_b32 v39, v124 offset:0
  ds_write_b32 v40, v128 offset:0
  ds_write_b32 v41, v132 offset:0
  s_mov_b32 exec_hi, 0
  ds_write_b32 v37, v118 offset:3200
  ds_write_b32 v38, v122 offset:3200
  ds_write_b32 v39, v126 offset:3200
  ds_write_b32 v40, v130 offset:3200
  ds_write_b32 v41, v134 offset:3200
  s_mov_b32 exec_hi, -1
  s_waitcnt lgkmcnt(0)
  s_barrier
  ds_read_b128 v[64:67], v20 offset:0
  ds_read_b128 v[68:71], v21 offset:0
  ds_read_b128 v[104:107], v6 offset:48384
  ds_read_b128 v[108:111], v6 offset:49408
  ds_read_b128 v[112:115], v6 offset:50432
  ds_read_b128 v[116:119], v7 offset:48384
  ds_read_b128 v[120:123], v7 offset:49408
  ds_read_b128 v[124:127], v7 offset:50432
  s_waitcnt lgkmcnt(7)
  v_mfma_f32_16x16x32_bf16 v[72:75], v[136:139], v[64:67], 0
  v_mfma_f32_16x16x32_bf16 v[76:79], v[140:143], v[64:67], 0
  s_waitcnt lgkmcnt(6)
  v_mfma_f32_16x16x32_bf16 v[80:83], v[136:139], v[68:71], 0
  v_mfma_f32_16x16x32_bf16 v[84:87], v[140:143], v[68:71], 0
  s_nop 3
  v_mul_f32 v88, v72, v144
  v_mul_f32 v89, v73, v144
  v_fma_f32 v88, v73, v145, v88
  v_fma_f32 v89, -v72, v145, v89
  v_cvt_pk_bf16_f32 v88, v88, v89
  ds_write_b32 v22, v88 offset:25600
  v_mul_f32 v90, v74, v146
  v_mul_f32 v91, v75, v146
  v_fma_f32 v90, v75, v147, v90
  v_fma_f32 v91, -v74, v147, v91
  v_cvt_pk_bf16_f32 v90, v90, v91
  ds_write_b32 v22, v90 offset:25792
  v_mul_f32 v92, v76, v148
  v_mul_f32 v93, v77, v148
  v_fma_f32 v92, v77, v149, v92
  v_fma_f32 v93, -v76, v149, v93
  v_cvt_pk_bf16_f32 v92, v92, v93
  ds_write_b32 v22, v92 offset:27136
  v_mul_f32 v94, v78, v150
  v_mul_f32 v95, v79, v150
  v_fma_f32 v94, v79, v151, v94
  v_fma_f32 v95, -v78, v151, v95
  v_cvt_pk_bf16_f32 v94, v94, v95
  ds_write_b32 v22, v94 offset:27328
  v_mul_f32 v96, v80, v152
  v_mul_f32 v97, v81, v152
  v_fma_f32 v96, v81, v153, v96
  v_fma_f32 v97, -v80, v153, v97
  v_cvt_pk_bf16_f32 v96, v96, v97
  ds_write_b32 v23, v96 offset:25600
  v_mul_f32 v98, v82, v154
  v_mul_f32 v99, v83, v154
  v_fma_f32 v98, v83, v155, v98
  v_fma_f32 v99, -v82, v155, v99
  v_cvt_pk_bf16_f32 v98, v98, v99
  ds_write_b32 v23, v98 offset:25792
  v_mul_f32 v100, v84, v156
  v_mul_f32 v101, v85, v156
  v_fma_f32 v100, v85, v157, v100
  v_fma_f32 v101, -v84, v157, v101
  v_cvt_pk_bf16_f32 v100, v100, v101
  ds_write_b32 v23, v100 offset:27136
  v_mul_f32 v102, v86, v158
  v_mul_f32 v103, v87, v158
  v_fma_f32 v102, v87, v159, v102
  v_fma_f32 v103, -v86, v159, v103
  v_cvt_pk_bf16_f32 v102, v102, v103
  ds_write_b32 v23, v102 offset:27328
  s_waitcnt lgkmcnt(0)
  s_barrier
  ds_read_b128 v[64:67], v26 offset:25600
  ds_read_b128 v[68:71], v26 offset:25664
  ds_read_b128 v[72:75], v28 offset:25728
  ds_read_b128 v[76:79], v27 offset:25600
  ds_read_b128 v[80:83], v27 offset:25664
  ds_read_b128 v[84:87], v29 offset:25728
  ds_read_b128 v[128:131], v42 offset:5120
  ds_read_b128 v[132:135], v42 offset:6144
  ds_read_b64 v[136:137], v15 offset:7168
  ds_read_b128 v[138:141], v42 offset:10240
  ds_read_b128 v[142:145], v42 offset:11264
  ds_read_b64 v[146:147], v15 offset:12288
  ds_read_b128 v[148:151], v42 offset:7680
  ds_read_b128 v[152:155], v42 offset:8704
  ds_read_b64 v[156:157], v15 offset:9728
  s_waitcnt lgkmcnt(14)
  v_mfma_f32_16x16x32_bf16 v[88:91], v[104:107], v[64:67], 0
  s_waitcnt lgkmcnt(13)
  v_mfma_f32_16x16x32_bf16 v[88:91], v[108:111], v[68:71], v[88:91]
  s_waitcnt lgkmcnt(12)
  v_mfma_f32_16x16x32_bf16 v[88:91], v[112:115], v[72:75], v[88:91]
  s_waitcnt lgkmcnt(11)
  v_mfma_f32_16x16x32_bf16 v[92:95], v[116:119], v[76:79], 0
  s_waitcnt lgkmcnt(10)
  v_mfma_f32_16x16x32_bf16 v[92:95], v[120:123], v[80:83], v[92:95]
  s_waitcnt lgkmcnt(9)
  v_mfma_f32_16x16x32_bf16 v[92:95], v[124:127], v[84:87], v[92:95]
  v_lshlrev_b32 v158, 16, v50
  v_and_b32 v159, 0xffff0000, v50
  v_lshlrev_b32 v160, 16, v51
  v_and_b32 v161, 0xffff0000, v51
  v_lshlrev_b32 v162, 16, v52
  v_and_b32 v163, 0xffff0000, v52
  v_lshlrev_b32 v164, 16, v53
  v_and_b32 v165, 0xffff0000, v53
  v_lshlrev_b32 v166, 16, v54
  v_and_b32 v167, 0xffff0000, v54
  ds_write_b32 v4, v88 offset:0
  ds_write_b32 v30, v88 offset:192
  ds_write_b32 v4, v89 offset:64
  ds_write_b32 v30, v89 offset:128
  ds_write_b32 v4, v90 offset:128
  ds_write_b32 v30, v90 offset:64
  ds_write_b32 v4, v91 offset:192
  ds_write_b32 v30, v91 offset:0
  ds_write_b32 v5, v92 offset:0
  ds_write_b32 v31, v92 offset:192
  ds_write_b32 v5, v93 offset:64
  ds_write_b32 v31, v93 offset:128
  ds_write_b32 v5, v94 offset:128
  ds_write_b32 v31, v94 offset:64
  ds_write_b32 v5, v95 offset:192
  ds_write_b32 v31, v95 offset:0
  s_waitcnt lgkmcnt(0)
  s_barrier
  ds_read_b128 v[64:67], v16
  ds_read_b128 v[68:71], v16 offset:1024
  ds_read_b64 v[72:73], v17 offset:2048
  s_waitcnt lgkmcnt(0)
  v_fma_f32 v158, v128, v64, v158
  v_fma_f32 v159, v129, v65, v159
  v_fma_f32 v160, v130, v66, v160
  v_fma_f32 v161, v131, v67, v161
  v_fma_f32 v162, v132, v68, v162
  v_fma_f32 v163, v133, v69, v163
  v_fma_f32 v164, v134, v70, v164
  v_fma_f32 v165, v135, v71, v165
  v_fma_f32 v166, v136, v72, v166
  v_fma_f32 v167, v137, v73, v167
  v_cvt_pk_bf16_f32 v50, v158, v159
  v_cvt_pk_bf16_f32 v51, v160, v161
  v_cvt_pk_bf16_f32 v52, v162, v163
  v_cvt_pk_bf16_f32 v53, v164, v165
  v_cvt_pk_bf16_f32 v54, v166, v167
  buffer_store_dwordx2 v[50:51], v44, s[24:27], s45 offen sc1
  buffer_store_dwordx2 v[52:53], v44, s[24:27], s45 offen offset:512 sc1
  buffer_store_dword v54, v43, s[24:27], s45 offen offset:1024 sc1
  v_lshlrev_b32 v158, 16, v50
  v_and_b32 v159, 0xffff0000, v50
  v_lshlrev_b32 v160, 16, v51
  v_and_b32 v161, 0xffff0000, v51
  v_lshlrev_b32 v162, 16, v52
  v_and_b32 v163, 0xffff0000, v52
  v_lshlrev_b32 v164, 16, v53
  v_and_b32 v165, 0xffff0000, v53
  v_lshlrev_b32 v166, 16, v54
  v_and_b32 v167, 0xffff0000, v54
  v_add_f32 v64, v158, v159
  v_add_f32 v65, v160, v161
  v_add_f32 v66, v162, v163
  v_add_f32 v67, v164, v165
  v_add_f32 v68, v166, v167
  v_add_f32 v64, v64, v65
  v_add_f32 v66, v66, v67
  v_add_f32 v64, v64, v68
  v_add_f32 v64, v64, v66
  s_nop 1
  v_add_f32_dpp v64, v64, v64 quad_perm:[1,0,3,2] row_mask:0xf bank_mask:0xf
  s_nop 1
  v_add_f32_dpp v64, v64, v64 quad_perm:[2,3,0,1] row_mask:0xf bank_mask:0xf
  s_nop 1
  v_add_f32_dpp v64, v64, v64 row_half_mirror row_mask:0xf bank_mask:0xf
  s_nop 1
  v_add_f32_dpp v64, v64, v64 row_mirror row_mask:0xf bank_mask:0xf
  v_mov_b32 v65, v64
  s_nop 1
  v_permlane16_swap_b32 v64, v65
  v_add_f32 v64, v64, v65
  v_mov_b32 v65, v64
  s_nop 1
  v_permlane32_swap_b32 v64, v65
  v_add_f32 v64, v64, v65
  v_mul_f32 v64, 0xbacccccd, v64
  v_add_f32 v158, v158, v64
  v_add_f32 v159, v159, v64
  v_add_f32 v160, v160, v64
  v_add_f32 v161, v161, v64
  v_add_f32 v162, v162, v64
  v_add_f32 v163, v163, v64
  v_add_f32 v164, v164, v64
  v_add_f32 v165, v165, v64
  v_add_f32 v166, v166, v64
  v_add_f32 v167, v167, v64
  v_mul_f32 v64, v158, v158
  v_mul_f32 v65, v159, v159
  v_fmac_f32 v64, v160, v160
  v_fmac_f32 v65, v161, v161
  v_fmac_f32 v64, v162, v162
  v_fmac_f32 v65, v163, v163
  v_fmac_f32 v64, v164, v164
  v_fmac_f32 v65, v165, v165
  v_fmac_f32 v64, v166, v166
  v_fmac_f32 v65, v167, v167
  v_add_f32 v64, v64, v65
  s_nop 1
  v_add_f32_dpp v64, v64, v64 quad_perm:[1,0,3,2] row_mask:0xf bank_mask:0xf
  s_nop 1
  v_add_f32_dpp v64, v64, v64 quad_perm:[2,3,0,1] row_mask:0xf bank_mask:0xf
  s_nop 1
  v_add_f32_dpp v64, v64, v64 row_half_mirror row_mask:0xf bank_mask:0xf
  s_nop 1
  v_add_f32_dpp v64, v64, v64 row_mirror row_mask:0xf bank_mask:0xf
  v_mov_b32 v65, v64
  s_nop 1
  v_permlane16_swap_b32 v64, v65
  v_add_f32 v64, v64, v65
  v_mov_b32 v65, v64
  s_nop 1
  v_permlane32_swap_b32 v64, v65
  v_add_f32 v64, v64, v65
  v_mov_b32 v65, 0x3727c5ac
  v_fmamk_f32 v64, v64, 0x3acccccd, v65
  v_rsq_f32 v64, v64
  s_nop 0
  v_mul_f32 v158, v158, v64
  v_mul_f32 v159, v159, v64
  v_mul_f32 v160, v160, v64
  v_mul_f32 v161, v161, v64
  v_mul_f32 v162, v162, v64
  v_mul_f32 v163, v163, v64
  v_mul_f32 v164, v164, v64
  v_mul_f32 v165, v165, v64
  v_mul_f32 v166, v166, v64
  v_mul_f32 v167, v167, v64
  v_fma_f32 v158, v158, v138, v148
  v_fma_f32 v159, v159, v139, v149
  v_fma_f32 v160, v160, v140, v150
  v_fma_f32 v161, v161, v141, v151
  v_fma_f32 v162, v162, v142, v152
  v_fma_f32 v163, v163, v143, v153
  v_fma_f32 v164, v164, v144, v154
  v_fma_f32 v165, v165, v145, v155
  v_fma_f32 v166, v166, v146, v156
  v_fma_f32 v167, v167, v147, v157
  v_cvt_pk_bf16_f32 v68, v158, v159
  v_cvt_pk_bf16_f32 v69, v160, v161
  v_cvt_pk_bf16_f32 v70, v162, v163
  v_cvt_pk_bf16_f32 v71, v164, v165
  v_cvt_pk_bf16_f32 v72, v166, v167
  buffer_store_dwordx2 v[68:69], v44, s[36:39], s45 offen sc1
  buffer_store_dwordx2 v[70:71], v44, s[36:39], s45 offen offset:512 sc1
  buffer_store_dword v72, v43, s[36:39], s45 offen offset:1024 sc1
  s_waitcnt vmcnt(0)
  s_barrier
  s_cmp_lg_u32 s3, 0
  s_cbranch_scc1 Lad_h2s
  s_mov_b32 s46, 0
  s_mov_b32 s47, 24576
  s_mov_b64 exec, 0xff
  buffer_atomic_add v48, v46, s[28:31], s47 offen sc1
  s_mov_b64 exec, -1
Lad_h2s:
  s_and_b32 s16, s2, 7
  s_lshr_b32 s17, s2, 3
  s_and_b32 s18, s16, 3
  s_lshl_b32 s18, s18, 3
  s_and_b32 s19, s17, 7
  s_add_u32 s18, s18, s19
  s_lshr_b32 s19, s16, 2
  s_lshl_b32 s19, s19, 2
  s_lshr_b32 s17, s17, 3
  s_add_u32 s19, s19, s17
  v_mov_b32 v5, v9
  v_lshrrev_b32 v15, 2, v10
  v_and_b32 v16, 3, v10
  v_lshrrev_b32 v17, 1, v16
  v_lshlrev_b32 v17, 2, v17
  v_and_b32 v18, 2, v15
  v_or_b32 v17, v17, v18
  v_xor_b32 v17, v17, v11
  v_lshlrev_b32 v17, 4, v17
  v_lshl_add_u32 v16, v15, 3, v16
  v_lshl_add_u32 v4, v16, 7, v17
  v_add_u32 v4, 32768, v4
  s_lshr_b32 s20, s3, 2
  s_lshl_b32 s23, s20, 12
  v_add_u32 v6, s23, v4
  v_xor_b32 v7, 64, v6
  v_add_u32 v8, 65536, v6
  v_add_u32 v9, 65536, v7
  v_lshrrev_b32 v14, 2, v1
  v_mul_u32_u24 v14, 224, v14
  v_and_b32 v13, 3, v1
  v_lshl_add_u32 v14, v13, 3, v14
  s_and_b32 s21, s3, 3
  s_lshl_b32 s23, s21, 6
  v_add_u32 v12, s23, v14
  v_add_u32 v13, 114688, v12
  s_lshl_b32 s23, s21, 11
  v_add_u32 v18, s23, v5
  v_add_u32 v19, 114688, v18
  s_and_b32 s23, s3, 1
  s_lshl_b32 s23, s23, 12
  s_bfe_u32 s22, s3, 0x10001
  s_lshl_b32 s22, s22, 9
  s_add_u32 s23, s23, s22
  v_add_u32 v24, s23, v4
  v_xor_b32 v25, 64, v24
  v_add_u32 v26, 65536, v24
  v_add_u32 v27, 65536, v25
  v_mov_b32 v15, 0xbdd2d3e8
  s_lshl_b32 s22, s18, 1
  s_add_u32 s20, s20, s22
  s_lshl_b32 s22, s19, 6
  s_add_u32 s22, s22, s20
  s_mul_i32 s22, s22, 7168
  s_lshl_b32 s23, s21, 11
  s_add_u32 s22, s22, s23
  s_add_u32 s24, s10, 0xc00000
  s_addc_u32 s25, s11, 0
  s_mov_b32 s26, 0x380000
  s_mov_b32 s27, 0x20000
  s_add_u32 s36, s10, 0x4000
  s_addc_u32 s37, s11, 0
  s_mov_b32 s38, 0x4000
  s_mov_b32 s39, 0x20000
  s_and_b32 s23, s15, 15
  s_lshl_b32 s23, s23, 7
  v_lshl_add_u32 v20, v1, 11, s23
  s_lshl_b32 s23, s14, 11
  v_lshl_add_u32 v21, v1, 7, s23
  v_mov_b32 v22, 1
  s_cmp_lg_u32 s3, 0
  s_cbranch_scc1 Lad_h2go
  s_mov_b64 exec, 0xffff
Lad_h2p:
  buffer_load_dword v49, v47, s[28:31], s47 offen sc0 sc1
  s_add_u32 s46, s46, 1
  s_waitcnt vmcnt(0)
  v_cmp_gt_u32 vcc, 16, v49
  s_cbranch_vccz Lad_h2d
  s_cmp_lt_u32 s46, 0x400000
  s_cbranch_scc1 Lad_h2p
Lad_h2d:
  s_mov_b64 exec, -1
Lad_h2go:
  s_waitcnt vmcnt(0)
  s_barrier
  s_or_b32 s23, s2, s3
  s_cmp_lg_u32 s23, 0
  s_cbranch_scc1 Lad_dz
  v_mov_b32 v160, 0
  s_mov_b64 exec, 1
  buffer_store_dword v160, v160, s[32:35], 0 offen sc1
  s_mov_b64 exec, -1
Lad_dz:
  s_cmp_eq_u32 s21, 3
  s_cbranch_scc1 Lad_z2b
  s_barrier
  ds_read_b128 v[48:51], v6 offset:0
  ds_read_b128 v[52:55], v6 offset:512
  ds_read_b64_tr_b16 v[56:57], v12 offset:0
  ds_read_b64_tr_b16 v[58:59], v12 offset:3584
  ds_read_b64_tr_b16 v[60:61], v12 offset:32
  ds_read_b64_tr_b16 v[62:63], v12 offset:3616
  ds_read_b128 v[64:67], v7 offset:0
  ds_read_b128 v[68:71], v7 offset:512
  ds_read_b64_tr_b16 v[72:73], v12 offset:7168
  ds_read_b64_tr_b16 v[74:75], v12 offset:10752
  ds_read_b64_tr_b16 v[76:77], v12 offset:7200
  ds_read_b64_tr_b16 v[78:79], v12 offset:10784
  s_barrier
  s_waitcnt lgkmcnt(6)
  v_mfma_f32_16x16x32_bf16 v[32:35], v[48:51], v[56:59], 0
  ds_read_b128 v[80:83], v6 offset:8192
  ds_read_b128 v[84:87], v6 offset:8704
  v_mfma_f32_16x16x32_bf16 v[36:39], v[52:55], v[56:59], 0
  ds_read_b64_tr_b16 v[88:89], v12 offset:14336
  ds_read_b64_tr_b16 v[90:91], v12 offset:17920
  v_mfma_f32_16x16x32_bf16 v[40:43], v[48:51], v[60:63], 0
  ds_read_b64_tr_b16 v[92:93], v12 offset:14368
  v_mfma_f32_16x16x32_bf16 v[44:47], v[52:55], v[60:63], 0
  ds_read_b64_tr_b16 v[94:95], v12 offset:17952
  s_waitcnt lgkmcnt(6)
  v_mfma_f32_16x16x32_bf16 v[32:35], v[64:67], v[72:75], v[32:35]
  ds_read_b128 v[48:51], v7 offset:8192
  ds_read_b128 v[52:55], v7 offset:8704
  v_mfma_f32_16x16x32_bf16 v[36:39], v[68:71], v[72:75], v[36:39]
  ds_read_b64_tr_b16 v[56:57], v12 offset:21504
  ds_read_b64_tr_b16 v[58:59], v12 offset:25088
  v_mfma_f32_16x16x32_bf16 v[40:43], v[64:67], v[76:79], v[40:43]
  ds_read_b64_tr_b16 v[60:61], v12 offset:21536
  v_mfma_f32_16x16x32_bf16 v[44:47], v[68:71], v[76:79], v[44:47]
  ds_read_b64_tr_b16 v[62:63], v12 offset:25120
  s_barrier
  s_waitcnt lgkmcnt(6)
  v_mfma_f32_16x16x32_bf16 v[32:35], v[80:83], v[88:91], v[32:35]
  ds_read_b128 v[64:67], v6 offset:16384
  ds_read_b128 v[68:71], v6 offset:16896
  v_mfma_f32_16x16x32_bf16 v[36:39], v[84:87], v[88:91], v[36:39]
  ds_read_b64_tr_b16 v[72:73], v13 offset:0
  ds_read_b64_tr_b16 v[74:75], v13 offset:3584
  v_mfma_f32_16x16x32_bf16 v[40:43], v[80:83], v[92:95], v[40:43]
  ds_read_b64_tr_b16 v[76:77], v13 offset:32
  v_mfma_f32_16x16x32_bf16 v[44:47], v[84:87], v[92:95], v[44:47]
  ds_read_b64_tr_b16 v[78:79], v13 offset:3616
  s_waitcnt lgkmcnt(6)
  v_mfma_f32_16x16x32_bf16 v[32:35], v[48:51], v[56:59], v[32:35]
  ds_read_b128 v[80:83], v7 offset:16384
  ds_read_b128 v[84:87], v7 offset:16896
  v_mfma_f32_16x16x32_bf16 v[36:39], v[52:55], v[56:59], v[36:39]
  ds_read_b64_tr_b16 v[88:89], v13 offset:7168
  ds_read_b64_tr_b16 v[90:91], v13 offset:10752
  v_mfma_f32_16x16x32_bf16 v[40:43], v[48:51], v[60:63], v[40:43]
  ds_read_b64_tr_b16 v[92:93], v13 offset:7200
  v_mfma_f32_16x16x32_bf16 v[44:47], v[52:55], v[60:63], v[44:47]
  ds_read_b64_tr_b16 v[94:95], v13 offset:10784
  s_barrier
  s_waitcnt lgkmcnt(6)
  v_mfma_f32_16x16x32_bf16 v[32:35], v[64:67], v[72:75], v[32:35]
  ds_read_b128 v[48:51], v6 offset:24576
  ds_read_b128 v[52:55], v6 offset:25088
  v_mfma_f32_16x16x32_bf16 v[36:39], v[68:71], v[72:75], v[36:39]
  ds_read_b64_tr_b16 v[56:57], v13 offset:14336
  ds_read_b64_tr_b16 v[58:59], v13 offset:17920
  v_mfma_f32_16x16x32_bf16 v[40:43], v[64:67], v[76:79], v[40:43]
  ds_read_b64_tr_b16 v[60:61], v13 offset:14368
  v_mfma_f32_16x16x32_bf16 v[44:47], v[68:71], v[76:79], v[44:47]
  ds_read_b64_tr_b16 v[62:63], v13 offset:17952
  s_waitcnt lgkmcnt(6)
  v_mfma_f32_16x16x32_bf16 v[32:35], v[80:83], v[88:91], v[32:35]
  ds_read_b128 v[64:67], v7 offset:24576
  ds_read_b128 v[68:71], v7 offset:25088
  v_mfma_f32_16x16x32_bf16 v[36:39], v[84:87], v[88:91], v[36:39]
  ds_read_b64_tr_b16 v[72:73], v13 offset:21504
  ds_read_b64_tr_b16 v[74:75], v13 offset:25088
  v_mfma_f32_16x16x32_bf16 v[40:43], v[80:83], v[92:95], v[40:43]
  ds_read_b64_tr_b16 v[76:77], v13 offset:21536
  v_mfma_f32_16x16x32_bf16 v[44:47], v[84:87], v[92:95], v[44:47]
  ds_read_b64_tr_b16 v[78:79], v13 offset:25120
  s_barrier
  s_waitcnt lgkmcnt(6)
  v_mfma_f32_16x16x32_bf16 v[32:35], v[48:51], v[56:59], v[32:35]
  ds_read_b128 v[80:83], v6 offset:32768
  ds_read_b128 v[84:87], v6 offset:33280
  v_mfma_f32_16x16x32_bf16 v[36:39], v[52:55], v[56:59], v[36:39]
  ds_read_b64_tr_b16 v[88:89], v13 offset:28672
  ds_read_b64_tr_b16 v[90:91], v13 offset:32256
  v_mfma_f32_16x16x32_bf16 v[40:43], v[48:51], v[60:63], v[40:43]
  ds_read_b64_tr_b16 v[92:93], v13 offset:28704
  v_mfma_f32_16x16x32_bf16 v[44:47], v[52:55], v[60:63], v[44:47]
  ds_read_b64_tr_b16 v[94:95], v13 offset:32288
  s_waitcnt lgkmcnt(6)
  v_mfma_f32_16x16x32_bf16 v[32:35], v[64:67], v[72:75], v[32:35]
  ds_read_b128 v[48:51], v7 offset:32768
  ds_read_b128 v[52:55], v7 offset:33280
  v_mfma_f32_16x16x32_bf16 v[36:39], v[68:71], v[72:75], v[36:39]
  ds_read_b64_tr_b16 v[56:57], v13 offset:35840
  ds_read_b64_tr_b16 v[58:59], v13 offset:39424
  v_mfma_f32_16x16x32_bf16 v[40:43], v[64:67], v[76:79], v[40:43]
  ds_read_b64_tr_b16 v[60:61], v13 offset:35872
  v_mfma_f32_16x16x32_bf16 v[44:47], v[68:71], v[76:79], v[44:47]
  ds_read_b64_tr_b16 v[62:63], v13 offset:39456
  s_barrier
  s_waitcnt lgkmcnt(6)
  v_mfma_f32_16x16x32_bf16 v[32:35], v[80:83], v[88:91], v[32:35]
  ds_read_b128 v[64:67], v6 offset:40960
  v_mfma_f32_16x16x32_bf16 v[36:39], v[84:87], v[88:91], v[36:39]
  ds_read_b128 v[68:71], v6 offset:41472
  v_mfma_f32_16x16x32_bf16 v[40:43], v[80:83], v[92:95], v[40:43]
  ds_read_b128 v[72:75], v18 offset:0
  v_mfma_f32_16x16x32_bf16 v[44:47], v[84:87], v[92:95], v[44:47]
  ds_read_b128 v[76:79], v18 offset:1024
  s_waitcnt lgkmcnt(4)
  v_mfma_f32_16x16x32_bf16 v[32:35], v[48:51], v[56:59], v[32:35]
  ds_read_b128 v[80:83], v7 offset:40960
  v_mfma_f32_16x16x32_bf16 v[36:39], v[52:55], v[56:59], v[36:39]
  ds_read_b128 v[84:87], v7 offset:41472
  v_mfma_f32_16x16x32_bf16 v[40:43], v[48:51], v[60:63], v[40:43]
  ds_read_b128 v[88:91], v18 offset:7168
  v_mfma_f32_16x16x32_bf16 v[44:47], v[52:55], v[60:63], v[44:47]
  ds_read_b128 v[92:95], v18 offset:8192
  s_barrier
  s_waitcnt lgkmcnt(4)
  v_mfma_f32_16x16x32_bf16 v[32:35], v[64:67], v[72:75], v[32:35]
  ds_read_b128 v[48:51], v6 offset:49152
  v_mfma_f32_16x16x32_bf16 v[36:39], v[68:71], v[72:75], v[36:39]
  ds_read_b128 v[52:55], v6 offset:49664
  v_mfma_f32_16x16x32_bf16 v[40:43], v[64:67], v[76:79], v[40:43]
  ds_read_b128 v[56:59], v18 offset:14336
  v_mfma_f32_16x16x32_bf16 v[44:47], v[68:71], v[76:79], v[44:47]
  ds_read_b128 v[60:63], v18 offset:15360
  s_waitcnt lgkmcnt(4)
  v_mfma_f32_16x16x32_bf16 v[32:35], v[80:83], v[88:91], v[32:35]
  ds_read_b128 v[64:67], v7 offset:49152
  v_mfma_f32_16x16x32_bf16 v[36:39], v[84:87], v[88:91], v[36:39]
  ds_read_b128 v[68:71], v7 offset:49664
  v_mfma_f32_16x16x32_bf16 v[40:43], v[80:83], v[92:95], v[40:43]
  ds_read_b128 v[72:75], v18 offset:21504
  v_mfma_f32_16x16x32_bf16 v[44:47], v[84:87], v[92:95], v[44:47]
  ds_read_b128 v[76:79], v18 offset:22528
  s_barrier
  s_waitcnt lgkmcnt(4)
  v_mfma_f32_16x16x32_bf16 v[32:35], v[48:51], v[56:59], v[32:35]
  ds_read_b128 v[80:83], v6 offset:57344
  v_mfma_f32_16x16x32_bf16 v[36:39], v[52:55], v[56:59], v[36:39]
  ds_read_b128 v[84:87], v6 offset:57856
  v_mfma_f32_16x16x32_bf16 v[40:43], v[48:51], v[60:63], v[40:43]
  ds_read_b128 v[88:91], v19 offset:0
  v_mfma_f32_16x16x32_bf16 v[44:47], v[52:55], v[60:63], v[44:47]
  ds_read_b128 v[92:95], v19 offset:1024
  s_waitcnt lgkmcnt(4)
  v_mfma_f32_16x16x32_bf16 v[32:35], v[64:67], v[72:75], v[32:35]
  ds_read_b128 v[48:51], v7 offset:57344
  v_mfma_f32_16x16x32_bf16 v[36:39], v[68:71], v[72:75], v[36:39]
  ds_read_b128 v[52:55], v7 offset:57856
  v_mfma_f32_16x16x32_bf16 v[40:43], v[64:67], v[76:79], v[40:43]
  ds_read_b128 v[56:59], v19 offset:7168
  v_mfma_f32_16x16x32_bf16 v[44:47], v[68:71], v[76:79], v[44:47]
  ds_read_b128 v[60:63], v19 offset:8192
  s_barrier
  s_waitcnt lgkmcnt(4)
  v_mfma_f32_16x16x32_bf16 v[32:35], v[80:83], v[88:91], v[32:35]
  ds_read_b128 v[64:67], v8 offset:0
  v_mfma_f32_16x16x32_bf16 v[36:39], v[84:87], v[88:91], v[36:39]
  ds_read_b128 v[68:71], v8 offset:512
  v_mfma_f32_16x16x32_bf16 v[40:43], v[80:83], v[92:95], v[40:43]
  ds_read_b128 v[72:75], v19 offset:14336
  v_mfma_f32_16x16x32_bf16 v[44:47], v[84:87], v[92:95], v[44:47]
  ds_read_b128 v[76:79], v19 offset:15360
  s_waitcnt lgkmcnt(4)
  v_mfma_f32_16x16x32_bf16 v[32:35], v[48:51], v[56:59], v[32:35]
  ds_read_b128 v[80:83], v9 offset:0
  v_mfma_f32_16x16x32_bf16 v[36:39], v[52:55], v[56:59], v[36:39]
  ds_read_b128 v[84:87], v9 offset:512
  v_mfma_f32_16x16x32_bf16 v[40:43], v[48:51], v[60:63], v[40:43]
  ds_read_b128 v[88:91], v19 offset:21504
  v_mfma_f32_16x16x32_bf16 v[44:47], v[52:55], v[60:63], v[44:47]
  ds_read_b128 v[92:95], v19 offset:22528
  s_barrier
  s_waitcnt lgkmcnt(4)
  v_mfma_f32_16x16x32_bf16 v[32:35], v[64:67], v[72:75], v[32:35]
  ds_read_b128 v[48:51], v8 offset:8192
  v_mfma_f32_16x16x32_bf16 v[36:39], v[68:71], v[72:75], v[36:39]
  ds_read_b128 v[52:55], v8 offset:8704
  v_mfma_f32_16x16x32_bf16 v[40:43], v[64:67], v[76:79], v[40:43]
  ds_read_b128 v[56:59], v19 offset:28672
  v_mfma_f32_16x16x32_bf16 v[44:47], v[68:71], v[76:79], v[44:47]
  ds_read_b128 v[60:63], v19 offset:29696
  s_waitcnt lgkmcnt(4)
  v_mfma_f32_16x16x32_bf16 v[32:35], v[80:83], v[88:91], v[32:35]
  ds_read_b128 v[64:67], v9 offset:8192
  v_mfma_f32_16x16x32_bf16 v[36:39], v[84:87], v[88:91], v[36:39]
  ds_read_b128 v[68:71], v9 offset:8704
  v_mfma_f32_16x16x32_bf16 v[40:43], v[80:83], v[92:95], v[40:43]
  ds_read_b128 v[72:75], v19 offset:35840
  v_mfma_f32_16x16x32_bf16 v[44:47], v[84:87], v[92:95], v[44:47]
  ds_read_b128 v[76:79], v19 offset:36864
  s_waitcnt lgkmcnt(4)
  v_mfma_f32_16x16x32_bf16 v[32:35], v[48:51], v[56:59], v[32:35]
  v_mfma_f32_16x16x32_bf16 v[36:39], v[52:55], v[56:59], v[36:39]
  v_mfma_f32_16x16x32_bf16 v[40:43], v[48:51], v[60:63], v[40:43]
  v_mfma_f32_16x16x32_bf16 v[44:47], v[52:55], v[60:63], v[44:47]
  s_waitcnt lgkmcnt(0)
  v_mfma_f32_16x16x32_bf16 v[32:35], v[64:67], v[72:75], v[32:35]
  v_mfma_f32_16x16x32_bf16 v[36:39], v[68:71], v[72:75], v[36:39]
  v_mfma_f32_16x16x32_bf16 v[40:43], v[64:67], v[76:79], v[40:43]
  v_mfma_f32_16x16x32_bf16 v[44:47], v[68:71], v[76:79], v[44:47]
  ds_read_b128 v[88:91], v24 offset:0
  ds_read_b128 v[92:95], v25 offset:0
  ds_read_b128 v[96:99], v24 offset:8192
  ds_read_b128 v[100:103], v25 offset:8192
  ds_read_b128 v[104:107], v24 offset:16384
  ds_read_b128 v[108:111], v25 offset:16384
  ds_read_b128 v[112:115], v24 offset:24576
  ds_read_b128 v[116:119], v25 offset:24576
  ds_read_b128 v[120:123], v24 offset:32768
  ds_read_b128 v[124:127], v25 offset:32768
  s_waitcnt lgkmcnt(4)
  ds_read_b128 v[128:131], v24 offset:40960
  ds_read_b128 v[132:135], v25 offset:40960
  ds_read_b128 v[136:139], v24 offset:49152
  ds_read_b128 v[140:143], v25 offset:49152
  ds_read_b128 v[144:147], v24 offset:57344
  ds_read_b128 v[148:151], v25 offset:57344
  ds_read_b128 v[152:155], v26 offset:0
  ds_read_b128 v[156:159], v27 offset:0
  ds_read_b128 v[160:163], v26 offset:8192
  ds_read_b128 v[164:167], v27 offset:8192
  s_waitcnt lgkmcnt(0)
  s_barrier
  v_mul_f32 v56, v32, v32
  v_mul_f32 v57, v33, v33
  v_mul_f32 v58, v34, v34
  v_mul_f32 v59, v35, v35
  v_mul_f32 v60, v36, v36
  v_mul_f32 v61, v37, v37
  v_mul_f32 v62, v38, v38
  v_mul_f32 v63, v39, v39
  v_mul_f32 v64, v40, v40
  v_mul_f32 v65, v41, v41
  v_mul_f32 v66, v42, v42
  v_mul_f32 v67, v43, v43
  v_mul_f32 v68, v44, v44
  v_mul_f32 v69, v45, v45
  v_mul_f32 v70, v46, v46
  v_mul_f32 v71, v47, v47
  v_fmaak_f32 v56, v56, v15, 0xc0135761
  v_fmaak_f32 v57, v57, v15, 0xc0135761
  v_fmaak_f32 v58, v58, v15, 0xc0135761
  v_fmaak_f32 v59, v59, v15, 0xc0135761
  v_fmaak_f32 v60, v60, v15, 0xc0135761
  v_fmaak_f32 v61, v61, v15, 0xc0135761
  v_fmaak_f32 v62, v62, v15, 0xc0135761
  v_fmaak_f32 v63, v63, v15, 0xc0135761
  v_fmaak_f32 v64, v64, v15, 0xc0135761
  v_fmaak_f32 v65, v65, v15, 0xc0135761
  v_fmaak_f32 v66, v66, v15, 0xc0135761
  v_fmaak_f32 v67, v67, v15, 0xc0135761
  v_fmaak_f32 v68, v68, v15, 0xc0135761
  v_fmaak_f32 v69, v69, v15, 0xc0135761
  v_fmaak_f32 v70, v70, v15, 0xc0135761
  v_fmaak_f32 v71, v71, v15, 0xc0135761
  v_mul_f32 v56, v56, v32
  v_mul_f32 v57, v57, v33
  v_mul_f32 v58, v58, v34
  v_mul_f32 v59, v59, v35
  v_mul_f32 v60, v60, v36
  v_mul_f32 v61, v61, v37
  v_mul_f32 v62, v62, v38
  v_mul_f32 v63, v63, v39
  v_mul_f32 v64, v64, v40
  v_mul_f32 v65, v65, v41
  v_mul_f32 v66, v66, v42
  v_mul_f32 v67, v67, v43
  v_mul_f32 v68, v68, v44
  v_mul_f32 v69, v69, v45
  v_mul_f32 v70, v70, v46
  v_mul_f32 v71, v71, v47
  v_exp_f32 v56, v56
  v_exp_f32 v57, v57
  v_exp_f32 v58, v58
  v_exp_f32 v59, v59
  v_exp_f32 v60, v60
  v_exp_f32 v61, v61
  v_exp_f32 v62, v62
  v_exp_f32 v63, v63
  v_exp_f32 v64, v64
  v_exp_f32 v65, v65
  v_exp_f32 v66, v66
  v_exp_f32 v67, v67
  v_exp_f32 v68, v68
  v_exp_f32 v69, v69
  v_exp_f32 v70, v70
  v_exp_f32 v71, v71
  v_add_f32 v56, 1.0, v56
  v_add_f32 v57, 1.0, v57
  v_add_f32 v58, 1.0, v58
  v_add_f32 v59, 1.0, v59
  v_add_f32 v60, 1.0, v60
  v_add_f32 v61, 1.0, v61
  v_add_f32 v62, 1.0, v62
  v_add_f32 v63, 1.0, v63
  v_add_f32 v64, 1.0, v64
  v_add_f32 v65, 1.0, v65
  v_add_f32 v66, 1.0, v66
  v_add_f32 v67, 1.0, v67
  v_add_f32 v68, 1.0, v68
  v_add_f32 v69, 1.0, v69
  v_add_f32 v70, 1.0, v70
  v_add_f32 v71, 1.0, v71
  v_rcp_f32 v56, v56
  v_rcp_f32 v57, v57
  v_rcp_f32 v58, v58
  v_rcp_f32 v59, v59
  v_rcp_f32 v60, v60
  v_rcp_f32 v61, v61
  v_rcp_f32 v62, v62
  v_rcp_f32 v63, v63
  v_rcp_f32 v64, v64
  v_rcp_f32 v65, v65
  v_rcp_f32 v66, v66
  v_rcp_f32 v67, v67
  v_rcp_f32 v68, v68
  v_rcp_f32 v69, v69
  v_rcp_f32 v70, v70
  v_rcp_f32 v71, v71
  v_mul_f32 v32, v32, v56
  v_mul_f32 v33, v33, v57
  v_mul_f32 v34, v34, v58
  v_mul_f32 v35, v35, v59
  v_mul_f32 v36, v36, v60
  v_mul_f32 v37, v37, v61
  v_mul_f32 v38, v38, v62
  v_mul_f32 v39, v39, v63
  v_mul_f32 v40, v40, v64
  v_mul_f32 v41, v41, v65
  v_mul_f32 v42, v42, v66
  v_mul_f32 v43, v43, v67
  v_mul_f32 v44, v44, v68
  v_mul_f32 v45, v45, v69
  v_mul_f32 v46, v46, v70
  v_mul_f32 v47, v47, v71
  v_cvt_pk_bf16_f32 v48, v32, v33
  v_cvt_pk_bf16_f32 v49, v34, v35
  v_cvt_pk_bf16_f32 v50, v36, v37
  v_cvt_pk_bf16_f32 v51, v38, v39
  buffer_store_dwordx4 v[48:51], v5, s[24:27], s22 offen offset:0 sc1
  v_cvt_pk_bf16_f32 v52, v40, v41
  v_cvt_pk_bf16_f32 v53, v42, v43
  v_cvt_pk_bf16_f32 v54, v44, v45
  v_cvt_pk_bf16_f32 v55, v46, v47
  buffer_store_dwordx4 v[52:55], v5, s[24:27], s22 offen offset:1024 sc1
  v_mul_f32 v73, v32, v32
  v_add_f32 v72, v32, v40
  v_fmac_f32 v73, v40, v40
  v_mul_f32 v75, v33, v33
  v_add_f32 v74, v33, v41
  v_fmac_f32 v75, v41, v41
  v_mul_f32 v77, v34, v34
  v_add_f32 v76, v34, v42
  v_fmac_f32 v77, v42, v42
  v_mul_f32 v79, v35, v35
  v_add_f32 v78, v35, v43
  v_fmac_f32 v79, v43, v43
  v_mul_f32 v81, v36, v36
  v_add_f32 v80, v36, v44
  v_fmac_f32 v81, v44, v44
  v_mul_f32 v83, v37, v37
  v_add_f32 v82, v37, v45
  v_fmac_f32 v83, v45, v45
  v_mul_f32 v85, v38, v38
  v_add_f32 v84, v38, v46
  v_fmac_f32 v85, v46, v46
  v_mul_f32 v87, v39, v39
  v_add_f32 v86, v39, v47
  v_fmac_f32 v87, v47, v47
  s_mov_b32 s40, 0xff00ff00
  s_mov_b32 s41, s40
  v_cndmask_b32 v56, v80, v72, s[40:41]
  v_cndmask_b32 v57, v81, v73, s[40:41]
  v_cndmask_b32 v58, v82, v74, s[40:41]
  v_cndmask_b32 v59, v83, v75, s[40:41]
  v_cndmask_b32 v60, v84, v76, s[40:41]
  v_cndmask_b32 v61, v85, v77, s[40:41]
  v_cndmask_b32 v62, v86, v78, s[40:41]
  v_cndmask_b32 v63, v87, v79, s[40:41]
  v_cndmask_b32 v72, v72, v80, s[40:41]
  v_cndmask_b32 v73, v73, v81, s[40:41]
  v_cndmask_b32 v74, v74, v82, s[40:41]
  v_cndmask_b32 v75, v75, v83, s[40:41]
  v_cndmask_b32 v76, v76, v84, s[40:41]
  v_cndmask_b32 v77, v77, v85, s[40:41]
  v_cndmask_b32 v78, v78, v86, s[40:41]
  v_cndmask_b32 v79, v79, v87, s[40:41]
  v_add_f32_dpp v72, v56, v72 row_ror:8 row_mask:0xf bank_mask:0xf
  v_add_f32_dpp v73, v57, v73 row_ror:8 row_mask:0xf bank_mask:0xf
  v_add_f32_dpp v74, v58, v74 row_ror:8 row_mask:0xf bank_mask:0xf
  v_add_f32_dpp v75, v59, v75 row_ror:8 row_mask:0xf bank_mask:0xf
  v_add_f32_dpp v76, v60, v76 row_ror:8 row_mask:0xf bank_mask:0xf
  v_add_f32_dpp v77, v61, v77 row_ror:8 row_mask:0xf bank_mask:0xf
  v_add_f32_dpp v78, v62, v78 row_ror:8 row_mask:0xf bank_mask:0xf
  v_add_f32_dpp v79, v63, v79 row_ror:8 row_mask:0xf bank_mask:0xf
  s_mov_b32 s40, 0xf0f0f0f0
  s_mov_b32 s41, s40
  v_cndmask_b32 v56, v76, v72, s[40:41]
  v_cndmask_b32 v57, v77, v73, s[40:41]
  v_cndmask_b32 v58, v78, v74, s[40:41]
  v_cndmask_b32 v59, v79, v75, s[40:41]
  v_cndmask_b32 v72, v72, v76, s[40:41]
  v_cndmask_b32 v73, v73, v77, s[40:41]
  v_cndmask_b32 v74, v74, v78, s[40:41]
  v_cndmask_b32 v75, v75, v79, s[40:41]
  v_add_f32_dpp v72, v56, v72 row_half_mirror row_mask:0xf bank_mask:0xf
  v_add_f32_dpp v73, v57, v73 row_half_mirror row_mask:0xf bank_mask:0xf
  v_add_f32_dpp v74, v58, v74 row_half_mirror row_mask:0xf bank_mask:0xf
  v_add_f32_dpp v75, v59, v75 row_half_mirror row_mask:0xf bank_mask:0xf
  s_mov_b32 s40, 0xcccccccc
  s_mov_b32 s41, s40
  v_cndmask_b32 v56, v74, v72, s[40:41]
  v_cndmask_b32 v57, v75, v73, s[40:41]
  v_cndmask_b32 v72, v72, v74, s[40:41]
  v_cndmask_b32 v73, v73, v75, s[40:41]
  s_nop 0
  v_add_f32_dpp v72, v56, v72 quad_perm:[2,3,0,1] row_mask:0xf bank_mask:0xf
  v_add_f32_dpp v73, v57, v73 quad_perm:[2,3,0,1] row_mask:0xf bank_mask:0xf
  s_mov_b32 s40, 0xaaaaaaaa
  s_mov_b32 s41, s40
  v_cndmask_b32 v56, v73, v72, s[40:41]
  v_cndmask_b32 v72, v72, v73, s[40:41]
  s_nop 1
  v_add_f32_dpp v72, v56, v72 quad_perm:[1,0,3,2] row_mask:0xf bank_mask:0xf
  v_lshlrev_b32 v2, 2, v1
  s_lshl_b32 s20, s20, 8
  buffer_atomic_add_f32 v72, v2, s[36:39], s20 offen
  s_branch Lad_z2d
Lad_z2b:
  s_barrier
  ds_read_b128 v[48:51], v6 offset:0
  ds_read_b128 v[52:55], v6 offset:512
  ds_read_b64_tr_b16 v[56:57], v12 offset:0
  ds_read_b64_tr_b16 v[58:59], v12 offset:3584
  ds_read_b128 v[64:67], v7 offset:0
  ds_read_b128 v[68:71], v7 offset:512
  ds_read_b64_tr_b16 v[72:73], v12 offset:7168
  ds_read_b64_tr_b16 v[74:75], v12 offset:10752
  s_barrier
  s_waitcnt lgkmcnt(4)
  v_mfma_f32_16x16x32_bf16 v[32:35], v[48:51], v[56:59], 0
  ds_read_b128 v[80:83], v6 offset:8192
  ds_read_b128 v[84:87], v6 offset:8704
  v_mfma_f32_16x16x32_bf16 v[36:39], v[52:55], v[56:59], 0
  ds_read_b64_tr_b16 v[88:89], v12 offset:14336
  ds_read_b64_tr_b16 v[90:91], v12 offset:17920
  s_waitcnt lgkmcnt(4)
  v_mfma_f32_16x16x32_bf16 v[32:35], v[64:67], v[72:75], v[32:35]
  ds_read_b128 v[48:51], v7 offset:8192
  ds_read_b128 v[52:55], v7 offset:8704
  v_mfma_f32_16x16x32_bf16 v[36:39], v[68:71], v[72:75], v[36:39]
  ds_read_b64_tr_b16 v[56:57], v12 offset:21504
  ds_read_b64_tr_b16 v[58:59], v12 offset:25088
  s_barrier
  s_waitcnt lgkmcnt(4)
  v_mfma_f32_16x16x32_bf16 v[32:35], v[80:83], v[88:91], v[32:35]
  ds_read_b128 v[64:67], v6 offset:16384
  ds_read_b128 v[68:71], v6 offset:16896
  v_mfma_f32_16x16x32_bf16 v[36:39], v[84:87], v[88:91], v[36:39]
  ds_read_b64_tr_b16 v[72:73], v13 offset:0
  ds_read_b64_tr_b16 v[74:75], v13 offset:3584
  s_waitcnt lgkmcnt(4)
  v_mfma_f32_16x16x32_bf16 v[32:35], v[48:51], v[56:59], v[32:35]
  ds_read_b128 v[80:83], v7 offset:16384
  ds_read_b128 v[84:87], v7 offset:16896
  v_mfma_f32_16x16x32_bf16 v[36:39], v[52:55], v[56:59], v[36:39]
  ds_read_b64_tr_b16 v[88:89], v13 offset:7168
  ds_read_b64_tr_b16 v[90:91], v13 offset:10752
  s_barrier
  s_waitcnt lgkmcnt(4)
  v_mfma_f32_16x16x32_bf16 v[32:35], v[64:67], v[72:75], v[32:35]
  ds_read_b128 v[48:51], v6 offset:24576
  ds_read_b128 v[52:55], v6 offset:25088
  v_mfma_f32_16x16x32_bf16 v[36:39], v[68:71], v[72:75], v[36:39]
  ds_read_b64_tr_b16 v[56:57], v13 offset:14336
  ds_read_b64_tr_b16 v[58:59], v13 offset:17920
  s_waitcnt lgkmcnt(4)
  v_mfma_f32_16x16x32_bf16 v[32:35], v[80:83], v[88:91], v[32:35]
  ds_read_b128 v[64:67], v7 offset:24576
  ds_read_b128 v[68:71], v7 offset:25088
  v_mfma_f32_16x16x32_bf16 v[36:39], v[84:87], v[88:91], v[36:39]
  ds_read_b64_tr_b16 v[72:73], v13 offset:21504
  ds_read_b64_tr_b16 v[74:75], v13 offset:25088
  s_barrier
  s_waitcnt lgkmcnt(4)
  v_mfma_f32_16x16x32_bf16 v[32:35], v[48:51], v[56:59], v[32:35]
  ds_read_b128 v[80:83], v6 offset:32768
  ds_read_b128 v[84:87], v6 offset:33280
  v_mfma_f32_16x16x32_bf16 v[36:39], v[52:55], v[56:59], v[36:39]
  ds_read_b64_tr_b16 v[88:89], v13 offset:28672
  ds_read_b64_tr_b16 v[90:91], v13 offset:32256
  s_waitcnt lgkmcnt(4)
  v_mfma_f32_16x16x32_bf16 v[32:35], v[64:67], v[72:75], v[32:35]
  ds_read_b128 v[48:51], v7 offset:32768
  ds_read_b128 v[52:55], v7 offset:33280
  v_mfma_f32_16x16x32_bf16 v[36:39], v[68:71], v[72:75], v[36:39]
  ds_read_b64_tr_b16 v[56:57], v13 offset:35840
  ds_read_b64_tr_b16 v[58:59], v13 offset:39424
  s_barrier
  s_waitcnt lgkmcnt(4)
  v_mfma_f32_16x16x32_bf16 v[32:35], v[80:83], v[88:91], v[32:35]
  ds_read_b128 v[64:67], v6 offset:40960
  ds_read_b128 v[68:71], v6 offset:41472
  v_mfma_f32_16x16x32_bf16 v[36:39], v[84:87], v[88:91], v[36:39]
  ds_read_b128 v[72:75], v18 offset:0
  s_waitcnt lgkmcnt(3)
  v_mfma_f32_16x16x32_bf16 v[32:35], v[48:51], v[56:59], v[32:35]
  ds_read_b128 v[80:83], v7 offset:40960
  ds_read_b128 v[84:87], v7 offset:41472
  v_mfma_f32_16x16x32_bf16 v[36:39], v[52:55], v[56:59], v[36:39]
  ds_read_b128 v[88:91], v18 offset:7168
  s_barrier
  s_waitcnt lgkmcnt(3)
  v_mfma_f32_16x16x32_bf16 v[32:35], v[64:67], v[72:75], v[32:35]
  ds_read_b128 v[48:51], v6 offset:49152
  ds_read_b128 v[52:55], v6 offset:49664
  v_mfma_f32_16x16x32_bf16 v[36:39], v[68:71], v[72:75], v[36:39]
  ds_read_b128 v[56:59], v18 offset:14336
  s_waitcnt lgkmcnt(3)
  v_mfma_f32_16x16x32_bf16 v[32:35], v[80:83], v[88:91], v[32:35]
  ds_read_b128 v[64:67], v7 offset:49152
  ds_read_b128 v[68:71], v7 offset:49664
  v_mfma_f32_16x16x32_bf16 v[36:39], v[84:87], v[88:91], v[36:39]
  ds_read_b128 v[72:75], v18 offset:21504
  s_barrier
  s_waitcnt lgkmcnt(3)
  v_mfma_f32_16x16x32_bf16 v[32:35], v[48:51], v[56:59], v[32:35]
  ds_read_b128 v[80:83], v6 offset:57344
  ds_read_b128 v[84:87], v6 offset:57856
  v_mfma_f32_16x16x32_bf16 v[36:39], v[52:55], v[56:59], v[36:39]
  ds_read_b128 v[88:91], v19 offset:0
  s_waitcnt lgkmcnt(3)
  v_mfma_f32_16x16x32_bf16 v[32:35], v[64:67], v[72:75], v[32:35]
  ds_read_b128 v[48:51], v7 offset:57344
  ds_read_b128 v[52:55], v7 offset:57856
  v_mfma_f32_16x16x32_bf16 v[36:39], v[68:71], v[72:75], v[36:39]
  ds_read_b128 v[56:59], v19 offset:7168
  s_barrier
  s_waitcnt lgkmcnt(3)
  v_mfma_f32_16x16x32_bf16 v[32:35], v[80:83], v[88:91], v[32:35]
  ds_read_b128 v[64:67], v8 offset:0
  ds_read_b128 v[68:71], v8 offset:512
  v_mfma_f32_16x16x32_bf16 v[36:39], v[84:87], v[88:91], v[36:39]
  ds_read_b128 v[72:75], v19 offset:14336
  s_waitcnt lgkmcnt(3)
  v_mfma_f32_16x16x32_bf16 v[32:35], v[48:51], v[56:59], v[32:35]
  ds_read_b128 v[80:83], v9 offset:0
  ds_read_b128 v[84:87], v9 offset:512
  v_mfma_f32_16x16x32_bf16 v[36:39], v[52:55], v[56:59], v[36:39]
  ds_read_b128 v[88:91], v19 offset:21504
  s_barrier
  s_waitcnt lgkmcnt(3)
  v_mfma_f32_16x16x32_bf16 v[32:35], v[64:67], v[72:75], v[32:35]
  ds_read_b128 v[48:51], v8 offset:8192
  ds_read_b128 v[52:55], v8 offset:8704
  v_mfma_f32_16x16x32_bf16 v[36:39], v[68:71], v[72:75], v[36:39]
  ds_read_b128 v[56:59], v19 offset:28672
  s_waitcnt lgkmcnt(3)
  v_mfma_f32_16x16x32_bf16 v[32:35], v[80:83], v[88:91], v[32:35]
  ds_read_b128 v[64:67], v9 offset:8192
  ds_read_b128 v[68:71], v9 offset:8704
  v_mfma_f32_16x16x32_bf16 v[36:39], v[84:87], v[88:91], v[36:39]
  ds_read_b128 v[72:75], v19 offset:35840
  s_waitcnt lgkmcnt(3)
  v_mfma_f32_16x16x32_bf16 v[32:35], v[48:51], v[56:59], v[32:35]
  v_mfma_f32_16x16x32_bf16 v[36:39], v[52:55], v[56:59], v[36:39]
  s_waitcnt lgkmcnt(0)
  v_mfma_f32_16x16x32_bf16 v[32:35], v[64:67], v[72:75], v[32:35]
  v_mfma_f32_16x16x32_bf16 v[36:39], v[68:71], v[72:75], v[36:39]
  ds_read_b128 v[88:91], v24 offset:0
  ds_read_b128 v[92:95], v25 offset:0
  ds_read_b128 v[96:99], v24 offset:8192
  ds_read_b128 v[100:103], v25 offset:8192
  ds_read_b128 v[104:107], v24 offset:16384
  ds_read_b128 v[108:111], v25 offset:16384
  ds_read_b128 v[112:115], v24 offset:24576
  ds_read_b128 v[116:119], v25 offset:24576
  ds_read_b128 v[120:123], v24 offset:32768
  ds_read_b128 v[124:127], v25 offset:32768
  s_waitcnt lgkmcnt(4)
  ds_read_b128 v[128:131], v24 offset:40960
  ds_read_b128 v[132:135], v25 offset:40960
  ds_read_b128 v[136:139], v24 offset:49152
  ds_read_b128 v[140:143], v25 offset:49152
  ds_read_b128 v[144:147], v24 offset:57344
  ds_read_b128 v[148:151], v25 offset:57344
  ds_read_b128 v[152:155], v26 offset:0
  ds_read_b128 v[156:159], v27 offset:0
  ds_read_b128 v[160:163], v26 offset:8192
  ds_read_b128 v[164:167], v27 offset:8192
  s_waitcnt lgkmcnt(0)
  s_barrier
  v_mul_f32 v56, v32, v32
  v_mul_f32 v57, v33, v33
  v_mul_f32 v58, v34, v34
  v_mul_f32 v59, v35, v35
  v_mul_f32 v60, v36, v36
  v_mul_f32 v61, v37, v37
  v_mul_f32 v62, v38, v38
  v_mul_f32 v63, v39, v39
  v_fmaak_f32 v56, v56, v15, 0xc0135761
  v_fmaak_f32 v57, v57, v15, 0xc0135761
  v_fmaak_f32 v58, v58, v15, 0xc0135761
  v_fmaak_f32 v59, v59, v15, 0xc0135761
  v_fmaak_f32 v60, v60, v15, 0xc0135761
  v_fmaak_f32 v61, v61, v15, 0xc0135761
  v_fmaak_f32 v62, v62, v15, 0xc0135761
  v_fmaak_f32 v63, v63, v15, 0xc0135761
  v_mul_f32 v56, v56, v32
  v_mul_f32 v57, v57, v33
  v_mul_f32 v58, v58, v34
  v_mul_f32 v59, v59, v35
  v_mul_f32 v60, v60, v36
  v_mul_f32 v61, v61, v37
  v_mul_f32 v62, v62, v38
  v_mul_f32 v63, v63, v39
  v_exp_f32 v56, v56
  v_exp_f32 v57, v57
  v_exp_f32 v58, v58
  v_exp_f32 v59, v59
  v_exp_f32 v60, v60
  v_exp_f32 v61, v61
  v_exp_f32 v62, v62
  v_exp_f32 v63, v63
  v_add_f32 v56, 1.0, v56
  v_add_f32 v57, 1.0, v57
  v_add_f32 v58, 1.0, v58
  v_add_f32 v59, 1.0, v59
  v_add_f32 v60, 1.0, v60
  v_add_f32 v61, 1.0, v61
  v_add_f32 v62, 1.0, v62
  v_add_f32 v63, 1.0, v63
  v_rcp_f32 v56, v56
  v_rcp_f32 v57, v57
  v_rcp_f32 v58, v58
  v_rcp_f32 v59, v59
  v_rcp_f32 v60, v60
  v_rcp_f32 v61, v61
  v_rcp_f32 v62, v62
  v_rcp_f32 v63, v63
  v_mul_f32 v32, v32, v56
  v_mul_f32 v33, v33, v57
  v_mul_f32 v34, v34, v58
  v_mul_f32 v35, v35, v59
  v_mul_f32 v36, v36, v60
  v_mul_f32 v37, v37, v61
  v_mul_f32 v38, v38, v62
  v_mul_f32 v39, v39, v63
  s_and_b32 s23, s19, 1
  s_cmp_eq_u32 s23, 1
  s_cselect_b32 s40, 0x00ff00ff, -1
  s_mov_b32 s41, s40
  v_cndmask_b32 v32, 0, v32, s[40:41]
  v_cndmask_b32 v33, 0, v33, s[40:41]
  v_cndmask_b32 v34, 0, v34, s[40:41]
  v_cndmask_b32 v35, 0, v35, s[40:41]
  v_cndmask_b32 v36, 0, v36, s[40:41]
  v_cndmask_b32 v37, 0, v37, s[40:41]
  v_cndmask_b32 v38, 0, v38, s[40:41]
  v_cndmask_b32 v39, 0, v39, s[40:41]
  v_cvt_pk_bf16_f32 v48, v32, v33
  v_cvt_pk_bf16_f32 v49, v34, v35
  v_cvt_pk_bf16_f32 v50, v36, v37
  v_cvt_pk_bf16_f32 v51, v38, v39
  buffer_store_dwordx4 v[48:51], v5, s[24:27], s22 offen offset:0 sc1
  v_mul_f32 v73, v32, v32
  v_mov_b32 v72, v32
  v_mul_f32 v75, v33, v33
  v_mov_b32 v74, v33
  v_mul_f32 v77, v34, v34
  v_mov_b32 v76, v34
  v_mul_f32 v79, v35, v35
  v_mov_b32 v78, v35
  v_mul_f32 v81, v36, v36
  v_mov_b32 v80, v36
  v_mul_f32 v83, v37, v37
  v_mov_b32 v82, v37
  v_mul_f32 v85, v38, v38
  v_mov_b32 v84, v38
  v_mul_f32 v87, v39, v39
  v_mov_b32 v86, v39
  s_mov_b32 s40, 0xff00ff00
  s_mov_b32 s41, s40
  v_cndmask_b32 v56, v80, v72, s[40:41]
  v_cndmask_b32 v57, v81, v73, s[40:41]
  v_cndmask_b32 v58, v82, v74, s[40:41]
  v_cndmask_b32 v59, v83, v75, s[40:41]
  v_cndmask_b32 v60, v84, v76, s[40:41]
  v_cndmask_b32 v61, v85, v77, s[40:41]
  v_cndmask_b32 v62, v86, v78, s[40:41]
  v_cndmask_b32 v63, v87, v79, s[40:41]
  v_cndmask_b32 v72, v72, v80, s[40:41]
  v_cndmask_b32 v73, v73, v81, s[40:41]
  v_cndmask_b32 v74, v74, v82, s[40:41]
  v_cndmask_b32 v75, v75, v83, s[40:41]
  v_cndmask_b32 v76, v76, v84, s[40:41]
  v_cndmask_b32 v77, v77, v85, s[40:41]
  v_cndmask_b32 v78, v78, v86, s[40:41]
  v_cndmask_b32 v79, v79, v87, s[40:41]
  v_add_f32_dpp v72, v56, v72 row_ror:8 row_mask:0xf bank_mask:0xf
  v_add_f32_dpp v73, v57, v73 row_ror:8 row_mask:0xf bank_mask:0xf
  v_add_f32_dpp v74, v58, v74 row_ror:8 row_mask:0xf bank_mask:0xf
  v_add_f32_dpp v75, v59, v75 row_ror:8 row_mask:0xf bank_mask:0xf
  v_add_f32_dpp v76, v60, v76 row_ror:8 row_mask:0xf bank_mask:0xf
  v_add_f32_dpp v77, v61, v77 row_ror:8 row_mask:0xf bank_mask:0xf
  v_add_f32_dpp v78, v62, v78 row_ror:8 row_mask:0xf bank_mask:0xf
  v_add_f32_dpp v79, v63, v79 row_ror:8 row_mask:0xf bank_mask:0xf
  s_mov_b32 s40, 0xf0f0f0f0
  s_mov_b32 s41, s40
  v_cndmask_b32 v56, v76, v72, s[40:41]
  v_cndmask_b32 v57, v77, v73, s[40:41]
  v_cndmask_b32 v58, v78, v74, s[40:41]
  v_cndmask_b32 v59, v79, v75, s[40:41]
  v_cndmask_b32 v72, v72, v76, s[40:41]
  v_cndmask_b32 v73, v73, v77, s[40:41]
  v_cndmask_b32 v74, v74, v78, s[40:41]
  v_cndmask_b32 v75, v75, v79, s[40:41]
  v_add_f32_dpp v72, v56, v72 row_half_mirror row_mask:0xf bank_mask:0xf
  v_add_f32_dpp v73, v57, v73 row_half_mirror row_mask:0xf bank_mask:0xf
  v_add_f32_dpp v74, v58, v74 row_half_mirror row_mask:0xf bank_mask:0xf
  v_add_f32_dpp v75, v59, v75 row_half_mirror row_mask:0xf bank_mask:0xf
  s_mov_b32 s40, 0xcccccccc
  s_mov_b32 s41, s40
  v_cndmask_b32 v56, v74, v72, s[40:41]
  v_cndmask_b32 v57, v75, v73, s[40:41]
  v_cndmask_b32 v72, v72, v74, s[40:41]
  v_cndmask_b32 v73, v73, v75, s[40:41]
  s_nop 0
  v_add_f32_dpp v72, v56, v72 quad_perm:[2,3,0,1] row_mask:0xf bank_mask:0xf
  v_add_f32_dpp v73, v57, v73 quad_perm:[2,3,0,1] row_mask:0xf bank_mask:0xf
  s_mov_b32 s40, 0xaaaaaaaa
  s_mov_b32 s41, s40
  v_cndmask_b32 v56, v73, v72, s[40:41]
  v_cndmask_b32 v72, v72, v73, s[40:41]
  s_nop 1
  v_add_f32_dpp v72, v56, v72 quad_perm:[1,0,3,2] row_mask:0xf bank_mask:0xf
  v_lshlrev_b32 v2, 2, v1
  s_lshl_b32 s20, s20, 8
  buffer_atomic_add_f32 v72, v2, s[36:39], s20 offen
Lad_z2d:
  s_lshr_b32 s23, s3, 2
  s_lshl_b32 s23, s23, 12
  v_add_u32 v18, s23, v5
  v_add_u32 v19, 114688, v18
  s_and_b32 s23, s3, 3
  s_lshl_b32 s23, s23, 12
  s_add_u32 s23, s23, 114688
  v_add_u32 v23, s23, v5
  v_add_u32 v12, 32768, v18
  v_add_u32 v13, 90112, v18
  s_barrier
  s_cmp_ge_u32 s3, 4
  s_cbranch_scc1 Lad_z1b
  ds_read_b128 v[48:51], v18 offset:0
  ds_read_b128 v[52:55], v18 offset:1024
  ds_read_b128 v[56:59], v18 offset:2048
  ds_read_b128 v[60:63], v18 offset:3072
  s_waitcnt lgkmcnt(3)
  v_mfma_f32_16x16x32_bf16 v[32:35], v[48:51], v[88:91], 0
  ds_read_b128 v[64:67], v18 offset:7168
  s_waitcnt lgkmcnt(3)
  v_mfma_f32_16x16x32_bf16 v[36:39], v[52:55], v[88:91], 0
  ds_read_b128 v[68:71], v18 offset:8192
  s_waitcnt lgkmcnt(3)
  v_mfma_f32_16x16x32_bf16 v[40:43], v[56:59], v[88:91], 0
  ds_read_b128 v[72:75], v18 offset:9216
  s_waitcnt lgkmcnt(3)
  v_mfma_f32_16x16x32_bf16 v[44:47], v[60:63], v[88:91], 0
  ds_read_b128 v[76:79], v18 offset:10240
  s_waitcnt lgkmcnt(3)
  v_mfma_f32_16x16x32_bf16 v[32:35], v[64:67], v[92:95], v[32:35]
  ds_read_b128 v[48:51], v18 offset:14336
  s_waitcnt lgkmcnt(3)
  v_mfma_f32_16x16x32_bf16 v[36:39], v[68:71], v[92:95], v[36:39]
  ds_read_b128 v[52:55], v18 offset:15360
  s_waitcnt lgkmcnt(3)
  v_mfma_f32_16x16x32_bf16 v[40:43], v[72:75], v[92:95], v[40:43]
  ds_read_b128 v[56:59], v18 offset:16384
  s_waitcnt lgkmcnt(3)
  v_mfma_f32_16x16x32_bf16 v[44:47], v[76:79], v[92:95], v[44:47]
  ds_read_b128 v[60:63], v18 offset:17408
  s_waitcnt lgkmcnt(3)
  v_mfma_f32_16x16x32_bf16 v[32:35], v[48:51], v[96:99], v[32:35]
  ds_read_b128 v[64:67], v18 offset:21504
  s_waitcnt lgkmcnt(3)
  v_mfma_f32_16x16x32_bf16 v[36:39], v[52:55], v[96:99], v[36:39]
  ds_read_b128 v[68:71], v18 offset:22528
  s_waitcnt lgkmcnt(3)
  v_mfma_f32_16x16x32_bf16 v[40:43], v[56:59], v[96:99], v[40:43]
  ds_read_b128 v[72:75], v18 offset:23552
  s_waitcnt lgkmcnt(3)
  v_mfma_f32_16x16x32_bf16 v[44:47], v[60:63], v[96:99], v[44:47]
  ds_read_b128 v[76:79], v18 offset:24576
  s_waitcnt lgkmcnt(3)
  v_mfma_f32_16x16x32_bf16 v[32:35], v[64:67], v[100:103], v[32:35]
  ds_read_b128 v[48:51], v19 offset:0
  s_waitcnt lgkmcnt(3)
  v_mfma_f32_16x16x32_bf16 v[36:39], v[68:71], v[100:103], v[36:39]
  ds_read_b128 v[52:55], v19 offset:1024
  s_waitcnt lgkmcnt(3)
  v_mfma_f32_16x16x32_bf16 v[40:43], v[72:75], v[100:103], v[40:43]
  ds_read_b128 v[56:59], v19 offset:2048
  s_waitcnt lgkmcnt(3)
  v_mfma_f32_16x16x32_bf16 v[44:47], v[76:79], v[100:103], v[44:47]
  ds_read_b128 v[60:63], v19 offset:3072
  s_waitcnt lgkmcnt(3)
  v_mfma_f32_16x16x32_bf16 v[32:35], v[48:51], v[104:107], v[32:35]
  ds_read_b128 v[64:67], v19 offset:7168
  s_waitcnt lgkmcnt(3)
  v_mfma_f32_16x16x32_bf16 v[36:39], v[52:55], v[104:107], v[36:39]
  ds_read_b128 v[68:71], v19 offset:8192
  s_waitcnt lgkmcnt(3)
  v_mfma_f32_16x16x32_bf16 v[40:43], v[56:59], v[104:107], v[40:43]
  ds_read_b128 v[72:75], v19 offset:9216
  s_waitcnt lgkmcnt(3)
  v_mfma_f32_16x16x32_bf16 v[44:47], v[60:63], v[104:107], v[44:47]
  ds_read_b128 v[76:79], v19 offset:10240
  s_waitcnt vmcnt(0)
  s_barrier
  s_mov_b32 s54, 0
  s_mov_b32 s55, 40960
  s_cmp_lg_u32 s3, 0
  s_cbranch_scc1 Lad_h3s
  s_mov_b64 exec, 0xff
  buffer_atomic_add v22, v20, s[28:31], s55 offen sc1
  s_mov_b64 exec, -1
Lad_h3s:
  s_waitcnt lgkmcnt(3)
  v_mfma_f32_16x16x32_bf16 v[32:35], v[64:67], v[108:111], v[32:35]
  ds_read_b128 v[48:51], v19 offset:14336
  s_waitcnt lgkmcnt(3)
  v_mfma_f32_16x16x32_bf16 v[36:39], v[68:71], v[108:111], v[36:39]
  ds_read_b128 v[52:55], v19 offset:15360
  s_waitcnt lgkmcnt(3)
  v_mfma_f32_16x16x32_bf16 v[40:43], v[72:75], v[108:111], v[40:43]
  ds_read_b128 v[56:59], v19 offset:16384
  s_waitcnt lgkmcnt(3)
  v_mfma_f32_16x16x32_bf16 v[44:47], v[76:79], v[108:111], v[44:47]
  ds_read_b128 v[60:63], v19 offset:17408
  s_waitcnt lgkmcnt(3)
  v_mfma_f32_16x16x32_bf16 v[32:35], v[48:51], v[112:115], v[32:35]
  ds_read_b128 v[64:67], v19 offset:21504
  s_waitcnt lgkmcnt(3)
  v_mfma_f32_16x16x32_bf16 v[36:39], v[52:55], v[112:115], v[36:39]
  ds_read_b128 v[68:71], v19 offset:22528
  s_waitcnt lgkmcnt(3)
  v_mfma_f32_16x16x32_bf16 v[40:43], v[56:59], v[112:115], v[40:43]
  ds_read_b128 v[72:75], v19 offset:23552
  s_waitcnt lgkmcnt(3)
  v_mfma_f32_16x16x32_bf16 v[44:47], v[60:63], v[112:115], v[44:47]
  ds_read_b128 v[76:79], v19 offset:24576
  s_waitcnt lgkmcnt(3)
  v_mfma_f32_16x16x32_bf16 v[32:35], v[64:67], v[116:119], v[32:35]
  ds_read_b128 v[48:51], v19 offset:28672
  s_waitcnt lgkmcnt(3)
  v_mfma_f32_16x16x32_bf16 v[36:39], v[68:71], v[116:119], v[36:39]
  ds_read_b128 v[52:55], v19 offset:29696
  s_waitcnt lgkmcnt(3)
  v_mfma_f32_16x16x32_bf16 v[40:43], v[72:75], v[116:119], v[40:43]
  ds_read_b128 v[56:59], v19 offset:30720
  s_waitcnt lgkmcnt(3)
  v_mfma_f32_16x16x32_bf16 v[44:47], v[76:79], v[116:119], v[44:47]
  ds_read_b128 v[60:63], v19 offset:31744
  s_waitcnt lgkmcnt(3)
  v_mfma_f32_16x16x32_bf16 v[32:35], v[48:51], v[120:123], v[32:35]
  ds_read_b128 v[64:67], v19 offset:35840
  s_waitcnt lgkmcnt(3)
  v_mfma_f32_16x16x32_bf16 v[36:39], v[52:55], v[120:123], v[36:39]
  ds_read_b128 v[68:71], v19 offset:36864
  s_waitcnt lgkmcnt(3)
  v_mfma_f32_16x16x32_bf16 v[40:43], v[56:59], v[120:123], v[40:43]
  ds_read_b128 v[72:75], v19 offset:37888
  s_waitcnt lgkmcnt(3)
  v_mfma_f32_16x16x32_bf16 v[44:47], v[60:63], v[120:123], v[44:47]
  ds_read_b128 v[76:79], v19 offset:38912
  s_waitcnt lgkmcnt(3)
  v_mfma_f32_16x16x32_bf16 v[32:35], v[64:67], v[124:127], v[32:35]
  ds_read_b128 v[48:51], v12 offset:0
  s_waitcnt lgkmcnt(3)
  v_mfma_f32_16x16x32_bf16 v[36:39], v[68:71], v[124:127], v[36:39]
  ds_read_b128 v[52:55], v12 offset:1024
  s_waitcnt lgkmcnt(3)
  v_mfma_f32_16x16x32_bf16 v[40:43], v[72:75], v[124:127], v[40:43]
  ds_read_b128 v[56:59], v12 offset:2048
  s_waitcnt lgkmcnt(3)
  v_mfma_f32_16x16x32_bf16 v[44:47], v[76:79], v[124:127], v[44:47]
  ds_read_b128 v[60:63], v12 offset:3072
  s_waitcnt lgkmcnt(3)
  v_mfma_f32_16x16x32_bf16 v[32:35], v[48:51], v[128:131], v[32:35]
  ds_read_b128 v[64:67], v12 offset:7168
  s_waitcnt lgkmcnt(3)
  v_mfma_f32_16x16x32_bf16 v[36:39], v[52:55], v[128:131], v[36:39]
  ds_read_b128 v[68:71], v12 offset:8192
  s_waitcnt lgkmcnt(3)
  v_mfma_f32_16x16x32_bf16 v[40:43], v[56:59], v[128:131], v[40:43]
  ds_read_b128 v[72:75], v12 offset:9216
  s_waitcnt lgkmcnt(3)
  v_mfma_f32_16x16x32_bf16 v[44:47], v[60:63], v[128:131], v[44:47]
  ds_read_b128 v[76:79], v12 offset:10240
  s_barrier
  s_waitcnt lgkmcnt(3)
  v_mfma_f32_16x16x32_bf16 v[32:35], v[64:67], v[132:135], v[32:35]
  ds_read_b128 v[48:51], v12 offset:14336
  s_waitcnt lgkmcnt(3)
  v_mfma_f32_16x16x32_bf16 v[36:39], v[68:71], v[132:135], v[36:39]
  ds_read_b128 v[52:55], v12 offset:15360
  s_waitcnt lgkmcnt(3)
  v_mfma_f32_16x16x32_bf16 v[40:43], v[72:75], v[132:135], v[40:43]
  ds_read_b128 v[56:59], v12 offset:16384
  s_waitcnt lgkmcnt(3)
  v_mfma_f32_16x16x32_bf16 v[44:47], v[76:79], v[132:135], v[44:47]
  ds_read_b128 v[60:63], v12 offset:17408
  s_waitcnt lgkmcnt(3)
  v_mfma_f32_16x16x32_bf16 v[32:35], v[48:51], v[136:139], v[32:35]
  ds_read_b128 v[64:67], v12 offset:21504
  s_waitcnt lgkmcnt(3)
  v_mfma_f32_16x16x32_bf16 v[36:39], v[52:55], v[136:139], v[36:39]
  ds_read_b128 v[68:71], v12 offset:22528
  s_waitcnt lgkmcnt(3)
  v_mfma_f32_16x16x32_bf16 v[40:43], v[56:59], v[136:139], v[40:43]
  ds_read_b128 v[72:75], v12 offset:23552
  s_waitcnt lgkmcnt(3)
  v_mfma_f32_16x16x32_bf16 v[44:47], v[60:63], v[136:139], v[44:47]
  ds_read_b128 v[76:79], v12 offset:24576
  s_waitcnt lgkmcnt(3)
  v_mfma_f32_16x16x32_bf16 v[32:35], v[64:67], v[140:143], v[32:35]
  ds_read_b128 v[48:51], v12 offset:28672
  s_waitcnt lgkmcnt(3)
  v_mfma_f32_16x16x32_bf16 v[36:39], v[68:71], v[140:143], v[36:39]
  ds_read_b128 v[52:55], v12 offset:29696
  s_waitcnt lgkmcnt(3)
  v_mfma_f32_16x16x32_bf16 v[40:43], v[72:75], v[140:143], v[40:43]
  ds_read_b128 v[56:59], v12 offset:30720
  s_waitcnt lgkmcnt(3)
  v_mfma_f32_16x16x32_bf16 v[44:47], v[76:79], v[140:143], v[44:47]
  ds_read_b128 v[60:63], v12 offset:31744
  s_waitcnt lgkmcnt(3)
  v_mfma_f32_16x16x32_bf16 v[32:35], v[48:51], v[144:147], v[32:35]
  ds_read_b128 v[64:67], v12 offset:35840
  s_waitcnt lgkmcnt(3)
  v_mfma_f32_16x16x32_bf16 v[36:39], v[52:55], v[144:147], v[36:39]
  ds_read_b128 v[68:71], v12 offset:36864
  s_waitcnt lgkmcnt(3)
  v_mfma_f32_16x16x32_bf16 v[40:43], v[56:59], v[144:147], v[40:43]
  ds_read_b128 v[72:75], v12 offset:37888
  s_waitcnt lgkmcnt(3)
  v_mfma_f32_16x16x32_bf16 v[44:47], v[60:63], v[144:147], v[44:47]
  ds_read_b128 v[76:79], v12 offset:38912
  s_waitcnt lgkmcnt(3)
  v_mfma_f32_16x16x32_bf16 v[32:35], v[64:67], v[148:151], v[32:35]
  ds_read_b128 v[48:51], v12 offset:43008
  s_waitcnt lgkmcnt(3)
  v_mfma_f32_16x16x32_bf16 v[36:39], v[68:71], v[148:151], v[36:39]
  ds_read_b128 v[52:55], v12 offset:44032
  s_waitcnt lgkmcnt(3)
  v_mfma_f32_16x16x32_bf16 v[40:43], v[72:75], v[148:151], v[40:43]
  ds_read_b128 v[56:59], v12 offset:45056
  s_waitcnt lgkmcnt(3)
  v_mfma_f32_16x16x32_bf16 v[44:47], v[76:79], v[148:151], v[44:47]
  ds_read_b128 v[60:63], v12 offset:46080
  s_waitcnt lgkmcnt(3)
  v_mfma_f32_16x16x32_bf16 v[32:35], v[48:51], v[152:155], v[32:35]
  ds_read_b128 v[64:67], v12 offset:50176
  s_waitcnt lgkmcnt(3)
  v_mfma_f32_16x16x32_bf16 v[36:39], v[52:55], v[152:155], v[36:39]
  ds_read_b128 v[68:71], v12 offset:51200
  s_waitcnt lgkmcnt(3)
  v_mfma_f32_16x16x32_bf16 v[40:43], v[56:59], v[152:155], v[40:43]
  ds_read_b128 v[72:75], v12 offset:52224
  s_waitcnt lgkmcnt(3)
  v_mfma_f32_16x16x32_bf16 v[44:47], v[60:63], v[152:155], v[44:47]
  ds_read_b128 v[76:79], v12 offset:53248
  s_waitcnt lgkmcnt(3)
  v_mfma_f32_16x16x32_bf16 v[32:35], v[64:67], v[156:159], v[32:35]
  ds_read_b128 v[48:51], v13 offset:0
  s_waitcnt lgkmcnt(3)
  v_mfma_f32_16x16x32_bf16 v[36:39], v[68:71], v[156:159], v[36:39]
  ds_read_b128 v[52:55], v13 offset:1024
  s_waitcnt lgkmcnt(3)
  v_mfma_f32_16x16x32_bf16 v[40:43], v[72:75], v[156:159], v[40:43]
  ds_read_b128 v[56:59], v13 offset:2048
  s_waitcnt lgkmcnt(3)
  v_mfma_f32_16x16x32_bf16 v[44:47], v[76:79], v[156:159], v[44:47]
  ds_read_b128 v[60:63], v13 offset:3072
  s_waitcnt lgkmcnt(3)
  v_mfma_f32_16x16x32_bf16 v[32:35], v[48:51], v[160:163], v[32:35]
  ds_read_b128 v[64:67], v13 offset:7168
  s_waitcnt lgkmcnt(3)
  v_mfma_f32_16x16x32_bf16 v[36:39], v[52:55], v[160:163], v[36:39]
  ds_read_b128 v[68:71], v13 offset:8192
  s_waitcnt lgkmcnt(3)
  v_mfma_f32_16x16x32_bf16 v[40:43], v[56:59], v[160:163], v[40:43]
  ds_read_b128 v[72:75], v13 offset:9216
  s_waitcnt lgkmcnt(3)
  v_mfma_f32_16x16x32_bf16 v[44:47], v[60:63], v[160:163], v[44:47]
  ds_read_b128 v[76:79], v13 offset:10240
  s_waitcnt lgkmcnt(3)
  v_mfma_f32_16x16x32_bf16 v[32:35], v[64:67], v[164:167], v[32:35]
  s_waitcnt lgkmcnt(2)
  v_mfma_f32_16x16x32_bf16 v[36:39], v[68:71], v[164:167], v[36:39]
  s_waitcnt lgkmcnt(1)
  v_mfma_f32_16x16x32_bf16 v[40:43], v[72:75], v[164:167], v[40:43]
  s_waitcnt lgkmcnt(0)
  v_mfma_f32_16x16x32_bf16 v[44:47], v[76:79], v[164:167], v[44:47]
  s_nop 1
  ds_write_b128 v23, v[32:35] offset:0
  s_nop 0
  ds_write_b128 v23, v[36:39] offset:1024
  s_nop 0
  ds_write_b128 v23, v[40:43] offset:2048
  s_nop 0
  ds_write_b128 v23, v[44:47] offset:3072
  s_waitcnt lgkmcnt(0)
  s_barrier
  s_branch Lad_z1d
Lad_z1b:
  ds_read_b128 v[48:51], v18 offset:0
  ds_read_b128 v[52:55], v18 offset:1024
  ds_read_b128 v[56:59], v18 offset:2048
  s_waitcnt lgkmcnt(2)
  v_mfma_f32_16x16x32_bf16 v[32:35], v[48:51], v[88:91], 0
  ds_read_b128 v[64:67], v18 offset:7168
  s_waitcnt lgkmcnt(2)
  v_mfma_f32_16x16x32_bf16 v[36:39], v[52:55], v[88:91], 0
  ds_read_b128 v[68:71], v18 offset:8192
  s_waitcnt lgkmcnt(2)
  v_mfma_f32_16x16x32_bf16 v[40:43], v[56:59], v[88:91], 0
  ds_read_b128 v[72:75], v18 offset:9216
  s_waitcnt lgkmcnt(2)
  v_mfma_f32_16x16x32_bf16 v[32:35], v[64:67], v[92:95], v[32:35]
  ds_read_b128 v[48:51], v18 offset:14336
  s_waitcnt lgkmcnt(2)
  v_mfma_f32_16x16x32_bf16 v[36:39], v[68:71], v[92:95], v[36:39]
  ds_read_b128 v[52:55], v18 offset:15360
  s_waitcnt lgkmcnt(2)
  v_mfma_f32_16x16x32_bf16 v[40:43], v[72:75], v[92:95], v[40:43]
  ds_read_b128 v[56:59], v18 offset:16384
  s_waitcnt lgkmcnt(2)
  v_mfma_f32_16x16x32_bf16 v[32:35], v[48:51], v[96:99], v[32:35]
  ds_read_b128 v[64:67], v18 offset:21504
  s_waitcnt lgkmcnt(2)
  v_mfma_f32_16x16x32_bf16 v[36:39], v[52:55], v[96:99], v[36:39]
  ds_read_b128 v[68:71], v18 offset:22528
  s_waitcnt lgkmcnt(2)
  v_mfma_f32_16x16x32_bf16 v[40:43], v[56:59], v[96:99], v[40:43]
  ds_read_b128 v[72:75], v18 offset:23552
  s_waitcnt lgkmcnt(2)
  v_mfma_f32_16x16x32_bf16 v[32:35], v[64:67], v[100:103], v[32:35]
  ds_read_b128 v[48:51], v19 offset:0
  s_waitcnt lgkmcnt(2)
  v_mfma_f32_16x16x32_bf16 v[36:39], v[68:71], v[100:103], v[36:39]
  ds_read_b128 v[52:55], v19 offset:1024
  s_waitcnt lgkmcnt(2)
  v_mfma_f32_16x16x32_bf16 v[40:43], v[72:75], v[100:103], v[40:43]
  ds_read_b128 v[56:59], v19 offset:2048
  s_waitcnt lgkmcnt(2)
  v_mfma_f32_16x16x32_bf16 v[32:35], v[48:51], v[104:107], v[32:35]
  ds_read_b128 v[64:67], v19 offset:7168
  s_waitcnt lgkmcnt(2)
  v_mfma_f32_16x16x32_bf16 v[36:39], v[52:55], v[104:107], v[36:39]
  ds_read_b128 v[68:71], v19 offset:8192
  s_waitcnt lgkmcnt(2)
  v_mfma_f32_16x16x32_bf16 v[40:43], v[56:59], v[104:107], v[40:43]
  ds_read_b128 v[72:75], v19 offset:9216
  s_waitcnt vmcnt(0)
  s_barrier
  s_mov_b32 s54, 0
  s_mov_b32 s55, 40960
  s_waitcnt lgkmcnt(2)
  v_mfma_f32_16x16x32_bf16 v[32:35], v[64:67], v[108:111], v[32:35]
  ds_read_b128 v[48:51], v19 offset:14336
  s_waitcnt lgkmcnt(2)
  v_mfma_f32_16x16x32_bf16 v[36:39], v[68:71], v[108:111], v[36:39]
  ds_read_b128 v[52:55], v19 offset:15360
  s_waitcnt lgkmcnt(2)
  v_mfma_f32_16x16x32_bf16 v[40:43], v[72:75], v[108:111], v[40:43]
  ds_read_b128 v[56:59], v19 offset:16384
  s_waitcnt lgkmcnt(2)
  v_mfma_f32_16x16x32_bf16 v[32:35], v[48:51], v[112:115], v[32:35]
  ds_read_b128 v[64:67], v19 offset:21504
  s_waitcnt lgkmcnt(2)
  v_mfma_f32_16x16x32_bf16 v[36:39], v[52:55], v[112:115], v[36:39]
  ds_read_b128 v[68:71], v19 offset:22528
  s_waitcnt lgkmcnt(2)
  v_mfma_f32_16x16x32_bf16 v[40:43], v[56:59], v[112:115], v[40:43]
  ds_read_b128 v[72:75], v19 offset:23552
  s_waitcnt lgkmcnt(2)
  v_mfma_f32_16x16x32_bf16 v[32:35], v[64:67], v[116:119], v[32:35]
  ds_read_b128 v[48:51], v19 offset:28672
  s_waitcnt lgkmcnt(2)
  v_mfma_f32_16x16x32_bf16 v[36:39], v[68:71], v[116:119], v[36:39]
  ds_read_b128 v[52:55], v19 offset:29696
  s_waitcnt lgkmcnt(2)
  v_mfma_f32_16x16x32_bf16 v[40:43], v[72:75], v[116:119], v[40:43]
  ds_read_b128 v[56:59], v19 offset:30720
  s_waitcnt lgkmcnt(2)
  v_mfma_f32_16x16x32_bf16 v[32:35], v[48:51], v[120:123], v[32:35]
  ds_read_b128 v[64:67], v19 offset:35840
  s_waitcnt lgkmcnt(2)
  v_mfma_f32_16x16x32_bf16 v[36:39], v[52:55], v[120:123], v[36:39]
  ds_read_b128 v[68:71], v19 offset:36864
  s_waitcnt lgkmcnt(2)
  v_mfma_f32_16x16x32_bf16 v[40:43], v[56:59], v[120:123], v[40:43]
  ds_read_b128 v[72:75], v19 offset:37888
  s_waitcnt lgkmcnt(2)
  v_mfma_f32_16x16x32_bf16 v[32:35], v[64:67], v[124:127], v[32:35]
  ds_read_b128 v[48:51], v12 offset:0
  s_waitcnt lgkmcnt(2)
  v_mfma_f32_16x16x32_bf16 v[36:39], v[68:71], v[124:127], v[36:39]
  ds_read_b128 v[52:55], v12 offset:1024
  s_waitcnt lgkmcnt(2)
  v_mfma_f32_16x16x32_bf16 v[40:43], v[72:75], v[124:127], v[40:43]
  ds_read_b128 v[56:59], v12 offset:2048
  s_waitcnt lgkmcnt(2)
  v_mfma_f32_16x16x32_bf16 v[32:35], v[48:51], v[128:131], v[32:35]
  ds_read_b128 v[64:67], v12 offset:7168
  s_waitcnt lgkmcnt(2)
  v_mfma_f32_16x16x32_bf16 v[36:39], v[52:55], v[128:131], v[36:39]
  ds_read_b128 v[68:71], v12 offset:8192
  s_waitcnt lgkmcnt(2)
  v_mfma_f32_16x16x32_bf16 v[40:43], v[56:59], v[128:131], v[40:43]
  ds_read_b128 v[72:75], v12 offset:9216
  s_barrier
  s_waitcnt lgkmcnt(2)
  v_mfma_f32_16x16x32_bf16 v[32:35], v[64:67], v[132:135], v[32:35]
  ds_read_b128 v[48:51], v12 offset:14336
  s_waitcnt lgkmcnt(2)
  v_mfma_f32_16x16x32_bf16 v[36:39], v[68:71], v[132:135], v[36:39]
  ds_read_b128 v[52:55], v12 offset:15360
  s_waitcnt lgkmcnt(2)
  v_mfma_f32_16x16x32_bf16 v[40:43], v[72:75], v[132:135], v[40:43]
  ds_read_b128 v[56:59], v12 offset:16384
  s_waitcnt lgkmcnt(2)
  v_mfma_f32_16x16x32_bf16 v[32:35], v[48:51], v[136:139], v[32:35]
  ds_read_b128 v[64:67], v12 offset:21504
  s_waitcnt lgkmcnt(2)
  v_mfma_f32_16x16x32_bf16 v[36:39], v[52:55], v[136:139], v[36:39]
  ds_read_b128 v[68:71], v12 offset:22528
  s_waitcnt lgkmcnt(2)
  v_mfma_f32_16x16x32_bf16 v[40:43], v[56:59], v[136:139], v[40:43]
  ds_read_b128 v[72:75], v12 offset:23552
  s_waitcnt lgkmcnt(2)
  v_mfma_f32_16x16x32_bf16 v[32:35], v[64:67], v[140:143], v[32:35]
  ds_read_b128 v[48:51], v12 offset:28672
  s_waitcnt lgkmcnt(2)
  v_mfma_f32_16x16x32_bf16 v[36:39], v[68:71], v[140:143], v[36:39]
  ds_read_b128 v[52:55], v12 offset:29696
  s_waitcnt lgkmcnt(2)
  v_mfma_f32_16x16x32_bf16 v[40:43], v[72:75], v[140:143], v[40:43]
  ds_read_b128 v[56:59], v12 offset:30720
  s_waitcnt lgkmcnt(2)
  v_mfma_f32_16x16x32_bf16 v[32:35], v[48:51], v[144:147], v[32:35]
  ds_read_b128 v[64:67], v12 offset:35840
  s_waitcnt lgkmcnt(2)
  v_mfma_f32_16x16x32_bf16 v[36:39], v[52:55], v[144:147], v[36:39]
  ds_read_b128 v[68:71], v12 offset:36864
  s_waitcnt lgkmcnt(2)
  v_mfma_f32_16x16x32_bf16 v[40:43], v[56:59], v[144:147], v[40:43]
  ds_read_b128 v[72:75], v12 offset:37888
  s_waitcnt lgkmcnt(2)
  v_mfma_f32_16x16x32_bf16 v[32:35], v[64:67], v[148:151], v[32:35]
  ds_read_b128 v[48:51], v12 offset:43008
  s_waitcnt lgkmcnt(2)
  v_mfma_f32_16x16x32_bf16 v[36:39], v[68:71], v[148:151], v[36:39]
  ds_read_b128 v[52:55], v12 offset:44032
  s_waitcnt lgkmcnt(2)
  v_mfma_f32_16x16x32_bf16 v[40:43], v[72:75], v[148:151], v[40:43]
  ds_read_b128 v[56:59], v12 offset:45056
  s_waitcnt lgkmcnt(2)
  v_mfma_f32_16x16x32_bf16 v[32:35], v[48:51], v[152:155], v[32:35]
  ds_read_b128 v[64:67], v12 offset:50176
  s_waitcnt lgkmcnt(2)
  v_mfma_f32_16x16x32_bf16 v[36:39], v[52:55], v[152:155], v[36:39]
  ds_read_b128 v[68:71], v12 offset:51200
  s_waitcnt lgkmcnt(2)
  v_mfma_f32_16x16x32_bf16 v[40:43], v[56:59], v[152:155], v[40:43]
  ds_read_b128 v[72:75], v12 offset:52224
  s_waitcnt lgkmcnt(2)
  v_mfma_f32_16x16x32_bf16 v[32:35], v[64:67], v[156:159], v[32:35]
  ds_read_b128 v[48:51], v13 offset:0
  s_waitcnt lgkmcnt(2)
  v_mfma_f32_16x16x32_bf16 v[36:39], v[68:71], v[156:159], v[36:39]
  ds_read_b128 v[52:55], v13 offset:1024
  s_waitcnt lgkmcnt(2)
  v_mfma_f32_16x16x32_bf16 v[40:43], v[72:75], v[156:159], v[40:43]
  ds_read_b128 v[56:59], v13 offset:2048
  s_waitcnt lgkmcnt(2)
  v_mfma_f32_16x16x32_bf16 v[32:35], v[48:51], v[160:163], v[32:35]
  ds_read_b128 v[64:67], v13 offset:7168
  s_waitcnt lgkmcnt(2)
  v_mfma_f32_16x16x32_bf16 v[36:39], v[52:55], v[160:163], v[36:39]
  ds_read_b128 v[68:71], v13 offset:8192
  s_waitcnt lgkmcnt(2)
  v_mfma_f32_16x16x32_bf16 v[40:43], v[56:59], v[160:163], v[40:43]
  ds_read_b128 v[72:75], v13 offset:9216
  s_waitcnt lgkmcnt(2)
  v_mfma_f32_16x16x32_bf16 v[32:35], v[64:67], v[164:167], v[32:35]
  s_waitcnt lgkmcnt(1)
  v_mfma_f32_16x16x32_bf16 v[36:39], v[68:71], v[164:167], v[36:39]
  s_waitcnt lgkmcnt(0)
  v_mfma_f32_16x16x32_bf16 v[40:43], v[72:75], v[164:167], v[40:43]
  s_nop 3
  v_mov_b64 v[152:153], v[32:33]
  v_mov_b64 v[154:155], v[34:35]
  v_mov_b64 v[156:157], v[36:37]
  v_mov_b64 v[158:159], v[38:39]
  v_mov_b64 v[160:161], v[40:41]
  v_mov_b64 v[162:163], v[42:43]
  s_barrier
  ds_read_b128 v[136:139], v23 offset:0
  ds_read_b128 v[140:143], v23 offset:1024
  ds_read_b128 v[144:147], v23 offset:2048
  ds_read_b128 v[148:151], v23 offset:3072
Lad_z1d:
  s_bfe_u32 s17, s3, 0x10001
  s_and_b32 s16, s3, 1
  s_lshl_b32 s16, s16, 1
  s_add_u32 s16, s16, s17
  s_add_u32 s32, s10, 0x4000
  s_addc_u32 s33, s11, 0
  s_mov_b32 s34, 0x4000
  s_mov_b32 s35, 0x20000
  s_add_u32 s36, s10, 0x880000
  s_addc_u32 s37, s11, 0
  s_mov_b32 s38, 0x380000
  s_mov_b32 s39, 0x20000
  s_mov_b32 s40, s60
  s_mov_b32 s41, s61
  s_mov_b32 s42, 0x1000
  s_mov_b32 s43, 0x20000
  v_and_b32 v2, 15, v1
  v_lshrrev_b32 v3, 4, v1
  v_lshrrev_b32 v15, 2, v2
  v_and_b32 v16, 3, v2
  v_lshl_add_u32 v18, v15, 3, v16
  s_lshr_b32 s44, s16, 1
  s_and_b32 s45, s16, 1
  s_lshl_b32 s46, s18, 1
  s_add_u32 s46, s46, s44
  s_lshl_b32 s47, s46, 3
  s_add_u32 s47, s47, s19
  s_mul_i32 s47, s47, 7168
  s_lshl_b32 s22, s45, 3
  v_add_u32 v4, s22, v5
  s_lshl_b32 s46, s46, 6
  s_add_u32 s46, s46, s22
  v_lshlrev_b32 v17, 1, v18
  buffer_load_ushort v30, v17, s[40:43], s46 offen
  v_lshrrev_b32 v17, 1, v16
  v_lshlrev_b32 v17, 2, v17
  v_and_b32 v19, 2, v15
  v_or_b32 v17, v17, v19
  v_xor_b32 v17, v17, v3
  v_lshlrev_b32 v17, 4, v17
  v_lshl_add_u32 v8, v18, 7, v17
  s_lshl_b32 s22, s17, 13
  s_lshl_b32 s44, s44, 12
  s_add_u32 s22, s22, s44
  s_lshl_b32 s45, s45, 9
  s_add_u32 s22, s22, s45
  v_add_u32 v8, s22, v8
  v_xor_b32 v9, 64, v8
  s_mul_i32 s44, s17, 7168
  s_add_u32 s44, s44, 65536
  v_add_u32 v12, s44, v5
  s_lshl_b32 s44, s17, 11
  s_add_u32 s44, s44, 159680
  v_lshl_add_u32 v14, v3, 4, s44
  s_lshl_b32 s44, s17, 12
  s_add_u32 s44, s44, 151552
  v_lshl_add_u32 v13, v18, 2, s44
  s_lshl_b32 s44, s3, 10
  s_add_u32 s44, s44, 151552
  v_lshl_add_u32 v6, v1, 3, s44
  s_lshl_b32 s44, s3, 9
  s_add_u32 s44, s44, 159744
  v_lshl_add_u32 v7, v1, 2, s44
  v_and_b32 v19, 1, v2
  v_mov_b32 v20, 0xffff
  v_lshlrev_b32 v19, 4, v19
  v_lshlrev_b32 v20, v19, v20
  v_cmp_eq_u32 vcc, v15, v3
  s_nop 1
  v_cndmask_b32 v20, 0, v20, vcc
  v_cmp_gt_u32 vcc, 2, v16
  s_nop 1
  v_cndmask_b32 v21, v20, 0, vcc
  v_cndmask_b32 v20, 0, v20, vcc
  v_mov_b32 v16, 0x3727c5ac
  v_mov_b32 v26, 0
  v_mov_b32 v27, 0
  s_lshl_b32 s23, s3, 11
  v_mov_b64 v[32:33], 0
  v_mov_b64 v[34:35], 0
  v_mov_b64 v[36:37], 0
  v_mov_b64 v[38:39], 0
  v_mov_b64 v[40:41], 0
  v_mov_b64 v[42:43], 0
  v_mov_b64 v[44:45], 0
  v_mov_b64 v[46:47], 0
  v_mov_b64 v[48:49], 0
  v_mov_b64 v[50:51], 0
  v_mov_b64 v[52:53], 0
  v_mov_b64 v[54:55], 0
  v_mov_b64 v[56:57], 0
  v_mov_b64 v[58:59], 0
  v_mov_b64 v[60:61], 0
  v_mov_b64 v[62:63], 0
  s_mov_b32 s48, 0
  s_mov_b32 s49, 0
  s_mov_b32 s52, 16384
  s_mov_b32 s53, 28672
  v_xor_b32 v10, 512, v8
  v_xor_b32 v11, 512, v9
  v_mov_b64 v[64:65], 0
  v_mov_b64 v[66:67], 0
  v_mov_b64 v[68:69], 0
  v_mov_b64 v[70:71], 0
  v_mov_b64 v[72:73], 0
  v_mov_b64 v[74:75], 0
  v_mov_b64 v[76:77], 0
  v_mov_b64 v[78:79], 0
  v_mov_b64 v[80:81], 0
  v_mov_b64 v[82:83], 0
  v_mov_b64 v[84:85], 0
  v_mov_b64 v[86:87], 0
  v_mov_b64 v[88:89], 0
  v_mov_b64 v[90:91], 0
  v_mov_b64 v[92:93], 0
  v_mov_b64 v[94:95], 0
  s_waitcnt vmcnt(0) lgkmcnt(0)
  s_barrier
  buffer_load_dwordx4 v[96:99], v5, s[32:35], s23 offen offset:0 sc1
  buffer_load_dwordx4 v[100:103], v5, s[32:35], s23 offen offset:1024 sc1
  s_waitcnt vmcnt(0)
  v_mul_f32 v96, 0xba97b426, v96
  v_fmamk_f32 v97, v97, 0x3a97b426, v16
  v_fma_f32 v97, -v96, v96, v97
  v_max_f32 v97, v97, v16
  v_rsq_f32 v97, v97
  v_mul_f32 v98, 0xba97b426, v98
  v_fmamk_f32 v99, v99, 0x3a97b426, v16
  v_fma_f32 v99, -v98, v98, v99
  v_max_f32 v99, v99, v16
  v_rsq_f32 v99, v99
  v_cvt_pk_bf16_f32 v96, v96, v98
  v_cvt_pk_bf16_f32 v98, v97, v97
  v_cvt_pk_bf16_f32 v99, v99, v99
  ds_write_b64 v6, v[98:99] offset:0
  ds_write_b32 v7, v96 offset:0
  v_mul_f32 v100, 0xba97b426, v100
  v_fmamk_f32 v101, v101, 0x3a97b426, v16
  v_fma_f32 v101, -v100, v100, v101
  v_max_f32 v101, v101, v16
  v_rsq_f32 v101, v101
  v_mul_f32 v102, 0xba97b426, v102
  v_fmamk_f32 v103, v103, 0x3a97b426, v16
  v_fma_f32 v103, -v102, v102, v103
  v_max_f32 v103, v103, v16
  v_rsq_f32 v103, v103
  v_cvt_pk_bf16_f32 v100, v100, v102
  v_cvt_pk_bf16_f32 v102, v101, v101
  v_cvt_pk_bf16_f32 v103, v103, v103
  ds_write_b64 v6, v[102:103] offset:512
  ds_write_b32 v7, v100 offset:256
  s_waitcnt lgkmcnt(0)
  s_cmp_ge_u32 s3, 4
  s_cbranch_scc1 Lad_idle
  s_barrier
  ds_read_b128 v[128:131], v8
  ds_read_b128 v[132:135], v10
  ds_read2_b32 v[22:23], v13 offset0:0 offset1:4
  s_add_u32 s48, s48, 1
  s_and_b32 s44, s48, 3
  s_cmp_eq_u32 s44, 0
  s_cselect_b32 s50, -49152, s52
  s_add_u32 s49, s49, 1
  s_cmp_eq_u32 s49, 3
  s_cselect_b32 s51, -57344, s53
  s_cselect_b32 s49, 0, s49
  s_cmp_lt_u32 s48, 17
  s_waitcnt lgkmcnt(0)
  v_and_b32 v24, v22, v20
  v_and_b32 v25, v22, v21
  v_and_b32 v28, v23, v20
  v_and_b32 v29, v23, v21
  s_barrier
  v_mfma_f32_16x16x32_bf16 v[136:139], v[24:27], v[128:131], 0
  ds_read_b128 v[96:99], v12 offset:14336
  v_mfma_f32_16x16x32_bf16 v[140:143], v[26:29], v[128:131], 0
  ds_read_b128 v[128:131], v9
  v_mfma_f32_16x16x32_bf16 v[144:147], v[24:27], v[132:135], 0
  v_mfma_f32_16x16x32_bf16 v[148:151], v[26:29], v[132:135], 0
  ds_read_b128 v[132:135], v11
  ds_read2_b32 v[22:23], v13 offset0:32 offset1:36
  ds_read_b128 v[100:103], v12 offset:15360
  ds_read_b128 v[104:107], v12 offset:16384
  ds_read_b128 v[108:111], v12 offset:17408
  ds_read_b128 v[112:115], v12 offset:18432
  ds_read_b128 v[116:119], v12 offset:19456
  ds_read_b128 v[120:123], v12 offset:20480
  ds_read_b128 v[124:127], v14 offset:64
  v_cvt_pk_bf16_f32 v152, v136, v137
  v_cvt_pk_bf16_f32 v153, v138, v139
  v_cvt_pk_bf16_f32 v154, v140, v141
  v_cvt_pk_bf16_f32 v155, v142, v143
  v_cvt_pk_bf16_f32 v156, v144, v145
  v_cvt_pk_bf16_f32 v157, v146, v147
  v_cvt_pk_bf16_f32 v158, v148, v149
  v_cvt_pk_bf16_f32 v159, v150, v151
  v_add_u32 v8, s50, v8
  v_add_u32 v9, s50, v9
  v_add_u32 v12, s51, v12
  v_add_u32 v13, 256, v13
  v_add_u32 v14, 128, v14
  v_add_u32 v10, s50, v10
  v_add_u32 v11, s50, v11
  s_waitcnt lgkmcnt(7)
  v_and_b32 v24, v22, v20
  v_and_b32 v25, v22, v21
  v_and_b32 v28, v23, v20
  v_and_b32 v29, v23, v21
Lad_cloop:
  s_barrier
  v_mfma_f32_16x16x32_bf16 v[32:35], v[96:99], v[152:155], v[32:35]
  v_mfma_f32_16x16x32_bf16 v[64:67], v[96:99], v[156:159], v[64:67]
  v_mfma_f32_16x16x32_bf16 v[136:139], v[24:27], v[128:131], 0
  ds_read_b128 v[96:99], v12 offset:0
  v_mfma_f32_16x16x32_bf16 v[140:143], v[26:29], v[128:131], 0
  ds_read_b128 v[128:131], v8
  v_mfma_f32_16x16x32_bf16 v[144:147], v[24:27], v[132:135], 0
  v_mfma_f32_16x16x32_bf16 v[148:151], v[26:29], v[132:135], 0
  ds_read_b128 v[132:135], v10
  ds_read2_b32 v[22:23], v13 offset0:0 offset1:4
  s_waitcnt lgkmcnt(6)
  v_mfma_f32_16x16x32_bf16 v[36:39], v[100:103], v[152:155], v[36:39]
  v_mfma_f32_16x16x32_bf16 v[68:71], v[100:103], v[156:159], v[68:71]
  ds_read_b128 v[100:103], v12 offset:1024
  v_mfma_f32_16x16x32_bf16 v[40:43], v[104:107], v[152:155], v[40:43]
  v_mfma_f32_16x16x32_bf16 v[72:75], v[104:107], v[156:159], v[72:75]
  ds_read_b128 v[104:107], v12 offset:2048
  v_mfma_f32_16x16x32_bf16 v[44:47], v[108:111], v[152:155], v[44:47]
  v_cvt_pk_bf16_f32 v160, v136, v137
  v_cvt_pk_bf16_f32 v161, v138, v139
  v_mfma_f32_16x16x32_bf16 v[76:79], v[108:111], v[156:159], v[76:79]
  v_cvt_pk_bf16_f32 v162, v140, v141
  v_cvt_pk_bf16_f32 v163, v142, v143
  ds_read_b128 v[108:111], v12 offset:3072
  v_mfma_f32_16x16x32_bf16 v[48:51], v[112:115], v[152:155], v[48:51]
  v_cvt_pk_bf16_f32 v164, v144, v145
  v_cvt_pk_bf16_f32 v165, v146, v147
  v_mfma_f32_16x16x32_bf16 v[80:83], v[112:115], v[156:159], v[80:83]
  v_cvt_pk_bf16_f32 v166, v148, v149
  v_cvt_pk_bf16_f32 v167, v150, v151
  ds_read_b128 v[112:115], v12 offset:4096
  v_mfma_f32_16x16x32_bf16 v[52:55], v[116:119], v[152:155], v[52:55]
  s_add_u32 s48, s48, 1
  s_and_b32 s44, s48, 3
  s_cmp_eq_u32 s44, 0
  s_cselect_b32 s50, -49152, s52
  v_mfma_f32_16x16x32_bf16 v[84:87], v[116:119], v[156:159], v[84:87]
  s_add_u32 s49, s49, 1
  s_cmp_eq_u32 s49, 3
  s_cselect_b32 s51, -57344, s53
  s_cselect_b32 s49, 0, s49
  ds_read_b128 v[116:119], v12 offset:5120
  s_waitcnt lgkmcnt(5)
  v_mfma_f32_16x16x32_bf16 v[56:59], v[120:123], v[152:155], v[56:59]
  v_and_b32 v24, v22, v20
  v_and_b32 v25, v22, v21
  v_mfma_f32_16x16x32_bf16 v[88:91], v[120:123], v[156:159], v[88:91]
  v_and_b32 v28, v23, v20
  v_and_b32 v29, v23, v21
  ds_read_b128 v[120:123], v12 offset:6144
  v_mfma_f32_16x16x32_bf16 v[60:63], v[124:127], v[152:155], v[60:63]
  s_cmp_lt_u32 s48, 17
  v_mfma_f32_16x16x32_bf16 v[92:95], v[124:127], v[156:159], v[92:95]
  ds_read_b128 v[124:127], v14 offset:0
  s_barrier
  v_mfma_f32_16x16x32_bf16 v[32:35], v[96:99], v[160:163], v[32:35]
  v_mfma_f32_16x16x32_bf16 v[64:67], v[96:99], v[164:167], v[64:67]
  v_mfma_f32_16x16x32_bf16 v[136:139], v[24:27], v[128:131], 0
  ds_read_b128 v[96:99], v12 offset:14336
  v_mfma_f32_16x16x32_bf16 v[140:143], v[26:29], v[128:131], 0
  ds_read_b128 v[128:131], v9
  v_mfma_f32_16x16x32_bf16 v[144:147], v[24:27], v[132:135], 0
  v_mfma_f32_16x16x32_bf16 v[148:151], v[26:29], v[132:135], 0
  ds_read_b128 v[132:135], v11
  ds_read2_b32 v[22:23], v13 offset0:32 offset1:36
  s_waitcnt lgkmcnt(6)
  v_mfma_f32_16x16x32_bf16 v[36:39], v[100:103], v[160:163], v[36:39]
  v_mfma_f32_16x16x32_bf16 v[68:71], v[100:103], v[164:167], v[68:71]
  ds_read_b128 v[100:103], v12 offset:15360
  v_mfma_f32_16x16x32_bf16 v[40:43], v[104:107], v[160:163], v[40:43]
  v_mfma_f32_16x16x32_bf16 v[72:75], v[104:107], v[164:167], v[72:75]
  ds_read_b128 v[104:107], v12 offset:16384
  v_mfma_f32_16x16x32_bf16 v[44:47], v[108:111], v[160:163], v[44:47]
  v_cvt_pk_bf16_f32 v152, v136, v137
  v_cvt_pk_bf16_f32 v153, v138, v139
  v_mfma_f32_16x16x32_bf16 v[76:79], v[108:111], v[164:167], v[76:79]
  v_cvt_pk_bf16_f32 v154, v140, v141
  v_cvt_pk_bf16_f32 v155, v142, v143
  ds_read_b128 v[108:111], v12 offset:17408
  v_mfma_f32_16x16x32_bf16 v[48:51], v[112:115], v[160:163], v[48:51]
  v_cvt_pk_bf16_f32 v156, v144, v145
  v_cvt_pk_bf16_f32 v157, v146, v147
  v_mfma_f32_16x16x32_bf16 v[80:83], v[112:115], v[164:167], v[80:83]
  v_cvt_pk_bf16_f32 v158, v148, v149
  v_cvt_pk_bf16_f32 v159, v150, v151
  ds_read_b128 v[112:115], v12 offset:18432
  v_mfma_f32_16x16x32_bf16 v[52:55], v[116:119], v[160:163], v[52:55]
  v_mfma_f32_16x16x32_bf16 v[84:87], v[116:119], v[164:167], v[84:87]
  ds_read_b128 v[116:119], v12 offset:19456
  s_waitcnt lgkmcnt(5)
  v_mfma_f32_16x16x32_bf16 v[56:59], v[120:123], v[160:163], v[56:59]
  v_and_b32 v24, v22, v20
  v_and_b32 v25, v22, v21
  v_mfma_f32_16x16x32_bf16 v[88:91], v[120:123], v[164:167], v[88:91]
  v_and_b32 v28, v23, v20
  v_and_b32 v29, v23, v21
  ds_read_b128 v[120:123], v12 offset:20480
  v_mfma_f32_16x16x32_bf16 v[60:63], v[124:127], v[160:163], v[60:63]
  v_add_u32 v8, s50, v8
  v_add_u32 v9, s50, v9
  v_mfma_f32_16x16x32_bf16 v[92:95], v[124:127], v[164:167], v[92:95]
  v_add_u32 v13, 256, v13
  v_add_u32 v10, s50, v10
  ds_read_b128 v[124:127], v14 offset:64
  v_add_u32 v11, s50, v11
  v_add_u32 v12, s51, v12
  v_add_u32 v14, 128, v14
  s_cbranch_scc1 Lad_cloop
  s_mul_i32 s44, s3, 3584
  s_add_u32 s44, s44, 79872
  v_lshl_add_u32 v9, v1, 3, s44
  s_add_u32 s44, s47, 4096
  s_xor_b32 s44, s3, 2
  s_lshl_b32 s44, s44, 13
  v_add_u32 v8, s44, v5
  v_lshl_add_u32 v10, v1, 2, s44
  ds_write_b128 v8, v[64:67] offset:0
  ds_write_b128 v8, v[68:71] offset:1024
  ds_write_b128 v8, v[72:75] offset:2048
  ds_write_b128 v8, v[76:79] offset:3072
  ds_write_b128 v8, v[80:83] offset:4096
  ds_write_b128 v8, v[84:87] offset:5120
  ds_write_b128 v8, v[88:91] offset:6144
  ds_write_b32 v10, v92 offset:7168
  s_lshl_b32 s44, s3, 13
  v_add_u32 v8, s44, v5
  v_lshl_add_u32 v10, v1, 2, s44
  s_add_u32 s24, s10, 0xf80000
  s_addc_u32 s25, s11, 0
  s_mov_b32 s26, 0x380000
  s_mov_b32 s27, 0x20000
  s_lshl_b32 s20, s18, 2
  s_add_u32 s20, s20, s16
  s_mul_i32 s20, s20, 28
  s_lshr_b32 s21, s19, 1
  s_mul_i32 s21, s21, 7
  s_add_u32 s20, s20, s21
  s_lshl_b32 s20, s20, 10
  s_and_b32 s21, s19, 1
  s_mul_i32 s22, s21, 3072
  s_add_u32 s22, s22, s20
  s_add_u32 s20, s20, 6144
  s_lshl_b32 s23, s21, 3
  v_add_u32 v6, s23, v5
  s_cmp_eq_u32 s21, 1
  s_cselect_b32 s41, 0, -1
  s_mov_b32 s40, -1
  v_lshlrev_b32 v30, 16, v30
  v_add_f32 v30, v30, v60
  s_waitcnt lgkmcnt(0)
  s_barrier
  ds_read_b32 v20, v10 offset:7168
  ds_read_b128 v[96:99], v8 offset:0
  ds_read_b128 v[100:103], v8 offset:1024
  ds_read_b128 v[104:107], v8 offset:2048
  ds_read_b128 v[108:111], v8 offset:3072
  ds_read_b128 v[112:115], v8 offset:4096
  ds_read_b128 v[116:119], v8 offset:5120
  ds_read_b128 v[120:123], v8 offset:6144
  ds_read_b64 v[136:137], v9 offset:0
  ds_read_b64 v[138:139], v9 offset:512
  ds_read_b64 v[140:141], v9 offset:1024
  ds_read_b64 v[142:143], v9 offset:1536
  ds_read_b64 v[144:145], v9 offset:2048
  ds_read_b64 v[146:147], v9 offset:2560
  ds_read_b64 v[148:149], v9 offset:3072
  s_waitcnt lgkmcnt(14)
  v_add_f32 v30, v30, v20
  v_add_f32 v32, v32, v30
  v_add_f32 v33, v33, v30
  v_add_f32 v34, v34, v30
  v_add_f32 v35, v35, v30
  v_add_f32 v36, v36, v30
  v_add_f32 v37, v37, v30
  v_add_f32 v38, v38, v30
  v_add_f32 v39, v39, v30
  v_add_f32 v40, v40, v30
  v_add_f32 v41, v41, v30
  v_add_f32 v42, v42, v30
  v_add_f32 v43, v43, v30
  v_add_f32 v44, v44, v30
  v_add_f32 v45, v45, v30
  v_add_f32 v46, v46, v30
  v_add_f32 v47, v47, v30
  v_add_f32 v48, v48, v30
  v_add_f32 v49, v49, v30
  v_add_f32 v50, v50, v30
  v_add_f32 v51, v51, v30
  v_add_f32 v52, v52, v30
  v_add_f32 v53, v53, v30
  v_add_f32 v54, v54, v30
  v_add_f32 v55, v55, v30
  v_add_f32 v56, v56, v30
  v_add_f32 v57, v57, v30
  v_add_f32 v58, v58, v30
  v_add_f32 v59, v59, v30
  s_waitcnt vmcnt(0) lgkmcnt(0)
  s_barrier
  v_lshlrev_b32 v152, 16, v136
  v_and_b32 v153, 0xffff0000, v136
  v_lshlrev_b32 v154, 16, v137
  v_and_b32 v155, 0xffff0000, v137
  v_add_f32 v32, v32, v96
  v_add_f32 v33, v33, v97
  v_add_f32 v34, v34, v98
  v_add_f32 v35, v35, v99
  v_mul_f32 v32, v32, v152
  v_mul_f32 v33, v33, v153
  v_mul_f32 v34, v34, v154
  v_mul_f32 v35, v35, v155
  v_cvt_pk_bf16_f32 v64, v32, v33
  v_cvt_pk_bf16_f32 v65, v34, v35
  v_lshlrev_b32 v152, 16, v138
  v_and_b32 v153, 0xffff0000, v138
  v_lshlrev_b32 v154, 16, v139
  v_and_b32 v155, 0xffff0000, v139
  v_add_f32 v36, v36, v100
  v_add_f32 v37, v37, v101
  v_add_f32 v38, v38, v102
  v_add_f32 v39, v39, v103
  v_mul_f32 v36, v36, v152
  v_mul_f32 v37, v37, v153
  v_mul_f32 v38, v38, v154
  v_mul_f32 v39, v39, v155
  v_cvt_pk_bf16_f32 v66, v36, v37
  v_cvt_pk_bf16_f32 v67, v38, v39
  buffer_store_dwordx4 v[64:67], v5, s[24:27], s22 offen offset:0 sc0 sc1
  v_lshlrev_b32 v152, 16, v140
  v_and_b32 v153, 0xffff0000, v140
  v_lshlrev_b32 v154, 16, v141
  v_and_b32 v155, 0xffff0000, v141
  v_add_f32 v40, v40, v104
  v_add_f32 v41, v41, v105
  v_add_f32 v42, v42, v106
  v_add_f32 v43, v43, v107
  v_mul_f32 v40, v40, v152
  v_mul_f32 v41, v41, v153
  v_mul_f32 v42, v42, v154
  v_mul_f32 v43, v43, v155
  v_cvt_pk_bf16_f32 v68, v40, v41
  v_cvt_pk_bf16_f32 v69, v42, v43
  v_lshlrev_b32 v152, 16, v142
  v_and_b32 v153, 0xffff0000, v142
  v_lshlrev_b32 v154, 16, v143
  v_and_b32 v155, 0xffff0000, v143
  v_add_f32 v44, v44, v108
  v_add_f32 v45, v45, v109
  v_add_f32 v46, v46, v110
  v_add_f32 v47, v47, v111
  v_mul_f32 v44, v44, v152
  v_mul_f32 v45, v45, v153
  v_mul_f32 v46, v46, v154
  v_mul_f32 v47, v47, v155
  v_cvt_pk_bf16_f32 v70, v44, v45
  v_cvt_pk_bf16_f32 v71, v46, v47
  buffer_store_dwordx4 v[68:71], v5, s[24:27], s22 offen offset:1024 sc0 sc1
  v_lshlrev_b32 v152, 16, v144
  v_and_b32 v153, 0xffff0000, v144
  v_lshlrev_b32 v154, 16, v145
  v_and_b32 v155, 0xffff0000, v145
  v_add_f32 v48, v48, v112
  v_add_f32 v49, v49, v113
  v_add_f32 v50, v50, v114
  v_add_f32 v51, v51, v115
  v_mul_f32 v48, v48, v152
  v_mul_f32 v49, v49, v153
  v_mul_f32 v50, v50, v154
  v_mul_f32 v51, v51, v155
  v_cvt_pk_bf16_f32 v72, v48, v49
  v_cvt_pk_bf16_f32 v73, v50, v51
  v_lshlrev_b32 v152, 16, v146
  v_and_b32 v153, 0xffff0000, v146
  v_lshlrev_b32 v154, 16, v147
  v_and_b32 v155, 0xffff0000, v147
  v_add_f32 v52, v52, v116
  v_add_f32 v53, v53, v117
  v_add_f32 v54, v54, v118
  v_add_f32 v55, v55, v119
  v_mul_f32 v52, v52, v152
  v_mul_f32 v53, v53, v153
  v_mul_f32 v54, v54, v154
  v_mul_f32 v55, v55, v155
  v_cvt_pk_bf16_f32 v74, v52, v53
  v_cvt_pk_bf16_f32 v75, v54, v55
  buffer_store_dwordx4 v[72:75], v5, s[24:27], s22 offen offset:2048 sc0 sc1
  v_lshlrev_b32 v152, 16, v148
  v_and_b32 v153, 0xffff0000, v148
  v_lshlrev_b32 v154, 16, v149
  v_and_b32 v155, 0xffff0000, v149
  v_add_f32 v56, v56, v120
  v_add_f32 v57, v57, v121
  v_add_f32 v58, v58, v122
  v_add_f32 v59, v59, v123
  v_mul_f32 v56, v56, v152
  v_mul_f32 v57, v57, v153
  v_mul_f32 v58, v58, v154
  v_mul_f32 v59, v59, v155
  v_cvt_pk_bf16_f32 v76, v56, v57
  v_cvt_pk_bf16_f32 v77, v58, v59
  v_cndmask_b32 v76, 0, v76, s[40:41]
  v_cndmask_b32 v77, 0, v77, s[40:41]
  buffer_store_dwordx2 v[76:77], v6, s[24:27], s20 offen sc0 sc1
  s_branch Lad_j4done
Lad_idle:
  s_mov_b32 s44, 0
  v_mov_b32 v15, 0xbdd2d3e8
  s_barrier
  s_barrier
  v_mul_f32 v32, v136, v136
  v_mul_f32 v33, v137, v137
  v_mul_f32 v34, v138, v138
  v_mul_f32 v35, v139, v139
  v_fmaak_f32 v32, v32, v15, 0xc0135761
  v_fmaak_f32 v33, v33, v15, 0xc0135761
  v_fmaak_f32 v34, v34, v15, 0xc0135761
  v_fmaak_f32 v35, v35, v15, 0xc0135761
  v_mul_f32 v32, v32, v136
  v_mul_f32 v33, v33, v137
  v_mul_f32 v34, v34, v138
  v_mul_f32 v35, v35, v139
  v_exp_f32 v32, v32
  v_exp_f32 v33, v33
  v_exp_f32 v34, v34
  v_exp_f32 v35, v35
  v_add_f32 v32, 1.0, v32
  v_add_f32 v33, 1.0, v33
  v_add_f32 v34, 1.0, v34
  v_add_f32 v35, 1.0, v35
  v_rcp_f32 v32, v32
  v_rcp_f32 v33, v33
  v_rcp_f32 v34, v34
  v_rcp_f32 v35, v35
  v_mul_f32 v136, v136, v32
  v_mul_f32 v137, v137, v33
  v_mul_f32 v138, v138, v34
  v_mul_f32 v139, v139, v35
  v_cvt_pk_bf16_f32 v64, v136, v137
  v_cvt_pk_bf16_f32 v65, v138, v139
  s_barrier
  s_barrier
  v_mul_f32 v32, v140, v140
  v_mul_f32 v33, v141, v141
  v_mul_f32 v34, v142, v142
  v_mul_f32 v35, v143, v143
  v_fmaak_f32 v32, v32, v15, 0xc0135761
  v_fmaak_f32 v33, v33, v15, 0xc0135761
  v_fmaak_f32 v34, v34, v15, 0xc0135761
  v_fmaak_f32 v35, v35, v15, 0xc0135761
  v_mul_f32 v32, v32, v140
  v_mul_f32 v33, v33, v141
  v_mul_f32 v34, v34, v142
  v_mul_f32 v35, v35, v143
  v_exp_f32 v32, v32
  v_exp_f32 v33, v33
  v_exp_f32 v34, v34
  v_exp_f32 v35, v35
  v_add_f32 v32, 1.0, v32
  v_add_f32 v33, 1.0, v33
  v_add_f32 v34, 1.0, v34
  v_add_f32 v35, 1.0, v35
  v_rcp_f32 v32, v32
  v_rcp_f32 v33, v33
  v_rcp_f32 v34, v34
  v_rcp_f32 v35, v35
  v_mul_f32 v140, v140, v32
  v_mul_f32 v141, v141, v33
  v_mul_f32 v142, v142, v34
  v_mul_f32 v143, v143, v35
  v_cvt_pk_bf16_f32 v66, v140, v141
  v_cvt_pk_bf16_f32 v67, v142, v143
  s_barrier
  s_barrier
  v_mul_f32 v32, v144, v144
  v_mul_f32 v33, v145, v145
  v_mul_f32 v34, v146, v146
  v_mul_f32 v35, v147, v147
  v_fmaak_f32 v32, v32, v15, 0xc0135761
  v_fmaak_f32 v33, v33, v15, 0xc0135761
  v_fmaak_f32 v34, v34, v15, 0xc0135761
  v_fmaak_f32 v35, v35, v15, 0xc0135761
  v_mul_f32 v32, v32, v144
  v_mul_f32 v33, v33, v145
  v_mul_f32 v34, v34, v146
  v_mul_f32 v35, v35, v147
  v_exp_f32 v32, v32
  v_exp_f32 v33, v33
  v_exp_f32 v34, v34
  v_exp_f32 v35, v35
  v_add_f32 v32, 1.0, v32
  v_add_f32 v33, 1.0, v33
  v_add_f32 v34, 1.0, v34
  v_add_f32 v35, 1.0, v35
  v_rcp_f32 v32, v32
  v_rcp_f32 v33, v33
  v_rcp_f32 v34, v34
  v_rcp_f32 v35, v35
  v_mul_f32 v144, v144, v32
  v_mul_f32 v145, v145, v33
  v_mul_f32 v146, v146, v34
  v_mul_f32 v147, v147, v35
  v_cvt_pk_bf16_f32 v68, v144, v145
  v_cvt_pk_bf16_f32 v69, v146, v147
  s_barrier
  s_barrier
  v_mul_f32 v32, v148, v148
  v_mul_f32 v33, v149, v149
  v_mul_f32 v34, v150, v150
  v_mul_f32 v35, v151, v151
  v_fmaak_f32 v32, v32, v15, 0xc0135761
  v_fmaak_f32 v33, v33, v15, 0xc0135761
  v_fmaak_f32 v34, v34, v15, 0xc0135761
  v_fmaak_f32 v35, v35, v15, 0xc0135761
  v_mul_f32 v32, v32, v148
  v_mul_f32 v33, v33, v149
  v_mul_f32 v34, v34, v150
  v_mul_f32 v35, v35, v151
  v_exp_f32 v32, v32
  v_exp_f32 v33, v33
  v_exp_f32 v34, v34
  v_exp_f32 v35, v35
  v_add_f32 v32, 1.0, v32
  v_add_f32 v33, 1.0, v33
  v_add_f32 v34, 1.0, v34
  v_add_f32 v35, 1.0, v35
  v_rcp_f32 v32, v32
  v_rcp_f32 v33, v33
  v_rcp_f32 v34, v34
  v_rcp_f32 v35, v35
  v_mul_f32 v148, v148, v32
  v_mul_f32 v149, v149, v33
  v_mul_f32 v150, v150, v34
  v_mul_f32 v151, v151, v35
  v_cvt_pk_bf16_f32 v70, v148, v149
  v_cvt_pk_bf16_f32 v71, v150, v151
  s_barrier
  s_barrier
  v_mul_f32 v32, v152, v152
  v_mul_f32 v33, v153, v153
  v_mul_f32 v34, v154, v154
  v_mul_f32 v35, v155, v155
  v_fmaak_f32 v32, v32, v15, 0xc0135761
  v_fmaak_f32 v33, v33, v15, 0xc0135761
  v_fmaak_f32 v34, v34, v15, 0xc0135761
  v_fmaak_f32 v35, v35, v15, 0xc0135761
  v_mul_f32 v32, v32, v152
  v_mul_f32 v33, v33, v153
  v_mul_f32 v34, v34, v154
  v_mul_f32 v35, v35, v155
  v_exp_f32 v32, v32
  v_exp_f32 v33, v33
  v_exp_f32 v34, v34
  v_exp_f32 v35, v35
  v_add_f32 v32, 1.0, v32
  v_add_f32 v33, 1.0, v33
  v_add_f32 v34, 1.0, v34
  v_add_f32 v35, 1.0, v35
  v_rcp_f32 v32, v32
  v_rcp_f32 v33, v33
  v_rcp_f32 v34, v34
  v_rcp_f32 v35, v35
  v_mul_f32 v152, v152, v32
  v_mul_f32 v153, v153, v33
  v_mul_f32 v154, v154, v34
  v_mul_f32 v155, v155, v35
  v_cvt_pk_bf16_f32 v72, v152, v153
  v_cvt_pk_bf16_f32 v73, v154, v155
  s_barrier
  s_barrier
  v_mul_f32 v32, v156, v156
  v_mul_f32 v33, v157, v157
  v_mul_f32 v34, v158, v158
  v_mul_f32 v35, v159, v159
  v_fmaak_f32 v32, v32, v15, 0xc0135761
  v_fmaak_f32 v33, v33, v15, 0xc0135761
  v_fmaak_f32 v34, v34, v15, 0xc0135761
  v_fmaak_f32 v35, v35, v15, 0xc0135761
  v_mul_f32 v32, v32, v156
  v_mul_f32 v33, v33, v157
  v_mul_f32 v34, v34, v158
  v_mul_f32 v35, v35, v159
  v_exp_f32 v32, v32
  v_exp_f32 v33, v33
  v_exp_f32 v34, v34
  v_exp_f32 v35, v35
  v_add_f32 v32, 1.0, v32
  v_add_f32 v33, 1.0, v33
  v_add_f32 v34, 1.0, v34
  v_add_f32 v35, 1.0, v35
  v_rcp_f32 v32, v32
  v_rcp_f32 v33, v33
  v_rcp_f32 v34, v34
  v_rcp_f32 v35, v35
  v_mul_f32 v156, v156, v32
  v_mul_f32 v157, v157, v33
  v_mul_f32 v158, v158, v34
  v_mul_f32 v159, v159, v35
  v_cvt_pk_bf16_f32 v74, v156, v157
  v_cvt_pk_bf16_f32 v75, v158, v159
  s_barrier
  s_barrier
  v_mul_f32 v32, v160, v160
  v_mul_f32 v33, v161, v161
  v_mul_f32 v34, v162, v162
  v_mul_f32 v35, v163, v163
  v_fmaak_f32 v32, v32, v15, 0xc0135761
  v_fmaak_f32 v33, v33, v15, 0xc0135761
  v_fmaak_f32 v34, v34, v15, 0xc0135761
  v_fmaak_f32 v35, v35, v15, 0xc0135761
  v_mul_f32 v32, v32, v160
  v_mul_f32 v33, v33, v161
  v_mul_f32 v34, v34, v162
  v_mul_f32 v35, v35, v163
  v_exp_f32 v32, v32
  v_exp_f32 v33, v33
  v_exp_f32 v34, v34
  v_exp_f32 v35, v35
  v_add_f32 v32, 1.0, v32
  v_add_f32 v33, 1.0, v33
  v_add_f32 v34, 1.0, v34
  v_add_f32 v35, 1.0, v35
  v_rcp_f32 v32, v32
  v_rcp_f32 v33, v33
  v_rcp_f32 v34, v34
  v_rcp_f32 v35, v35
  v_mul_f32 v160, v160, v32
  v_mul_f32 v161, v161, v33
  v_mul_f32 v162, v162, v34
  v_mul_f32 v163, v163, v35
  v_cvt_pk_bf16_f32 v76, v160, v161
  v_cvt_pk_bf16_f32 v77, v162, v163
  s_mov_b32 s44, 14
Lad_idl:
  s_barrier
  s_barrier
  s_barrier
  s_barrier
  s_barrier
  s_barrier
  s_barrier
  s_barrier
  s_barrier
  s_barrier
  s_barrier
  s_barrier
  s_barrier
  s_barrier
  s_barrier
  s_barrier
  s_barrier
  s_barrier
  s_barrier
  s_barrier
  s_mul_i32 s44, s3, 3584
  s_add_u32 s44, s44, 65536
  v_lshl_add_u32 v9, v1, 3, s44
  ds_write_b64 v9, v[64:65] offset:0
  ds_write_b64 v9, v[66:67] offset:512
  ds_write_b64 v9, v[68:69] offset:1024
  ds_write_b64 v9, v[70:71] offset:1536
  ds_write_b64 v9, v[72:73] offset:2048
  ds_write_b64 v9, v[74:75] offset:2560
  ds_write_b64 v9, v[76:77] offset:3072
  s_waitcnt lgkmcnt(0)
  s_barrier
  s_barrier
  s_add_u32 s24, s10, 0xf80000
  s_addc_u32 s25, s11, 0
  s_mov_b32 s26, 0x380000
  s_mov_b32 s27, 0x20000
Lad_j4done:
  s_and_b32 s16, s3, 3
  s_lshr_b32 s17, s3, 2
  s_lshl_b32 s21, s18, 2
  s_add_u32 s21, s21, s16
  s_mul_i32 s21, s21, 28672
  s_mul_i32 s44, s17, 14336
  s_add_u32 s21, s21, s44
  s_mul_i32 s44, s17, 71680
  s_add_u32 s44, s44, 32768
  v_add_u32 v6, s44, v5
  s_cmp_eq_u32 s17, 0
  s_cselect_b32 s44, 89088, 0
  v_add_u32 v7, s44, v5
  s_lshr_b32 s44, s16, 1
  s_lshl_b32 s44, s44, 5
  s_and_b32 s45, s16, 1
  s_lshl_b32 s45, s45, 2
  s_add_u32 s44, s44, s45
  s_mul_i32 s44, s44, 160
  s_add_u32 s44, s44, 15360
  v_mul_u32_u24 v10, 160, v18
  v_lshl_add_u32 v10, v3, 3, v10
  v_add_u32 v10, s44, v10
  v_lshlrev_b32 v9, 4, v3
  v_add_u32 v9, 160768, v9
  s_mul_i32 s44, s16, 1280
  s_add_u32 s44, s44, 25600
  v_lshl_add_u32 v8, v1, 2, s44
  s_add_u32 s36, s10, 0x8000
  s_addc_u32 s37, s11, 0
  s_mov_b32 s38, 0xe000
  s_mov_b32 s39, 0x20000
  s_lshl_b32 s46, s18, 8
  v_mov_b32 v14, s46
  v_mov_b32 v15, 1
  s_waitcnt vmcnt(0)
  s_barrier
  s_cmp_lg_u32 s3, 0
  s_cbranch_scc1 Lad_nopoll
  s_mov_b32 s45, 0
  s_mov_b64 exec, 1
  buffer_atomic_add v15, v14, s[36:39], 0 offen sc1
Lad_poll:
  buffer_load_dword v16, v14, s[36:39], 0 offen sc0 sc1
  s_add_u32 s45, s45, 1
  s_waitcnt vmcnt(0)
  v_readfirstlane_b32 s46, v16
  s_nop 1
  s_cmp_ge_u32 s46, 8
  s_cbranch_scc1 Lad_pdone
  s_cmp_lt_u32 s45, 0x400000
  s_cbranch_scc1 Lad_poll
Lad_pdone:
  s_mov_b64 exec, -1
Lad_nopoll:
  s_barrier
  s_add_u32 s23, s21, 0
  buffer_load_dwordx4 v[32:35], v5, s[24:27], s23 offen offset:0 sc1
  buffer_load_dwordx4 v[36:39], v5, s[24:27], s23 offen offset:1024 sc1
  ds_read_b128 v[88:91], v6 offset:0
  ds_read_b128 v[92:95], v6 offset:1024
  ds_read_b128 v[96:99], v6 offset:2048
  ds_read_b128 v[100:103], v6 offset:3072
  ds_read_b128 v[104:107], v6 offset:4096
  ds_read_b128 v[108:111], v6 offset:5120
  ds_read_b128 v[112:115], v6 offset:6144
  ds_read_b128 v[116:119], v6 offset:7168
  ds_read_b128 v[120:123], v6 offset:8192
  ds_read_b128 v[124:127], v6 offset:9216
  buffer_load_dwordx4 v[40:43], v5, s[24:27], s23 offen offset:2048 sc1
  buffer_load_dwordx4 v[44:47], v5, s[24:27], s23 offen offset:3072 sc1
  s_add_u32 s23, s21, 4096
  buffer_load_dwordx4 v[48:51], v5, s[24:27], s23 offen offset:0 sc1
  buffer_load_dwordx4 v[52:55], v5, s[24:27], s23 offen offset:1024 sc1
  buffer_load_dwordx4 v[56:59], v5, s[24:27], s23 offen offset:2048 sc1
  buffer_load_dwordx4 v[60:63], v5, s[24:27], s23 offen offset:3072 sc1
  s_add_u32 s23, s21, 8192
  buffer_load_dwordx4 v[64:67], v5, s[24:27], s23 offen offset:0 sc1
  buffer_load_dwordx4 v[68:71], v5, s[24:27], s23 offen offset:1024 sc1
  buffer_load_dwordx4 v[72:75], v5, s[24:27], s23 offen offset:2048 sc1
  buffer_load_dwordx4 v[76:79], v5, s[24:27], s23 offen offset:3072 sc1
  s_add_u32 s23, s21, 12288
  buffer_load_dwordx4 v[80:83], v5, s[24:27], s23 offen offset:0 sc1
  buffer_load_dwordx4 v[84:87], v5, s[24:27], s23 offen offset:1024 sc1
  s_waitcnt vmcnt(13) lgkmcnt(5)
  ds_read_b128 v[128:131], v6 offset:10240
  ds_read_b128 v[132:135], v6 offset:11264
  v_mfma_f32_16x16x32_bf16 v[12:15], v[88:91], v[32:35], 0
  ds_read_b128 v[136:139], v6 offset:12288
  ds_read_b128 v[140:143], v6 offset:13312
  v_mfma_f32_16x16x32_bf16 v[16:19], v[92:95], v[32:35], 0
  ds_read_b128 v[144:147], v6 offset:14336
  v_mfma_f32_16x16x32_bf16 v[20:23], v[96:99], v[32:35], 0
  v_mfma_f32_16x16x32_bf16 v[24:27], v[100:103], v[32:35], 0
  v_mfma_f32_16x16x32_bf16 v[28:31], v[104:107], v[32:35], 0
  s_waitcnt vmcnt(12) lgkmcnt(5)
  ds_read_b128 v[88:91], v6 offset:15360
  ds_read_b128 v[92:95], v6 offset:16384
  v_mfma_f32_16x16x32_bf16 v[12:15], v[108:111], v[36:39], v[12:15]
  ds_read_b128 v[96:99], v6 offset:17408
  ds_read_b128 v[100:103], v6 offset:18432
  v_mfma_f32_16x16x32_bf16 v[16:19], v[112:115], v[36:39], v[16:19]
  ds_read_b128 v[104:107], v6 offset:19456
  v_mfma_f32_16x16x32_bf16 v[20:23], v[116:119], v[36:39], v[20:23]
  v_mfma_f32_16x16x32_bf16 v[24:27], v[120:123], v[36:39], v[24:27]
  v_mfma_f32_16x16x32_bf16 v[28:31], v[124:127], v[36:39], v[28:31]
  s_waitcnt vmcnt(11) lgkmcnt(5)
  ds_read_b128 v[108:111], v6 offset:20480
  ds_read_b128 v[112:115], v6 offset:21504
  v_mfma_f32_16x16x32_bf16 v[12:15], v[128:131], v[40:43], v[12:15]
  ds_read_b128 v[116:119], v6 offset:22528
  ds_read_b128 v[120:123], v6 offset:23552
  v_mfma_f32_16x16x32_bf16 v[16:19], v[132:135], v[40:43], v[16:19]
  ds_read_b128 v[124:127], v6 offset:24576
  v_mfma_f32_16x16x32_bf16 v[20:23], v[136:139], v[40:43], v[20:23]
  v_mfma_f32_16x16x32_bf16 v[24:27], v[140:143], v[40:43], v[24:27]
  v_mfma_f32_16x16x32_bf16 v[28:31], v[144:147], v[40:43], v[28:31]
  s_waitcnt vmcnt(10) lgkmcnt(5)
  ds_read_b128 v[128:131], v6 offset:25600
  ds_read_b128 v[132:135], v6 offset:26624
  v_mfma_f32_16x16x32_bf16 v[12:15], v[88:91], v[44:47], v[12:15]
  ds_read_b128 v[136:139], v6 offset:27648
  ds_read_b128 v[140:143], v6 offset:28672
  v_mfma_f32_16x16x32_bf16 v[16:19], v[92:95], v[44:47], v[16:19]
  ds_read_b128 v[144:147], v6 offset:29696
  v_mfma_f32_16x16x32_bf16 v[20:23], v[96:99], v[44:47], v[20:23]
  v_mfma_f32_16x16x32_bf16 v[24:27], v[100:103], v[44:47], v[24:27]
  v_mfma_f32_16x16x32_bf16 v[28:31], v[104:107], v[44:47], v[28:31]
  s_waitcnt vmcnt(9) lgkmcnt(5)
  ds_read_b128 v[88:91], v6 offset:30720
  ds_read_b128 v[92:95], v6 offset:31744
  v_mfma_f32_16x16x32_bf16 v[12:15], v[108:111], v[48:51], v[12:15]
  ds_read_b128 v[96:99], v6 offset:32768
  ds_read_b128 v[100:103], v6 offset:33792
  v_mfma_f32_16x16x32_bf16 v[16:19], v[112:115], v[48:51], v[16:19]
  ds_read_b128 v[104:107], v6 offset:34816
  v_mfma_f32_16x16x32_bf16 v[20:23], v[116:119], v[48:51], v[20:23]
  v_mfma_f32_16x16x32_bf16 v[24:27], v[120:123], v[48:51], v[24:27]
  v_mfma_f32_16x16x32_bf16 v[28:31], v[124:127], v[48:51], v[28:31]
  s_waitcnt vmcnt(8) lgkmcnt(5)
  ds_read_b128 v[108:111], v6 offset:35840
  ds_read_b128 v[112:115], v6 offset:36864
  v_mfma_f32_16x16x32_bf16 v[12:15], v[128:131], v[52:55], v[12:15]
  ds_read_b128 v[116:119], v6 offset:37888
  ds_read_b128 v[120:123], v6 offset:38912
  v_mfma_f32_16x16x32_bf16 v[16:19], v[132:135], v[52:55], v[16:19]
  ds_read_b128 v[124:127], v6 offset:39936
  v_mfma_f32_16x16x32_bf16 v[20:23], v[136:139], v[52:55], v[20:23]
  v_mfma_f32_16x16x32_bf16 v[24:27], v[140:143], v[52:55], v[24:27]
  v_mfma_f32_16x16x32_bf16 v[28:31], v[144:147], v[52:55], v[28:31]
  s_waitcnt vmcnt(7) lgkmcnt(5)
  ds_read_b128 v[128:131], v6 offset:40960
  ds_read_b128 v[132:135], v6 offset:41984
  v_mfma_f32_16x16x32_bf16 v[12:15], v[88:91], v[56:59], v[12:15]
  ds_read_b128 v[136:139], v6 offset:43008
  ds_read_b128 v[140:143], v6 offset:44032
  v_mfma_f32_16x16x32_bf16 v[16:19], v[92:95], v[56:59], v[16:19]
  ds_read_b128 v[144:147], v6 offset:45056
  v_mfma_f32_16x16x32_bf16 v[20:23], v[96:99], v[56:59], v[20:23]
  v_mfma_f32_16x16x32_bf16 v[24:27], v[100:103], v[56:59], v[24:27]
  v_mfma_f32_16x16x32_bf16 v[28:31], v[104:107], v[56:59], v[28:31]
  s_waitcnt vmcnt(6) lgkmcnt(5)
  ds_read_b128 v[88:91], v6 offset:46080
  ds_read_b128 v[92:95], v6 offset:47104
  v_mfma_f32_16x16x32_bf16 v[12:15], v[108:111], v[60:63], v[12:15]
  ds_read_b128 v[96:99], v6 offset:48128
  ds_read_b128 v[100:103], v6 offset:49152
  v_mfma_f32_16x16x32_bf16 v[16:19], v[112:115], v[60:63], v[16:19]
  ds_read_b128 v[104:107], v6 offset:50176
  v_mfma_f32_16x16x32_bf16 v[20:23], v[116:119], v[60:63], v[20:23]
  v_mfma_f32_16x16x32_bf16 v[24:27], v[120:123], v[60:63], v[24:27]
  v_mfma_f32_16x16x32_bf16 v[28:31], v[124:127], v[60:63], v[28:31]
  s_waitcnt vmcnt(5) lgkmcnt(5)
  ds_read_b128 v[108:111], v6 offset:51200
  ds_read_b128 v[112:115], v6 offset:52224
  v_mfma_f32_16x16x32_bf16 v[12:15], v[128:131], v[64:67], v[12:15]
  ds_read_b128 v[116:119], v6 offset:53248
  ds_read_b128 v[120:123], v6 offset:54272
  v_mfma_f32_16x16x32_bf16 v[16:19], v[132:135], v[64:67], v[16:19]
  ds_read_b128 v[124:127], v6 offset:55296
  v_mfma_f32_16x16x32_bf16 v[20:23], v[136:139], v[64:67], v[20:23]
  v_mfma_f32_16x16x32_bf16 v[24:27], v[140:143], v[64:67], v[24:27]
  v_mfma_f32_16x16x32_bf16 v[28:31], v[144:147], v[64:67], v[28:31]
  s_waitcnt vmcnt(4) lgkmcnt(5)
  ds_read_b128 v[128:131], v7 offset:0
  ds_read_b128 v[132:135], v7 offset:1024
  v_mfma_f32_16x16x32_bf16 v[12:15], v[88:91], v[68:71], v[12:15]
  ds_read_b128 v[136:139], v7 offset:2048
  ds_read_b128 v[140:143], v7 offset:3072
  v_mfma_f32_16x16x32_bf16 v[16:19], v[92:95], v[68:71], v[16:19]
  ds_read_b128 v[144:147], v7 offset:4096
  v_mfma_f32_16x16x32_bf16 v[20:23], v[96:99], v[68:71], v[20:23]
  v_mfma_f32_16x16x32_bf16 v[24:27], v[100:103], v[68:71], v[24:27]
  v_mfma_f32_16x16x32_bf16 v[28:31], v[104:107], v[68:71], v[28:31]
  s_waitcnt vmcnt(3) lgkmcnt(5)
  ds_read_b128 v[88:91], v7 offset:5120
  ds_read_b128 v[92:95], v7 offset:6144
  v_mfma_f32_16x16x32_bf16 v[12:15], v[108:111], v[72:75], v[12:15]
  ds_read_b128 v[96:99], v7 offset:7168
  ds_read_b128 v[100:103], v7 offset:8192
  v_mfma_f32_16x16x32_bf16 v[16:19], v[112:115], v[72:75], v[16:19]
  ds_read_b128 v[104:107], v7 offset:9216
  v_mfma_f32_16x16x32_bf16 v[20:23], v[116:119], v[72:75], v[20:23]
  v_mfma_f32_16x16x32_bf16 v[24:27], v[120:123], v[72:75], v[24:27]
  v_mfma_f32_16x16x32_bf16 v[28:31], v[124:127], v[72:75], v[28:31]
  s_waitcnt vmcnt(2) lgkmcnt(5)
  ds_read_b128 v[108:111], v7 offset:10240
  ds_read_b128 v[112:115], v7 offset:11264
  v_mfma_f32_16x16x32_bf16 v[12:15], v[128:131], v[76:79], v[12:15]
  ds_read_b128 v[116:119], v7 offset:12288
  ds_read_b128 v[120:123], v7 offset:13312
  v_mfma_f32_16x16x32_bf16 v[16:19], v[132:135], v[76:79], v[16:19]
  ds_read_b128 v[124:127], v7 offset:14336
  v_mfma_f32_16x16x32_bf16 v[20:23], v[136:139], v[76:79], v[20:23]
  v_mfma_f32_16x16x32_bf16 v[24:27], v[140:143], v[76:79], v[24:27]
  v_mfma_f32_16x16x32_bf16 v[28:31], v[144:147], v[76:79], v[28:31]
  s_waitcnt vmcnt(1) lgkmcnt(5)
  v_mfma_f32_16x16x32_bf16 v[12:15], v[88:91], v[80:83], v[12:15]
  v_mfma_f32_16x16x32_bf16 v[16:19], v[92:95], v[80:83], v[16:19]
  v_mfma_f32_16x16x32_bf16 v[20:23], v[96:99], v[80:83], v[20:23]
  v_mfma_f32_16x16x32_bf16 v[24:27], v[100:103], v[80:83], v[24:27]
  v_mfma_f32_16x16x32_bf16 v[28:31], v[104:107], v[80:83], v[28:31]
  s_waitcnt vmcnt(0) lgkmcnt(0)
  v_mfma_f32_16x16x32_bf16 v[12:15], v[108:111], v[84:87], v[12:15]
  v_mfma_f32_16x16x32_bf16 v[16:19], v[112:115], v[84:87], v[16:19]
  v_mfma_f32_16x16x32_bf16 v[20:23], v[116:119], v[84:87], v[20:23]
  v_mfma_f32_16x16x32_bf16 v[24:27], v[120:123], v[84:87], v[24:27]
  v_mfma_f32_16x16x32_bf16 v[28:31], v[124:127], v[84:87], v[28:31]
  s_lshl_b32 s44, s16, 13
  s_add_u32 s44, s44, 32768
  v_add_u32 v8, s44, v5
  s_barrier
  s_cmp_eq_u32 s17, 0
  s_cbranch_scc1 Lad_g3a
  ds_write_b128 v8, v[12:15] offset:0
  ds_write_b128 v8, v[16:19] offset:1024
  ds_write_b128 v8, v[20:23] offset:2048
  ds_write_b128 v8, v[24:27] offset:3072
  ds_write_b128 v8, v[28:31] offset:4096
  s_waitcnt lgkmcnt(0)
  s_barrier
  s_branch Lad_g3b
Lad_g3a:
  ds_read_b128 v[32:35], v9 offset:0
  ds_read_b64 v[52:53], v10 offset:0
  ds_read_b128 v[36:39], v9 offset:64
  ds_read_b64 v[54:55], v10 offset:32
  ds_read_b128 v[40:43], v9 offset:128
  ds_read_b64 v[56:57], v10 offset:64
  ds_read_b128 v[44:47], v9 offset:192
  ds_read_b64 v[58:59], v10 offset:96
  ds_read_b128 v[48:51], v9 offset:256
  ds_read_b64 v[60:61], v10 offset:128
  s_waitcnt lgkmcnt(0)
  v_lshlrev_b32 v64, 16, v52
  v_and_b32 v65, 0xffff0000, v52
  v_lshlrev_b32 v66, 16, v53
  v_and_b32 v67, 0xffff0000, v53
  v_lshlrev_b32 v68, 16, v54
  v_and_b32 v69, 0xffff0000, v54
  v_lshlrev_b32 v70, 16, v55
  v_and_b32 v71, 0xffff0000, v55
  v_lshlrev_b32 v72, 16, v56
  v_and_b32 v73, 0xffff0000, v56
  v_lshlrev_b32 v74, 16, v57
  v_and_b32 v75, 0xffff0000, v57
  v_lshlrev_b32 v76, 16, v58
  v_and_b32 v77, 0xffff0000, v58
  v_lshlrev_b32 v78, 16, v59
  v_and_b32 v79, 0xffff0000, v59
  v_lshlrev_b32 v80, 16, v60
  v_and_b32 v81, 0xffff0000, v60
  v_lshlrev_b32 v82, 16, v61
  v_and_b32 v83, 0xffff0000, v61
  s_barrier
  ds_read_b128 v[88:91], v8 offset:0
  ds_read_b128 v[92:95], v8 offset:1024
  ds_read_b128 v[96:99], v8 offset:2048
  ds_read_b128 v[100:103], v8 offset:3072
  ds_read_b128 v[104:107], v8 offset:4096
  s_waitcnt lgkmcnt(4)
  v_add_f32 v12, v12, v88
  v_add_f32 v13, v13, v89
  v_add_f32 v14, v14, v90
  v_add_f32 v15, v15, v91
  v_fma_f32 v12, v12, v32, v64
  v_fma_f32 v13, v13, v33, v65
  v_fma_f32 v14, v14, v34, v66
  v_fma_f32 v15, v15, v35, v67
  v_cvt_pk_bf16_f32 v12, v12, v13
  v_cvt_pk_bf16_f32 v13, v14, v15
  ds_write_b64 v10, v[12:13] offset:0
  s_waitcnt lgkmcnt(4)
  v_add_f32 v16, v16, v92
  v_add_f32 v17, v17, v93
  v_add_f32 v18, v18, v94
  v_add_f32 v19, v19, v95
  v_fma_f32 v16, v16, v36, v68
  v_fma_f32 v17, v17, v37, v69
  v_fma_f32 v18, v18, v38, v70
  v_fma_f32 v19, v19, v39, v71
  v_cvt_pk_bf16_f32 v16, v16, v17
  v_cvt_pk_bf16_f32 v17, v18, v19
  ds_write_b64 v10, v[16:17] offset:32
  s_waitcnt lgkmcnt(4)
  v_add_f32 v20, v20, v96
  v_add_f32 v21, v21, v97
  v_add_f32 v22, v22, v98
  v_add_f32 v23, v23, v99
  v_fma_f32 v20, v20, v40, v72
  v_fma_f32 v21, v21, v41, v73
  v_fma_f32 v22, v22, v42, v74
  v_fma_f32 v23, v23, v43, v75
  v_cvt_pk_bf16_f32 v20, v20, v21
  v_cvt_pk_bf16_f32 v21, v22, v23
  ds_write_b64 v10, v[20:21] offset:64
  s_waitcnt lgkmcnt(4)
  v_add_f32 v24, v24, v100
  v_add_f32 v25, v25, v101
  v_add_f32 v26, v26, v102
  v_add_f32 v27, v27, v103
  v_fma_f32 v24, v24, v44, v76
  v_fma_f32 v25, v25, v45, v77
  v_fma_f32 v26, v26, v46, v78
  v_fma_f32 v27, v27, v47, v79
  v_cvt_pk_bf16_f32 v24, v24, v25
  v_cvt_pk_bf16_f32 v25, v26, v27
  ds_write_b64 v10, v[24:25] offset:96
  s_waitcnt lgkmcnt(4)
  v_add_f32 v28, v28, v104
  v_add_f32 v29, v29, v105
  v_add_f32 v30, v30, v106
  v_add_f32 v31, v31, v107
  v_fma_f32 v28, v28, v48, v80
  v_fma_f32 v29, v29, v49, v81
  v_fma_f32 v30, v30, v50, v82
  v_fma_f32 v31, v31, v51, v83
  v_cvt_pk_bf16_f32 v28, v28, v29
  v_cvt_pk_bf16_f32 v29, v30, v31
  ds_write_b64 v10, v[28:29] offset:128
  s_waitcnt lgkmcnt(0)
Lad_g3b:
  s_barrier
  s_endpgm
Lad_loader:
  s_sub_u32 s3, s3, 8
  v_lshlrev_b32 v5, 4, v1
  s_getpc_b64 s[24:25]
  s_add_u32 s24, s24, p2_tab@rel32@lo+4
  s_addc_u32 s25, s25, p2_tab@rel32@hi+12
  s_mov_b32 s26, 16384
  s_mov_b32 s27, 0x20000
  s_lshl_b32 s20, s3, 12
  s_add_u32 m0, s20, 41216
  s_nop 0
  buffer_load_dwordx4 v5, s[24:27], s20 offen offset:0 lds
  buffer_load_dwordx4 v5, s[24:27], s20 offen offset:1024 lds
  buffer_load_dwordx4 v5, s[24:27], s20 offen offset:2048 lds
  buffer_load_dwordx4 v5, s[24:27], s20 offen offset:3072 lds
  s_getpc_b64 s[28:29]
  s_add_u32 s28, s28, adaLN_cond__spectral_fnet__mixer_gmlp__prompt_kernel@rel32@lo+4
  s_addc_u32 s29, s29, adaLN_cond__spectral_fnet__mixer_gmlp__prompt_kernel@rel32@hi+12
  s_mov_b32 s30, p2_tab-adaLN_cond__spectral_fnet__mixer_gmlp__prompt_kernel
  s_mov_b32 s31, 0x20000
  s_lshl_b32 s21, s3, 13
  v_lshlrev_b32 v2, 7, v1
  buffer_load_dword v20, v2, s[28:31], s21 offen
  s_add_u32 s21, s21, 32768
  buffer_load_dword v21, v2, s[28:31], s21 offen
  s_and_b32 s58, s2, 7
  s_lshr_b32 s59, s2, 3
  s_lshl_b32 s16, s58, 2
  s_lshr_b32 s18, s59, 3
  s_add_u32 s16, s16, s18
  s_mov_b32 s6, s16
  s_and_b32 s16, s2, 7
  s_lshr_b32 s17, s2, 3
  s_and_b32 s18, s16, 3
  s_lshl_b32 s18, s18, 3
  s_and_b32 s19, s17, 7
  s_add_u32 s18, s18, s19
  s_lshr_b32 s19, s16, 2
  s_lshl_b32 s19, s19, 2
  s_lshr_b32 s17, s17, 3
  s_add_u32 s19, s19, s17
  s_mov_b32 s16, s6
  v_lshrrev_b32 v2, 3, v1
  v_and_b32 v3, 7, v1
  v_bfe_u32 v4, v2, 1, 1
  v_lshlrev_b32 v4, 2, v4
  v_xor_b32 v4, v3, v4
  v_mul_u32_u24 v6, 1280, v2
  v_lshl_add_u32 v10, v4, 4, v6
  s_and_b32 s21, s3, 1
  s_lshl_b32 s21, s21, 5
  v_xor_b32 v10, s21, v10
  v_add_u32 v11, 9216, v10
  v_lshlrev_b32 v2, 11, v2
  v_lshl_add_u32 v22, v3, 7, v2
  v_add_u32 v23, 1024, v22
  s_add_u32 s21, s3, 0
  s_cmp_ge_u32 s21, 7
  s_cselect_b32 s22, 7, 0
  s_cselect_b32 s23, 110592, 0
  s_sub_u32 s21, s21, s22
  s_lshl_b32 s21, s21, 6
  v_add_u32 v2, s21, v1
  v_mul_u32_u24 v3, 4682, v2
  v_lshrrev_b32 v3, 16, v3
  v_mul_u32_u24 v4, 14, v3
  v_sub_u32 v2, v2, v4
  v_and_b32 v4, 3, v3
  v_bfe_u32 v6, v3, 2, 2
  v_lshl_add_u32 v4, v6, 3, v4
  v_lshrrev_b32 v6, 4, v3
  v_lshl_add_u32 v4, v6, 2, v4
  v_mul_u32_u24 v4, 3456, v4
  v_lshl_add_u32 v4, v2, 4, v4
  v_add_u32 v14, s23, v4
  s_add_u32 s21, s3, 4
  s_cmp_ge_u32 s21, 7
  s_cselect_b32 s22, 7, 0
  s_cselect_b32 s23, 110592, 0
  s_sub_u32 s21, s21, s22
  s_lshl_b32 s21, s21, 6
  v_add_u32 v2, s21, v1
  v_mul_u32_u24 v3, 4682, v2
  v_lshrrev_b32 v3, 16, v3
  v_mul_u32_u24 v4, 14, v3
  v_sub_u32 v2, v2, v4
  v_and_b32 v4, 3, v3
  v_bfe_u32 v6, v3, 2, 2
  v_lshl_add_u32 v4, v6, 3, v4
  v_lshrrev_b32 v6, 4, v3
  v_lshl_add_u32 v4, v6, 2, v4
  v_mul_u32_u24 v4, 3456, v4
  v_lshl_add_u32 v4, v2, 4, v4
  v_add_u32 v15, s23, v4
  s_add_u32 s21, s3, 8
  s_cmp_ge_u32 s21, 7
  s_cselect_b32 s22, 7, 0
  s_cselect_b32 s23, 110592, 0
  s_sub_u32 s21, s21, s22
  s_lshl_b32 s21, s21, 6
  v_add_u32 v2, s21, v1
  v_mul_u32_u24 v3, 4682, v2
  v_lshrrev_b32 v3, 16, v3
  v_mul_u32_u24 v4, 14, v3
  v_sub_u32 v2, v2, v4
  v_and_b32 v4, 3, v3
  v_bfe_u32 v6, v3, 2, 2
  v_lshl_add_u32 v4, v6, 3, v4
  v_lshrrev_b32 v6, 4, v3
  v_lshl_add_u32 v4, v6, 2, v4
  v_mul_u32_u24 v4, 3456, v4
  v_lshl_add_u32 v4, v2, 4, v4
  v_add_u32 v16, s23, v4
  s_add_u32 s21, s3, 12
  s_cmp_ge_u32 s21, 7
  s_cselect_b32 s22, 7, 0
  s_cselect_b32 s23, 110592, 0
  s_sub_u32 s21, s21, s22
  s_lshl_b32 s21, s21, 6
  v_add_u32 v2, s21, v1
  v_mul_u32_u24 v3, 4682, v2
  v_lshrrev_b32 v3, 16, v3
  v_mul_u32_u24 v4, 14, v3
  v_sub_u32 v2, v2, v4
  v_and_b32 v4, 3, v3
  v_bfe_u32 v6, v3, 2, 2
  v_lshl_add_u32 v4, v6, 3, v4
  v_lshrrev_b32 v6, 4, v3
  v_lshl_add_u32 v4, v6, 2, v4
  v_mul_u32_u24 v4, 3456, v4
  v_lshl_add_u32 v4, v2, 4, v4
  v_add_u32 v17, s23, v4
  s_mul_i32 s40, s2, 2341
  s_lshr_b32 s40, s40, 16
  s_mul_i32 s41, s40, 28
  s_sub_u32 s41, s2, s41
  s_mul_i32 s22, s41, 37
  s_lshr_b32 s22, s22, 8
  s_mul_i32 s23, s22, 7
  s_sub_u32 s41, s41, s23
  s_lshl_b32 s23, s41, 5
  s_cmp_ge_u32 s41, 3
  s_cselect_b32 s47, 16, 0
  s_add_u32 s23, s23, s47
  s_cmp_eq_u32 s41, 6
  s_cselect_b32 s23, 96, s23
  s_cselect_b32 s47, 96, 0
  s_mul_i32 s22, s22, 216
  s_add_u32 s23, s23, s22
  s_mul_i32 s23, s23, 1280
  s_mul_i32 s40, s40, 160
  s_add_u32 s48, s23, s40
  v_add_u32 v3, 0, v1
  v_mul_u32_u24 v2, 6554, v3
  v_lshrrev_b32 v2, 16, v2
  v_mul_u32_u24 v4, 10, v2
  v_sub_u32 v3, v3, v4
  v_lshrrev_b32 v4, 4, v2
  v_mul_u32_u24 v4, s47, v4
  v_add_u32 v2, v2, v4
  v_mul_u32_u24 v2, 1280, v2
  v_lshl_add_u32 v24, v3, 4, v2
  v_add_u32 v3, 64, v1
  v_mul_u32_u24 v2, 6554, v3
  v_lshrrev_b32 v2, 16, v2
  v_mul_u32_u24 v4, 10, v2
  v_sub_u32 v3, v3, v4
  v_lshrrev_b32 v4, 4, v2
  v_mul_u32_u24 v4, s47, v4
  v_add_u32 v2, v2, v4
  v_mul_u32_u24 v2, 1280, v2
  v_lshl_add_u32 v25, v3, 4, v2
  v_add_u32 v3, 128, v1
  v_mul_u32_u24 v2, 6554, v3
  v_lshrrev_b32 v2, 16, v2
  v_mul_u32_u24 v4, 10, v2
  v_sub_u32 v3, v3, v4
  v_lshrrev_b32 v4, 4, v2
  v_mul_u32_u24 v4, s47, v4
  v_add_u32 v2, v2, v4
  v_mul_u32_u24 v2, 1280, v2
  v_lshl_add_u32 v26, v3, 4, v2
  v_add_u32 v3, 192, v1
  v_mul_u32_u24 v2, 6554, v3
  v_lshrrev_b32 v2, 16, v2
  v_mul_u32_u24 v4, 10, v2
  v_sub_u32 v3, v3, v4
  v_lshrrev_b32 v4, 4, v2
  v_mul_u32_u24 v4, s47, v4
  v_add_u32 v2, v2, v4
  v_mul_u32_u24 v2, 1280, v2
  v_lshl_add_u32 v27, v3, 4, v2
  v_add_u32 v3, 256, v1
  v_mul_u32_u24 v2, 6554, v3
  v_lshrrev_b32 v2, 16, v2
  v_mul_u32_u24 v4, 10, v2
  v_sub_u32 v3, v3, v4
  v_lshrrev_b32 v4, 4, v2
  v_mul_u32_u24 v4, s47, v4
  v_add_u32 v2, v2, v4
  v_mul_u32_u24 v2, 1280, v2
  v_lshl_add_u32 v28, v3, 4, v2
  v_lshrrev_b32 v2, 2, v1
  v_mul_u32_u24 v2, 160, v2
  v_and_b32 v3, 3, v1
  v_lshl_add_u32 v2, v3, 3, v2
  v_add_u32 v29, 155904, v2
  s_mul_i32 s40, s2, 205
  s_lshr_b32 s40, s40, 12
  s_mul_i32 s41, s40, 20
  s_sub_u32 s41, s2, s41
  s_sub_u32 s22, s2, 160
  s_mul_i32 s23, s22, 205
  s_lshr_b32 s23, s23, 11
  s_mul_i32 s47, s23, 10
  s_sub_u32 s22, s22, s47
  s_add_u32 s22, s22, 10
  s_add_u32 s23, s23, 8
  s_cmp_ge_u32 s2, 160
  s_cselect_b32 s40, s23, s40
  s_cselect_b32 s41, s22, s41
  s_mul_i32 s45, s40, 20
  s_add_u32 s45, s45, s41
  s_mul_i32 s45, s45, 7168
  s_lshr_b32 s22, s40, 1
  s_mul_i32 s22, s22, 432
  s_and_b32 s40, s40, 1
  s_mul_i32 s40, s40, 224
  s_add_u32 s22, s22, s40
  s_mul_i32 s41, s41, 110592
  s_add_u32 s47, s22, s41
  v_lshrrev_b32 v2, 4, v1
  v_and_b32 v3, 15, v1
  v_lshlrev_b32 v4, 1, v2
  v_xor_b32 v3, v3, v4
  v_mul_u32_u24 v2, 3456, v2
  v_lshl_add_u32 v30, v3, 4, v2
  v_xor_b32 v3, 8, v3
  v_lshl_add_u32 v31, v3, 4, v2
  v_cmp_gt_u32 vcc, 14, v3
  s_nop 1
  v_cndmask_b32 v31, 0x40000000, v31, vcc
  v_xor_b32 v3, 8, v3
  v_cmp_gt_u32 vcc, 14, v3
  s_nop 1
  v_cndmask_b32 v30, 0x40000000, v30, vcc
  v_lshrrev_b32 v2, 2, v1
  v_and_b32 v4, 7, v2
  v_lshlrev_b32 v4, 1, v4
  v_bfe_u32 v3, v1, 1, 1
  v_and_b32 v6, 1, v1
  v_lshlrev_b32 v6, 3, v6
  v_lshl_add_u32 v6, v2, 8, v6
  v_add_u32 v6, 73984, v6
  v_add_u32 v2, 0, v3
  v_xor_b32 v2, v2, v4
  v_lshl_add_u32 v60, v2, 4, v6
  v_add_u32 v2, 2, v3
  v_xor_b32 v2, v2, v4
  v_lshl_add_u32 v61, v2, 4, v6
  v_add_u32 v2, 4, v3
  v_xor_b32 v2, v2, v4
  v_lshl_add_u32 v62, v2, 4, v6
  v_add_u32 v2, 6, v3
  v_xor_b32 v2, v2, v4
  v_lshl_add_u32 v63, v2, 4, v6
  v_add_u32 v2, 8, v3
  v_xor_b32 v2, v2, v4
  v_lshl_add_u32 v64, v2, 4, v6
  v_add_u32 v2, 10, v3
  v_xor_b32 v2, v2, v4
  v_lshl_add_u32 v65, v2, 4, v6
  v_add_u32 v2, 12, v3
  v_xor_b32 v2, v2, v4
  v_lshl_add_u32 v66, v2, 4, v6
  s_lshr_b32 s40, s19, 1
  s_mul_i32 s40, s40, 432
  s_and_b32 s41, s19, 1
  s_mul_i32 s41, s41, 224
  s_add_u32 s49, s40, s41
  s_lshl_b32 s50, s18, 2
  s_add_u32 s50, s50, s3
  s_mul_i32 s50, s50, 20480
  s_lshl_b32 s7, s3, 11
  s_add_u32 s7, s7, 32768
  s_lshl_b32 s22, s59, 2
  s_add_u32 s22, s22, s3
  s_lshl_b32 s22, s22, 13
  s_and_b32 s51, s58, 3
  s_lshl_b32 s51, s51, 21
  s_add_u32 s51, s51, s22
  s_lshr_b32 s23, s58, 2
  s_lshl_b32 s23, s23, 20
  s_add_u32 s51, s51, s23
  s_mul_i32 s21, s3, 10240
  s_mul_i32 s22, s16, 81920
  s_add_u32 s22, s22, s21
  s_add_u32 s21, s21, 73984
  s_lshl_b32 s46, s3, 10
  s_waitcnt lgkmcnt(0)
  s_add_u32 s24, s10, 0x100000
  s_addc_u32 s25, s11, 0
  s_mov_b32 s26, 0x280000
  s_mov_b32 s27, 0x20000
  s_mov_b32 s28, s10
  s_mov_b32 s29, s11
  s_mov_b32 s30, 0x3c00
  s_mov_b32 s31, 0x20000
  s_mov_b32 s32, s52
  s_mov_b32 s33, s53
  s_mov_b32 s34, 0x21c000
  s_mov_b32 s35, 0x20000
  s_mov_b32 s36, s56
  s_mov_b32 s37, s57
  s_mov_b32 s38, 0x10e000
  s_mov_b32 s39, 0x20000
  s_mov_b32 s40, s54
  s_mov_b32 s41, s55
  s_mov_b32 s42, 0x800000
  s_mov_b32 s43, 0x20000
  s_cmp_ge_u32 s2, 228
  s_cbranch_scc1 Lad_lb0
  s_barrier
  s_cmp_ge_u32 s2, 160
  s_cbranch_scc1 Lad_lb0
  s_barrier
Lad_lb0:
  s_barrier
  s_barrier
  s_add_u32 s23, s22, 0
  s_add_u32 m0, s21, 0
  s_nop 0
  buffer_load_dwordx4 v5, s[24:27], s23 offen offset:0 sc1 lds
  buffer_load_dwordx4 v5, s[24:27], s23 offen offset:1024 sc1 lds
  buffer_load_dwordx4 v5, s[24:27], s23 offen offset:2048 sc1 lds
  buffer_load_dwordx4 v5, s[24:27], s23 offen offset:3072 sc1 lds
  s_add_u32 s23, s22, 4096
  s_add_u32 m0, s21, 4096
  s_nop 0
  buffer_load_dwordx4 v5, s[24:27], s23 offen offset:0 sc1 lds
  buffer_load_dwordx4 v5, s[24:27], s23 offen offset:1024 sc1 lds
  buffer_load_dwordx4 v5, s[24:27], s23 offen offset:2048 sc1 lds
  buffer_load_dwordx4 v5, s[24:27], s23 offen offset:3072 sc1 lds
  s_add_u32 s23, s22, 8192
  s_add_u32 m0, s21, 8192
  s_nop 0
  buffer_load_dwordx4 v5, s[24:27], s23 offen offset:0 sc1 lds
  buffer_load_dwordx4 v5, s[24:27], s23 offen offset:1024 sc1 lds
  s_add_u32 s23, s22, 40960
  s_add_u32 m0, s21, 40960
  s_nop 0
  buffer_load_dwordx4 v5, s[24:27], s23 offen offset:0 sc1 lds
  buffer_load_dwordx4 v5, s[24:27], s23 offen offset:1024 sc1 lds
  buffer_load_dwordx4 v5, s[24:27], s23 offen offset:2048 sc1 lds
  buffer_load_dwordx4 v5, s[24:27], s23 offen offset:3072 sc1 lds
  s_add_u32 s23, s22, 45056
  s_add_u32 m0, s21, 45056
  s_nop 0
  buffer_load_dwordx4 v5, s[24:27], s23 offen offset:0 sc1 lds
  buffer_load_dwordx4 v5, s[24:27], s23 offen offset:1024 sc1 lds
  buffer_load_dwordx4 v5, s[24:27], s23 offen offset:2048 sc1 lds
  buffer_load_dwordx4 v5, s[24:27], s23 offen offset:3072 sc1 lds
  s_add_u32 s23, s22, 49152
  s_add_u32 m0, s21, 49152
  s_nop 0
  buffer_load_dwordx4 v5, s[24:27], s23 offen offset:0 sc1 lds
  buffer_load_dwordx4 v5, s[24:27], s23 offen offset:1024 sc1 lds
  s_add_u32 m0, s20, 57600
  s_nop 0
  buffer_load_dwordx4 v5, s[28:31], s20 offen offset:0 sc1 lds
  buffer_load_dwordx4 v5, s[28:31], s20 offen offset:1024 sc1 lds
  buffer_load_dwordx4 v5, s[28:31], s20 offen offset:2048 sc1 lds
  buffer_load_dwordx4 v5, s[28:31], s20 offen offset:3072 sc1 lds
  s_add_u32 s24, s10, 0x600000
  s_addc_u32 s25, s11, 0
  s_mov_b32 s26, 0x280000
  s_mov_b32 s27, 0x20000
  s_add_u32 s28, s10, 0x1530000
  s_addc_u32 s29, s11, 0
  s_mov_b32 s30, 0x118000
  s_mov_b32 s31, 0x20000
  s_waitcnt vmcnt(14)
  s_barrier
  s_waitcnt vmcnt(0)
  s_barrier
  s_cmp_lg_u32 s3, 3
  s_cbranch_scc1 Lad_nwo
  s_mov_b32 m0, 155904
  s_nop 0
  buffer_load_dwordx4 v24, s[36:39], s48 offen lds
  s_mov_b32 m0, 156928
  s_nop 0
  buffer_load_dwordx4 v25, s[36:39], s48 offen lds
  s_mov_b32 m0, 157952
  s_nop 0
  buffer_load_dwordx4 v26, s[36:39], s48 offen lds
  s_mov_b32 m0, 158976
  s_nop 0
  buffer_load_dwordx4 v27, s[36:39], s48 offen lds
  s_mov_b32 m0, 160000
  s_nop 0
  buffer_load_dwordx4 v28, s[36:39], s48 offen lds
Lad_nwo:
  s_mov_b32 exec_hi, 0
  buffer_load_dword v20, v22, s[40:43], s51 offen
  s_mov_b32 exec_hi, -1
  s_barrier
  s_cmp_lg_u32 s3, 2
  s_cbranch_scc1 Lad_nwi
  s_add_u32 s23, s47, 0
  s_mov_b32 m0, 73984
  s_nop 0
  buffer_load_dwordx4 v30, s[32:35], s23 offen lds
  s_add_u32 s23, s47, 27648
  s_mov_b32 m0, 75008
  s_nop 0
  buffer_load_dwordx4 v31, s[32:35], s23 offen lds
  s_add_u32 s23, s47, 55296
  s_mov_b32 m0, 76032
  s_nop 0
  buffer_load_dwordx4 v30, s[32:35], s23 offen lds
  s_add_u32 s23, s47, 82944
  s_mov_b32 m0, 77056
  s_nop 0
  buffer_load_dwordx4 v31, s[32:35], s23 offen lds
  s_add_u32 s23, s47, 13824
  s_mov_b32 m0, 78080
  s_nop 0
  buffer_load_dwordx4 v30, s[32:35], s23 offen lds
  s_add_u32 s23, s47, 41472
  s_mov_b32 m0, 79104
  s_nop 0
  buffer_load_dwordx4 v31, s[32:35], s23 offen lds
  s_add_u32 s23, s47, 69120
  s_mov_b32 m0, 80128
  s_nop 0
  buffer_load_dwordx4 v30, s[32:35], s23 offen lds
  s_add_u32 s23, s47, 96768
  s_mov_b32 m0, 81152
  s_nop 0
  buffer_load_dwordx4 v31, s[32:35], s23 offen lds
Lad_nwi:
  s_barrier
  s_cmp_lg_u32 s3, 3
  s_cbranch_scc1 Lad_nwe
  s_cmp_ge_u32 s2, 224
  s_cbranch_scc1 Lad_nwe
  s_mul_i32 s23, s2, 5120
  s_add_u32 s44, s23, 4096
  s_waitcnt vmcnt(1)
  ds_read_b64_tr_b16 v[32:33], v29 offset:0
  ds_read_b64_tr_b16 v[34:35], v29 offset:2560
  ds_read_b64_tr_b16 v[36:37], v29 offset:32
  ds_read_b64_tr_b16 v[38:39], v29 offset:2592
  ds_read_b64_tr_b16 v[40:41], v29 offset:64
  ds_read_b64_tr_b16 v[42:43], v29 offset:2624
  ds_read_b64_tr_b16 v[44:45], v29 offset:96
  ds_read_b64_tr_b16 v[46:47], v29 offset:2656
  ds_read_b64_tr_b16 v[48:49], v29 offset:128
  ds_read_b64_tr_b16 v[50:51], v29 offset:2688
  s_waitcnt lgkmcnt(8)
  buffer_store_dwordx4 v[32:35], v5, s[28:31], s23 offen offset:0 sc1
  s_waitcnt lgkmcnt(6)
  buffer_store_dwordx4 v[36:39], v5, s[28:31], s23 offen offset:1024 sc1
  s_waitcnt lgkmcnt(4)
  buffer_store_dwordx4 v[40:43], v5, s[28:31], s23 offen offset:2048 sc1
  s_waitcnt lgkmcnt(2)
  buffer_store_dwordx4 v[44:47], v5, s[28:31], s23 offen offset:3072 sc1
  s_waitcnt lgkmcnt(0)
  buffer_store_dwordx4 v[48:51], v5, s[28:31], s44 offen offset:0 sc1
Lad_nwe:
  s_add_u32 s36, s10, 0x1300000
  s_addc_u32 s37, s11, 0
  s_mov_b32 s38, 0x230000
  s_mov_b32 s39, 0x20000
  s_barrier
  s_cmp_lg_u32 s3, 2
  s_cbranch_scc1 Lad_npk
  s_cmp_ge_u32 s2, 240
  s_cbranch_scc1 Lad_npk
  s_add_u32 s44, s45, 4096
  s_waitcnt vmcnt(0)
  ds_read_b64_tr_b16 v[32:33], v60
  ds_read_b64_tr_b16 v[34:35], v60 offset:4096
  ds_read_b64_tr_b16 v[36:37], v61
  ds_read_b64_tr_b16 v[38:39], v61 offset:4096
  ds_read_b64_tr_b16 v[40:41], v62
  ds_read_b64_tr_b16 v[42:43], v62 offset:4096
  ds_read_b64_tr_b16 v[44:45], v63
  ds_read_b64_tr_b16 v[46:47], v63 offset:4096
  ds_read_b64_tr_b16 v[48:49], v64
  ds_read_b64_tr_b16 v[50:51], v64 offset:4096
  ds_read_b64_tr_b16 v[52:53], v65
  ds_read_b64_tr_b16 v[54:55], v65 offset:4096
  ds_read_b64_tr_b16 v[56:57], v66
  ds_read_b64_tr_b16 v[58:59], v66 offset:4096
  s_waitcnt lgkmcnt(12)
  buffer_store_dwordx4 v[32:35], v5, s[36:39], s45 offen offset:0 sc1
  s_waitcnt lgkmcnt(10)
  buffer_store_dwordx4 v[36:39], v5, s[36:39], s45 offen offset:1024 sc1
  s_waitcnt lgkmcnt(8)
  buffer_store_dwordx4 v[40:43], v5, s[36:39], s45 offen offset:2048 sc1
  s_waitcnt lgkmcnt(6)
  buffer_store_dwordx4 v[44:47], v5, s[36:39], s45 offen offset:3072 sc1
  s_waitcnt lgkmcnt(4)
  buffer_store_dwordx4 v[48:51], v5, s[36:39], s44 offen offset:0 sc1
  s_waitcnt lgkmcnt(2)
  buffer_store_dwordx4 v[52:55], v5, s[36:39], s44 offen offset:1024 sc1
  s_waitcnt lgkmcnt(0)
  buffer_store_dwordx4 v[56:59], v5, s[36:39], s44 offen offset:2048 sc1
Lad_npk:
  s_mul_i32 s45, s19, 143360
  s_add_u32 s45, s45, s46
  s_waitcnt vmcnt(0) lgkmcnt(0)
  s_barrier
  s_add_u32 s23, s49, 1728
  s_add_u32 m0, s46, 0
  s_nop 0
  buffer_load_dwordx4 v14, s[32:35], s23 offen lds
  s_add_u32 m0, s46, 4096
  s_nop 0
  buffer_load_dwordx4 v15, s[32:35], s23 offen lds
  s_add_u32 m0, s46, 8192
  s_nop 0
  buffer_load_dwordx4 v16, s[32:35], s23 offen lds
  s_cmp_ge_u32 s3, 2
  s_cbranch_scc1 Lad_b1
  s_add_u32 m0, s46, 12288
  s_nop 0
  buffer_load_dwordx4 v17, s[32:35], s23 offen lds
Lad_b1:
  s_add_u32 s23, s49, 222912
  s_add_u32 m0, s46, 14336
  s_nop 0
  buffer_load_dwordx4 v14, s[32:35], s23 offen lds
  s_add_u32 m0, s46, 18432
  s_nop 0
  buffer_load_dwordx4 v15, s[32:35], s23 offen lds
  s_add_u32 m0, s46, 22528
  s_nop 0
  buffer_load_dwordx4 v16, s[32:35], s23 offen lds
  s_cmp_ge_u32 s3, 2
  s_cbranch_scc1 Lad_b2
  s_add_u32 m0, s46, 26624
  s_nop 0
  buffer_load_dwordx4 v17, s[32:35], s23 offen lds
Lad_b2:
  s_add_u32 s23, s49, 444096
  s_add_u32 m0, s46, 114688
  s_nop 0
  buffer_load_dwordx4 v14, s[32:35], s23 offen lds
  s_add_u32 m0, s46, 118784
  s_nop 0
  buffer_load_dwordx4 v15, s[32:35], s23 offen lds
  s_add_u32 m0, s46, 122880
  s_nop 0
  buffer_load_dwordx4 v16, s[32:35], s23 offen lds
  s_cmp_ge_u32 s3, 2
  s_cbranch_scc1 Lad_b3
  s_add_u32 m0, s46, 126976
  s_nop 0
  buffer_load_dwordx4 v17, s[32:35], s23 offen lds
Lad_b3:
  s_add_u32 s23, s49, 665280
  s_add_u32 m0, s46, 129024
  s_nop 0
  buffer_load_dwordx4 v14, s[32:35], s23 offen lds
  s_add_u32 m0, s46, 133120
  s_nop 0
  buffer_load_dwordx4 v15, s[32:35], s23 offen lds
  s_add_u32 m0, s46, 137216
  s_nop 0
  buffer_load_dwordx4 v16, s[32:35], s23 offen lds
  s_cmp_ge_u32 s3, 2
  s_cbranch_scc1 Lad_b4
  s_add_u32 m0, s46, 141312
  s_nop 0
  buffer_load_dwordx4 v17, s[32:35], s23 offen lds
Lad_b4:
  s_add_u32 s23, s49, 886464
  s_add_u32 m0, s46, 143360
  s_nop 0
  buffer_load_dwordx4 v14, s[32:35], s23 offen lds
  s_add_u32 m0, s46, 147456
  s_nop 0
  buffer_load_dwordx4 v15, s[32:35], s23 offen lds
  s_add_u32 m0, s46, 151552
  s_nop 0
  buffer_load_dwordx4 v16, s[32:35], s23 offen lds
  s_cmp_ge_u32 s3, 2
  s_cbranch_scc1 Lad_b5
  s_add_u32 m0, s46, 155648
  s_nop 0
  buffer_load_dwordx4 v17, s[32:35], s23 offen lds
Lad_b5:
  s_barrier
  s_add_u32 s23, s50, 0
  s_add_u32 m0, s7, 0
  s_nop 0
  buffer_load_dwordx4 v10, s[24:27], s23 offen offset:0 sc1 lds
  buffer_load_dwordx4 v11, s[24:27], s23 offen offset:1024 sc1 lds
  s_add_u32 s23, s50, 128
  s_add_u32 m0, s7, 8192
  s_nop 0
  buffer_load_dwordx4 v10, s[24:27], s23 offen offset:0 sc1 lds
  buffer_load_dwordx4 v11, s[24:27], s23 offen offset:1024 sc1 lds
  s_add_u32 s23, s50, 256
  s_add_u32 m0, s7, 16384
  s_nop 0
  buffer_load_dwordx4 v10, s[24:27], s23 offen offset:0 sc1 lds
  buffer_load_dwordx4 v11, s[24:27], s23 offen offset:1024 sc1 lds
  s_add_u32 s23, s50, 384
  s_add_u32 m0, s7, 24576
  s_nop 0
  buffer_load_dwordx4 v10, s[24:27], s23 offen offset:0 sc1 lds
  buffer_load_dwordx4 v11, s[24:27], s23 offen offset:1024 sc1 lds
  s_waitcnt vmcnt(6)
  s_barrier
  s_add_u32 s23, s50, 512
  s_add_u32 m0, s7, 32768
  s_nop 0
  buffer_load_dwordx4 v10, s[24:27], s23 offen offset:0 sc1 lds
  buffer_load_dwordx4 v11, s[24:27], s23 offen offset:1024 sc1 lds
  s_waitcnt vmcnt(6)
  s_barrier
  s_add_u32 s23, s50, 640
  s_add_u32 m0, s7, 40960
  s_nop 0
  buffer_load_dwordx4 v10, s[24:27], s23 offen offset:0 sc1 lds
  buffer_load_dwordx4 v11, s[24:27], s23 offen offset:1024 sc1 lds
  s_waitcnt vmcnt(6)
  s_barrier
  s_add_u32 s23, s50, 768
  s_add_u32 m0, s7, 49152
  s_nop 0
  buffer_load_dwordx4 v10, s[24:27], s23 offen offset:0 sc1 lds
  buffer_load_dwordx4 v11, s[24:27], s23 offen offset:1024 sc1 lds
  s_add_u32 m0, s46, 0
  s_add_u32 s23, s45, 1218560
  buffer_load_dwordx4 v5, s[36:39], s23 offen sc1 lds
  s_add_u32 m0, s46, 4096
  s_add_u32 s23, s45, 1222656
  buffer_load_dwordx4 v5, s[36:39], s23 offen sc1 lds
  s_add_u32 m0, s46, 8192
  s_add_u32 s23, s45, 1226752
  buffer_load_dwordx4 v5, s[36:39], s23 offen sc1 lds
  s_cmp_ge_u32 s3, 2
  s_cbranch_scc1 Lad_b6
  s_add_u32 m0, s46, 12288
  s_add_u32 s23, s45, 1230848
  buffer_load_dwordx4 v5, s[36:39], s23 offen sc1 lds
Lad_b6:
  s_waitcnt vmcnt(9)
  s_barrier
  s_add_u32 s23, s50, 896
  s_add_u32 m0, s7, 57344
  s_nop 0
  buffer_load_dwordx4 v10, s[24:27], s23 offen offset:0 sc1 lds
  buffer_load_dwordx4 v11, s[24:27], s23 offen offset:1024 sc1 lds
  s_add_u32 m0, s46, 14336
  s_add_u32 s23, s45, 1232896
  buffer_load_dwordx4 v5, s[36:39], s23 offen sc1 lds
  s_add_u32 m0, s46, 18432
  s_add_u32 s23, s45, 1236992
  buffer_load_dwordx4 v5, s[36:39], s23 offen sc1 lds
  s_add_u32 m0, s46, 22528
  s_add_u32 s23, s45, 1241088
  buffer_load_dwordx4 v5, s[36:39], s23 offen sc1 lds
  s_cmp_ge_u32 s3, 2
  s_cbranch_scc1 Lad_b7
  s_add_u32 m0, s46, 26624
  s_add_u32 s23, s45, 1245184
  buffer_load_dwordx4 v5, s[36:39], s23 offen sc1 lds
Lad_b7:
  s_waitcnt vmcnt(12)
  s_barrier
  s_add_u32 s23, s50, 1024
  s_add_u32 m0, s7, 65536
  s_nop 0
  buffer_load_dwordx4 v10, s[24:27], s23 offen offset:0 sc1 lds
  buffer_load_dwordx4 v11, s[24:27], s23 offen offset:1024 sc1 lds
  s_add_u32 m0, s46, 114688
  s_add_u32 s23, s45, 1247232
  buffer_load_dwordx4 v5, s[36:39], s23 offen sc1 lds
  s_add_u32 m0, s46, 118784
  s_add_u32 s23, s45, 1251328
  buffer_load_dwordx4 v5, s[36:39], s23 offen sc1 lds
  s_add_u32 m0, s46, 122880
  s_add_u32 s23, s45, 1255424
  buffer_load_dwordx4 v5, s[36:39], s23 offen sc1 lds
  s_cmp_ge_u32 s3, 2
  s_cbranch_scc1 Lad_b8
  s_add_u32 m0, s46, 126976
  s_add_u32 s23, s45, 1259520
  buffer_load_dwordx4 v5, s[36:39], s23 offen sc1 lds
Lad_b8:
  s_waitcnt vmcnt(10)
  s_barrier
  s_add_u32 s23, s50, 1152
  s_add_u32 m0, s7, 73728
  s_nop 0
  buffer_load_dwordx4 v10, s[24:27], s23 offen offset:0 sc1 lds
  buffer_load_dwordx4 v11, s[24:27], s23 offen offset:1024 sc1 lds
  s_add_u32 m0, s46, 129024
  s_add_u32 s23, s45, 1261568
  buffer_load_dwordx4 v5, s[36:39], s23 offen sc1 lds
  s_add_u32 m0, s46, 133120
  s_add_u32 s23, s45, 1265664
  buffer_load_dwordx4 v5, s[36:39], s23 offen sc1 lds
  s_add_u32 m0, s46, 137216
  s_add_u32 s23, s45, 1269760
  buffer_load_dwordx4 v5, s[36:39], s23 offen sc1 lds
  s_cmp_ge_u32 s3, 2
  s_cbranch_scc1 Lad_b9
  s_add_u32 m0, s46, 141312
  s_add_u32 s23, s45, 1273856
  buffer_load_dwordx4 v5, s[36:39], s23 offen sc1 lds
Lad_b9:
  s_waitcnt vmcnt(10)
  s_barrier
  s_add_u32 m0, s46, 143360
  s_add_u32 s23, s45, 1275904
  buffer_load_dwordx4 v5, s[36:39], s23 offen sc1 lds
  s_add_u32 m0, s46, 147456
  s_add_u32 s23, s45, 1280000
  buffer_load_dwordx4 v5, s[36:39], s23 offen sc1 lds
  s_add_u32 m0, s46, 151552
  s_add_u32 s23, s45, 1284096
  buffer_load_dwordx4 v5, s[36:39], s23 offen sc1 lds
  s_cmp_ge_u32 s3, 2
  s_cbranch_scc1 Lad_b10
  s_add_u32 m0, s46, 155648
  s_add_u32 s23, s45, 1288192
  buffer_load_dwordx4 v5, s[36:39], s23 offen sc1 lds
Lad_b10:
  s_waitcnt vmcnt(8)
  s_barrier
  s_add_u32 m0, s46, 0
  s_add_u32 s23, s45, 0
  buffer_load_dwordx4 v5, s[36:39], s23 offen sc1 lds
  s_add_u32 m0, s46, 4096
  s_add_u32 s23, s45, 4096
  buffer_load_dwordx4 v5, s[36:39], s23 offen sc1 lds
  s_add_u32 m0, s46, 8192
  s_add_u32 s23, s45, 8192
  buffer_load_dwordx4 v5, s[36:39], s23 offen sc1 lds
  s_cmp_ge_u32 s3, 2
  s_cbranch_scc1 Lad_b11
  s_add_u32 m0, s46, 12288
  s_add_u32 s23, s45, 12288
  buffer_load_dwordx4 v5, s[36:39], s23 offen sc1 lds
Lad_b11:
  s_waitcnt vmcnt(6)
  s_barrier
  s_add_u32 m0, s46, 14336
  s_add_u32 s23, s45, 14336
  buffer_load_dwordx4 v5, s[36:39], s23 offen sc1 lds
  s_add_u32 m0, s46, 18432
  s_add_u32 s23, s45, 18432
  buffer_load_dwordx4 v5, s[36:39], s23 offen sc1 lds
  s_add_u32 m0, s46, 22528
  s_add_u32 s23, s45, 22528
  buffer_load_dwordx4 v5, s[36:39], s23 offen sc1 lds
  s_cmp_ge_u32 s3, 2
  s_cbranch_scc1 Lad_b12
  s_add_u32 m0, s46, 26624
  s_add_u32 s23, s45, 26624
  buffer_load_dwordx4 v5, s[36:39], s23 offen sc1 lds
Lad_b12:
  s_waitcnt vmcnt(6)
  s_barrier
  s_add_u32 m0, s46, 114688
  s_add_u32 s23, s45, 28672
  buffer_load_dwordx4 v5, s[36:39], s23 offen sc1 lds
  s_add_u32 m0, s46, 118784
  s_add_u32 s23, s45, 32768
  buffer_load_dwordx4 v5, s[36:39], s23 offen sc1 lds
  s_add_u32 m0, s46, 122880
  s_add_u32 s23, s45, 36864
  buffer_load_dwordx4 v5, s[36:39], s23 offen sc1 lds
  s_cmp_ge_u32 s3, 2
  s_cbranch_scc1 Lad_b13
  s_add_u32 m0, s46, 126976
  s_add_u32 s23, s45, 40960
  buffer_load_dwordx4 v5, s[36:39], s23 offen sc1 lds
Lad_b13:
  s_barrier
  s_add_u32 m0, s46, 129024
  s_add_u32 s23, s45, 43008
  buffer_load_dwordx4 v5, s[36:39], s23 offen sc1 lds
  s_add_u32 m0, s46, 133120
  s_add_u32 s23, s45, 47104
  buffer_load_dwordx4 v5, s[36:39], s23 offen sc1 lds
  s_add_u32 m0, s46, 137216
  s_add_u32 s23, s45, 51200
  buffer_load_dwordx4 v5, s[36:39], s23 offen sc1 lds
  s_cmp_ge_u32 s3, 2
  s_cbranch_scc1 Lad_b14
  s_add_u32 m0, s46, 141312
  s_add_u32 s23, s45, 55296
  buffer_load_dwordx4 v5, s[36:39], s23 offen sc1 lds
Lad_b14:
  s_add_u32 m0, s46, 143360
  s_add_u32 s23, s45, 57344
  buffer_load_dwordx4 v5, s[36:39], s23 offen sc1 lds
  s_add_u32 m0, s46, 147456
  s_add_u32 s23, s45, 61440
  buffer_load_dwordx4 v5, s[36:39], s23 offen sc1 lds
  s_add_u32 m0, s46, 151552
  s_add_u32 s23, s45, 65536
  buffer_load_dwordx4 v5, s[36:39], s23 offen sc1 lds
  s_cmp_ge_u32 s3, 2
  s_cbranch_scc1 Lad_b15
  s_add_u32 m0, s46, 155648
  s_add_u32 s23, s45, 69632
  buffer_load_dwordx4 v5, s[36:39], s23 offen sc1 lds
Lad_b15:
  s_add_u32 m0, s46, 32768
  s_add_u32 s23, s45, 71680
  buffer_load_dwordx4 v5, s[36:39], s23 offen sc1 lds
  s_add_u32 m0, s46, 36864
  s_add_u32 s23, s45, 75776
  buffer_load_dwordx4 v5, s[36:39], s23 offen sc1 lds
  s_add_u32 m0, s46, 40960
  s_add_u32 s23, s45, 79872
  buffer_load_dwordx4 v5, s[36:39], s23 offen sc1 lds
  s_cmp_ge_u32 s3, 2
  s_cbranch_scc1 Lad_b16
  s_add_u32 m0, s46, 45056
  s_add_u32 s23, s45, 83968
  buffer_load_dwordx4 v5, s[36:39], s23 offen sc1 lds
Lad_b16:
  s_add_u32 m0, s46, 47104
  s_add_u32 s23, s45, 86016
  buffer_load_dwordx4 v5, s[36:39], s23 offen sc1 lds
  s_add_u32 m0, s46, 51200
  s_add_u32 s23, s45, 90112
  buffer_load_dwordx4 v5, s[36:39], s23 offen sc1 lds
  s_add_u32 m0, s46, 55296
  s_add_u32 s23, s45, 94208
  buffer_load_dwordx4 v5, s[36:39], s23 offen sc1 lds
  s_cmp_ge_u32 s3, 2
  s_cbranch_scc1 Lad_b17
  s_add_u32 m0, s46, 59392
  s_add_u32 s23, s45, 98304
  buffer_load_dwordx4 v5, s[36:39], s23 offen sc1 lds
Lad_b17:
  s_waitcnt vmcnt(12)
  s_barrier
  s_add_u32 m0, s46, 61440
  s_add_u32 s23, s45, 100352
  buffer_load_dwordx4 v5, s[36:39], s23 offen sc1 lds
  s_add_u32 m0, s46, 65536
  s_add_u32 s23, s45, 104448
  buffer_load_dwordx4 v5, s[36:39], s23 offen sc1 lds
  s_add_u32 m0, s46, 69632
  s_add_u32 s23, s45, 108544
  buffer_load_dwordx4 v5, s[36:39], s23 offen sc1 lds
  s_cmp_ge_u32 s3, 2
  s_cbranch_scc1 Lad_b18
  s_add_u32 m0, s46, 73728
  s_add_u32 s23, s45, 112640
  buffer_load_dwordx4 v5, s[36:39], s23 offen sc1 lds
Lad_b18:
  s_add_u32 m0, s46, 75776
  s_add_u32 s23, s45, 114688
  buffer_load_dwordx4 v5, s[36:39], s23 offen sc1 lds
  s_add_u32 m0, s46, 79872
  s_add_u32 s23, s45, 118784
  buffer_load_dwordx4 v5, s[36:39], s23 offen sc1 lds
  s_add_u32 m0, s46, 83968
  s_add_u32 s23, s45, 122880
  buffer_load_dwordx4 v5, s[36:39], s23 offen sc1 lds
  s_cmp_ge_u32 s3, 2
  s_cbranch_scc1 Lad_b19
  s_add_u32 m0, s46, 88064
  s_add_u32 s23, s45, 126976
  buffer_load_dwordx4 v5, s[36:39], s23 offen sc1 lds
Lad_b19:
  s_add_u32 m0, s46, 90112
  s_add_u32 s23, s45, 129024
  buffer_load_dwordx4 v5, s[36:39], s23 offen sc1 lds
  s_add_u32 m0, s46, 94208
  s_add_u32 s23, s45, 133120
  buffer_load_dwordx4 v5, s[36:39], s23 offen sc1 lds
  s_add_u32 m0, s46, 98304
  s_add_u32 s23, s45, 137216
  buffer_load_dwordx4 v5, s[36:39], s23 offen sc1 lds
  s_cmp_ge_u32 s3, 2
  s_cbranch_scc1 Lad_b20
  s_add_u32 m0, s46, 102400
  s_add_u32 s23, s45, 141312
  buffer_load_dwordx4 v5, s[36:39], s23 offen sc1 lds
Lad_b20:
  s_and_b32 s16, s3, 1
  s_lshr_b32 s17, s3, 1
  v_lshrrev_b32 v2, 3, v1
  v_and_b32 v3, 7, v1
  v_bfe_u32 v4, v2, 1, 1
  v_lshlrev_b32 v4, 2, v4
  v_xor_b32 v3, v3, v4
  v_lshlrev_b32 v2, 12, v2
  v_lshl_add_u32 v10, v3, 4, v2
  v_add_u32 v11, 31744, v10
  v_xor_b32 v12, 32, v10
  v_add_u32 v12, 63488, v12
  v_add_u32 v13, 31744, v12
  s_lshl_b32 s20, s18, 18
  s_lshl_b32 s21, s16, 17
  s_add_u32 s20, s20, s21
  s_lshl_b32 s21, s17, 11
  s_add_u32 s20, s20, s21
  s_lshl_b32 s21, s19, 6
  s_lshl_b32 s22, s17, 5
  s_add_u32 s21, s21, s22
  s_add_u32 s21, s21, s16
  s_mul_i32 s21, s21, 7168
  s_lshl_b32 s22, s17, 13
  s_lshl_b32 s23, s16, 12
  s_add_u32 s22, s22, s23
  s_mul_i32 s23, s17, 7168
  s_add_u32 s44, s16, 1
  s_mul_i32 s44, s44, 14336
  s_add_u32 s23, s23, s44
  s_add_u32 s23, s23, 65536
  s_add_u32 s49, s23, 57344
  s_cmp_eq_u32 s16, 1
  s_cselect_b32 s44, 28672, 0
  s_sub_u32 s49, s49, s44
  s_mov_b32 s53, 28672
  s_mov_b32 s24, s54
  s_mov_b32 s25, s55
  s_mov_b32 s26, 0x800000
  s_mov_b32 s27, 0x20000
  s_add_u32 s28, s10, 0xc00000
  s_addc_u32 s29, s11, 0
  s_mov_b32 s30, 0x380000
  s_mov_b32 s31, 0x20000
  s_waitcnt vmcnt(12)
  s_barrier
  s_add_u32 s44, s20, 0
  s_add_u32 m0, s22, 0
  s_nop 0
  buffer_load_dwordx4 v10, s[24:27], s44 offen offset:0 lds
  buffer_load_dwordx4 v11, s[24:27], s44 offen offset:1024 lds
  buffer_load_dwordx4 v12, s[24:27], s44 offen offset:2048 lds
  buffer_load_dwordx4 v13, s[24:27], s44 offen offset:3072 lds
  s_add_u32 s44, s20, 128
  s_add_u32 m0, s22, 16384
  s_nop 0
  buffer_load_dwordx4 v10, s[24:27], s44 offen offset:0 lds
  buffer_load_dwordx4 v11, s[24:27], s44 offen offset:1024 lds
  buffer_load_dwordx4 v12, s[24:27], s44 offen offset:2048 lds
  buffer_load_dwordx4 v13, s[24:27], s44 offen offset:3072 lds
  s_mov_b32 exec_hi, 0
  buffer_load_dword v20, v23, s[40:43], s51 offen
  s_mov_b32 exec_hi, -1
  s_waitcnt vmcnt(9)
  s_barrier
  s_barrier
  s_add_u32 s44, s20, 256
  s_add_u32 m0, s22, 32768
  s_nop 0
  buffer_load_dwordx4 v10, s[24:27], s44 offen offset:0 lds
  buffer_load_dwordx4 v11, s[24:27], s44 offen offset:1024 lds
  buffer_load_dwordx4 v12, s[24:27], s44 offen offset:2048 lds
  buffer_load_dwordx4 v13, s[24:27], s44 offen offset:3072 lds
  s_add_u32 s44, s20, 384
  s_add_u32 m0, s22, 49152
  s_nop 0
  buffer_load_dwordx4 v10, s[24:27], s44 offen offset:0 lds
  buffer_load_dwordx4 v11, s[24:27], s44 offen offset:1024 lds
  buffer_load_dwordx4 v12, s[24:27], s44 offen offset:2048 lds
  buffer_load_dwordx4 v13, s[24:27], s44 offen offset:3072 lds
  s_add_u32 s20, s20, 512
  s_add_u32 s22, s22, 0
  s_cmp_lg_u32 s3, 0
  s_cbranch_scc1 Lad_h3go
  s_add_u32 s32, s10, 0x8000
  s_addc_u32 s33, s11, 0
  s_mov_b32 s34, 0xe000
  s_mov_b32 s35, 0x20000
  s_lshl_b32 s44, s58, 11
  s_add_u32 s44, s44, 40960
  v_lshlrev_b32 v2, 7, v1
  s_mov_b32 s45, 0
  s_mov_b64 exec, 0xffff
Lad_h3p:
  buffer_load_dword v3, v2, s[32:35], s44 offen sc0 sc1
  s_add_u32 s45, s45, 1
  s_waitcnt vmcnt(0)
  v_cmp_gt_u32 vcc, 16, v3
  s_cbranch_vccz Lad_h3d
  s_cmp_lt_u32 s45, 0x400000
  s_cbranch_scc1 Lad_h3p
Lad_h3d:
  s_mov_b64 exec, -1
Lad_h3go:
  s_waitcnt vmcnt(8)
  s_barrier
  s_cmp_eq_u32 s16, 1
  s_cbranch_scc1 Lad_lh1
  s_mov_b32 m0, s23
  s_add_u32 s47, s21, 4096
  buffer_load_dwordx4 v5, s[28:31], s21 offen offset:0 sc1 lds
  buffer_load_dwordx4 v5, s[28:31], s21 offen offset:1024 sc1 lds
  buffer_load_dwordx4 v5, s[28:31], s21 offen offset:2048 sc1 lds
  buffer_load_dwordx4 v5, s[28:31], s21 offen offset:3072 sc1 lds
  s_add_u32 m0, s23, 4096
  s_nop 0
  buffer_load_dwordx4 v5, s[28:31], s47 offen offset:0 sc1 lds
  buffer_load_dwordx4 v5, s[28:31], s47 offen offset:1024 sc1 lds
  buffer_load_dwordx4 v5, s[28:31], s47 offen offset:2048 sc1 lds
  s_add_u32 s21, s21, 14336
  s_cmp_eq_u32 s23, s49
  s_cselect_b32 s44, -57344, s53
  s_add_u32 s23, s23, s44
  s_barrier
  s_mov_b32 m0, s23
  s_add_u32 s47, s21, 4096
  buffer_load_dwordx4 v5, s[28:31], s21 offen offset:0 sc1 lds
  buffer_load_dwordx4 v5, s[28:31], s21 offen offset:1024 sc1 lds
  buffer_load_dwordx4 v5, s[28:31], s21 offen offset:2048 sc1 lds
  buffer_load_dwordx4 v5, s[28:31], s21 offen offset:3072 sc1 lds
  s_add_u32 m0, s23, 4096
  s_nop 0
  buffer_load_dwordx4 v5, s[28:31], s47 offen offset:0 sc1 lds
  buffer_load_dwordx4 v5, s[28:31], s47 offen offset:1024 sc1 lds
  buffer_load_dwordx4 v5, s[28:31], s47 offen offset:2048 sc1 lds
  s_add_u32 s21, s21, 14336
  s_cmp_eq_u32 s23, s49
  s_cselect_b32 s44, -57344, s53
  s_add_u32 s23, s23, s44
  s_waitcnt vmcnt(7)
  s_barrier
  s_barrier
  s_mov_b32 m0, s23
  s_add_u32 s47, s21, 4096
  buffer_load_dwordx4 v5, s[28:31], s21 offen offset:0 sc1 lds
  buffer_load_dwordx4 v5, s[28:31], s21 offen offset:1024 sc1 lds
  buffer_load_dwordx4 v5, s[28:31], s21 offen offset:2048 sc1 lds
  buffer_load_dwordx4 v5, s[28:31], s21 offen offset:3072 sc1 lds
  s_add_u32 m0, s23, 4096
  s_nop 0
  buffer_load_dwordx4 v5, s[28:31], s47 offen offset:0 sc1 lds
  buffer_load_dwordx4 v5, s[28:31], s47 offen offset:1024 sc1 lds
  buffer_load_dwordx4 v5, s[28:31], s47 offen offset:2048 sc1 lds
  s_add_u32 s21, s21, 14336
  s_cmp_eq_u32 s23, s49
  s_cselect_b32 s44, -57344, s53
  s_add_u32 s23, s23, s44
  s_waitcnt vmcnt(7)
  s_barrier
  s_mov_b32 m0, s22
  s_nop 0
  buffer_load_dwordx4 v10, s[24:27], s20 offen offset:0 lds
  buffer_load_dwordx4 v11, s[24:27], s20 offen offset:1024 lds
  buffer_load_dwordx4 v12, s[24:27], s20 offen offset:2048 lds
  buffer_load_dwordx4 v13, s[24:27], s20 offen offset:3072 lds
  s_add_u32 s20, s20, 128
  s_add_u32 s22, s22, 16384
  s_and_b32 s22, s22, 0xffff
  s_waitcnt vmcnt(29)
  s_mov_b32 s45, 0
Lad_ll0:
  s_barrier
  s_mov_b32 m0, s23
  s_add_u32 s47, s21, 4096
  buffer_load_dwordx4 v5, s[28:31], s21 offen offset:0 sc1 lds
  buffer_load_dwordx4 v5, s[28:31], s21 offen offset:1024 sc1 lds
  buffer_load_dwordx4 v5, s[28:31], s21 offen offset:2048 sc1 lds
  buffer_load_dwordx4 v5, s[28:31], s21 offen offset:3072 sc1 lds
  s_add_u32 m0, s23, 4096
  s_nop 0
  buffer_load_dwordx4 v5, s[28:31], s47 offen offset:0 sc1 lds
  buffer_load_dwordx4 v5, s[28:31], s47 offen offset:1024 sc1 lds
  buffer_load_dwordx4 v5, s[28:31], s47 offen offset:2048 sc1 lds
  s_add_u32 s21, s21, 14336
  s_cmp_eq_u32 s23, s49
  s_cselect_b32 s44, -57344, s53
  s_add_u32 s23, s23, s44
  s_waitcnt vmcnt(11)
  s_barrier
  s_mov_b32 m0, s22
  s_nop 0
  buffer_load_dwordx4 v10, s[24:27], s20 offen offset:0 lds
  buffer_load_dwordx4 v11, s[24:27], s20 offen offset:1024 lds
  buffer_load_dwordx4 v12, s[24:27], s20 offen offset:2048 lds
  buffer_load_dwordx4 v13, s[24:27], s20 offen offset:3072 lds
  s_add_u32 s20, s20, 128
  s_add_u32 s22, s22, 16384
  s_and_b32 s22, s22, 0xffff
  s_add_u32 s45, s45, 1
  s_cmp_lt_u32 s45, 11
  s_waitcnt vmcnt(22)
  s_cbranch_scc1 Lad_ll0
  s_barrier
  s_mov_b32 m0, s23
  s_add_u32 s47, s21, 4096
  buffer_load_dwordx4 v5, s[28:31], s21 offen offset:0 sc1 lds
  buffer_load_dwordx4 v5, s[28:31], s21 offen offset:1024 sc1 lds
  buffer_load_dwordx4 v5, s[28:31], s21 offen offset:2048 sc1 lds
  buffer_load_dwordx4 v5, s[28:31], s21 offen offset:3072 sc1 lds
  s_add_u32 m0, s23, 4096
  s_nop 0
  buffer_load_dwordx4 v5, s[28:31], s47 offen offset:0 sc1 lds
  buffer_load_dwordx4 v5, s[28:31], s47 offen offset:1024 sc1 lds
  buffer_load_dwordx4 v5, s[28:31], s47 offen offset:2048 sc1 lds
  s_add_u32 s21, s21, 14336
  s_cmp_eq_u32 s23, s49
  s_cselect_b32 s44, -57344, s53
  s_add_u32 s23, s23, s44
  s_waitcnt vmcnt(11)
  s_barrier
  s_waitcnt vmcnt(18)
  s_barrier
  s_mov_b32 m0, s23
  s_add_u32 s47, s21, 4096
  buffer_load_dwordx4 v5, s[28:31], s21 offen offset:0 sc1 lds
  buffer_load_dwordx4 v5, s[28:31], s21 offen offset:1024 sc1 lds
  buffer_load_dwordx4 v5, s[28:31], s21 offen offset:2048 sc1 lds
  buffer_load_dwordx4 v5, s[28:31], s21 offen offset:3072 sc1 lds
  s_add_u32 m0, s23, 4096
  s_nop 0
  buffer_load_dwordx4 v5, s[28:31], s47 offen offset:0 sc1 lds
  buffer_load_dwordx4 v5, s[28:31], s47 offen offset:1024 sc1 lds
  buffer_load_dwordx4 v5, s[28:31], s47 offen offset:2048 sc1 lds
  s_add_u32 s21, s21, 14336
  s_cmp_eq_u32 s23, s49
  s_cselect_b32 s44, -57344, s53
  s_add_u32 s23, s23, s44
  s_waitcnt vmcnt(7)
  s_barrier
  s_waitcnt vmcnt(14)
  s_add_u32 s24, s10, 0x1530000
  s_addc_u32 s25, s11, 0
  s_mov_b32 s26, 0x118000
  s_mov_b32 s27, 0x20000
  s_mul_i32 s22, s3, 5120
  s_mul_i32 s20, s19, 143360
  s_add_u32 s21, s20, s22
  s_add_u32 s22, s22, 32768
  s_barrier
  s_add_u32 s23, s21, 75776
  s_add_u32 m0, s22, 75776
  s_nop 0
  buffer_load_dwordx4 v5, s[24:27], s23 offen offset:0 lds
  buffer_load_dwordx4 v5, s[24:27], s23 offen offset:1024 lds
  buffer_load_dwordx4 v5, s[24:27], s23 offen offset:2048 lds
  buffer_load_dwordx4 v5, s[24:27], s23 offen offset:3072 lds
  s_add_u32 s23, s21, 79872
  s_add_u32 m0, s22, 79872
  s_nop 0
  buffer_load_dwordx4 v5, s[24:27], s23 offen lds
  s_waitcnt vmcnt(5)
  s_barrier
  s_add_u32 s23, s21, 96256
  s_add_u32 m0, s22, 96256
  s_nop 0
  buffer_load_dwordx4 v5, s[24:27], s23 offen offset:0 lds
  buffer_load_dwordx4 v5, s[24:27], s23 offen offset:1024 lds
  buffer_load_dwordx4 v5, s[24:27], s23 offen offset:2048 lds
  buffer_load_dwordx4 v5, s[24:27], s23 offen offset:3072 lds
  s_add_u32 s23, s21, 100352
  s_add_u32 m0, s22, 100352
  s_nop 0
  buffer_load_dwordx4 v5, s[24:27], s23 offen lds
  s_waitcnt vmcnt(24)
  s_barrier
  s_add_u32 s23, s21, 0
  s_add_u32 m0, s22, 0
  s_nop 0
  buffer_load_dwordx4 v5, s[24:27], s23 offen offset:0 lds
  buffer_load_dwordx4 v5, s[24:27], s23 offen offset:1024 lds
  buffer_load_dwordx4 v5, s[24:27], s23 offen offset:2048 lds
  buffer_load_dwordx4 v5, s[24:27], s23 offen offset:3072 lds
  s_add_u32 s23, s21, 4096
  s_add_u32 m0, s22, 4096
  s_nop 0
  buffer_load_dwordx4 v5, s[24:27], s23 offen lds
  s_barrier
  s_add_u32 s23, s21, 20480
  s_add_u32 m0, s22, 20480
  s_nop 0
  buffer_load_dwordx4 v5, s[24:27], s23 offen offset:0 lds
  buffer_load_dwordx4 v5, s[24:27], s23 offen offset:1024 lds
  buffer_load_dwordx4 v5, s[24:27], s23 offen offset:2048 lds
  buffer_load_dwordx4 v5, s[24:27], s23 offen offset:3072 lds
  s_add_u32 s23, s21, 24576
  s_add_u32 m0, s22, 24576
  s_nop 0
  buffer_load_dwordx4 v5, s[24:27], s23 offen lds
  s_branch Lad_ltail
Lad_lh1:
  s_mov_b32 m0, s23
  s_add_u32 s47, s21, 4096
  buffer_load_dwordx4 v5, s[28:31], s21 offen offset:0 sc1 lds
  buffer_load_dwordx4 v5, s[28:31], s21 offen offset:1024 sc1 lds
  buffer_load_dwordx4 v5, s[28:31], s21 offen offset:2048 sc1 lds
  buffer_load_dwordx4 v5, s[28:31], s21 offen offset:3072 sc1 lds
  s_add_u32 m0, s23, 4096
  s_nop 0
  buffer_load_dwordx4 v5, s[28:31], s47 offen offset:0 sc1 lds
  buffer_load_dwordx4 v5, s[28:31], s47 offen offset:1024 sc1 lds
  buffer_load_dwordx4 v5, s[28:31], s47 offen offset:2048 sc1 lds
  s_add_u32 s21, s21, 14336
  s_cmp_eq_u32 s23, s49
  s_cselect_b32 s44, -57344, s53
  s_add_u32 s23, s23, s44
  s_barrier
  s_barrier
  s_mov_b32 m0, s23
  s_add_u32 s47, s21, 4096
  buffer_load_dwordx4 v5, s[28:31], s21 offen offset:0 sc1 lds
  buffer_load_dwordx4 v5, s[28:31], s21 offen offset:1024 sc1 lds
  buffer_load_dwordx4 v5, s[28:31], s21 offen offset:2048 sc1 lds
  buffer_load_dwordx4 v5, s[28:31], s21 offen offset:3072 sc1 lds
  s_add_u32 m0, s23, 4096
  s_nop 0
  buffer_load_dwordx4 v5, s[28:31], s47 offen offset:0 sc1 lds
  buffer_load_dwordx4 v5, s[28:31], s47 offen offset:1024 sc1 lds
  buffer_load_dwordx4 v5, s[28:31], s47 offen offset:2048 sc1 lds
  s_add_u32 s21, s21, 14336
  s_cmp_eq_u32 s23, s49
  s_cselect_b32 s44, -57344, s53
  s_add_u32 s23, s23, s44
  s_waitcnt vmcnt(7)
  s_barrier
  s_mov_b32 m0, s22
  s_nop 0
  buffer_load_dwordx4 v10, s[24:27], s20 offen offset:0 lds
  buffer_load_dwordx4 v11, s[24:27], s20 offen offset:1024 lds
  buffer_load_dwordx4 v12, s[24:27], s20 offen offset:2048 lds
  buffer_load_dwordx4 v13, s[24:27], s20 offen offset:3072 lds
  s_add_u32 s20, s20, 128
  s_add_u32 s22, s22, 16384
  s_and_b32 s22, s22, 0xffff
  s_barrier
  s_mov_b32 m0, s23
  s_add_u32 s47, s21, 4096
  buffer_load_dwordx4 v5, s[28:31], s21 offen offset:0 sc1 lds
  buffer_load_dwordx4 v5, s[28:31], s21 offen offset:1024 sc1 lds
  buffer_load_dwordx4 v5, s[28:31], s21 offen offset:2048 sc1 lds
  buffer_load_dwordx4 v5, s[28:31], s21 offen offset:3072 sc1 lds
  s_add_u32 m0, s23, 4096
  s_nop 0
  buffer_load_dwordx4 v5, s[28:31], s47 offen offset:0 sc1 lds
  buffer_load_dwordx4 v5, s[28:31], s47 offen offset:1024 sc1 lds
  buffer_load_dwordx4 v5, s[28:31], s47 offen offset:2048 sc1 lds
  s_add_u32 s21, s21, 14336
  s_cmp_eq_u32 s23, s49
  s_cselect_b32 s44, -57344, s53
  s_add_u32 s23, s23, s44
  s_waitcnt vmcnt(11)
  s_mov_b32 s45, 0
Lad_ll1:
  s_barrier
  s_mov_b32 m0, s22
  s_nop 0
  buffer_load_dwordx4 v10, s[24:27], s20 offen offset:0 lds
  buffer_load_dwordx4 v11, s[24:27], s20 offen offset:1024 lds
  buffer_load_dwordx4 v12, s[24:27], s20 offen offset:2048 lds
  buffer_load_dwordx4 v13, s[24:27], s20 offen offset:3072 lds
  s_add_u32 s20, s20, 128
  s_add_u32 s22, s22, 16384
  s_and_b32 s22, s22, 0xffff
  s_waitcnt vmcnt(33)
  s_barrier
  s_mov_b32 m0, s23
  s_add_u32 s47, s21, 4096
  buffer_load_dwordx4 v5, s[28:31], s21 offen offset:0 sc1 lds
  buffer_load_dwordx4 v5, s[28:31], s21 offen offset:1024 sc1 lds
  buffer_load_dwordx4 v5, s[28:31], s21 offen offset:2048 sc1 lds
  buffer_load_dwordx4 v5, s[28:31], s21 offen offset:3072 sc1 lds
  s_add_u32 m0, s23, 4096
  s_nop 0
  buffer_load_dwordx4 v5, s[28:31], s47 offen offset:0 sc1 lds
  buffer_load_dwordx4 v5, s[28:31], s47 offen offset:1024 sc1 lds
  buffer_load_dwordx4 v5, s[28:31], s47 offen offset:2048 sc1 lds
  s_add_u32 s21, s21, 14336
  s_cmp_eq_u32 s23, s49
  s_cselect_b32 s44, -57344, s53
  s_add_u32 s23, s23, s44
  s_add_u32 s45, s45, 1
  s_cmp_lt_u32 s45, 11
  s_waitcnt vmcnt(11)
  s_cbranch_scc1 Lad_ll1
  s_barrier
  s_waitcnt vmcnt(29)
  s_barrier
  s_mov_b32 m0, s23
  s_add_u32 s47, s21, 4096
  buffer_load_dwordx4 v5, s[28:31], s21 offen offset:0 sc1 lds
  buffer_load_dwordx4 v5, s[28:31], s21 offen offset:1024 sc1 lds
  buffer_load_dwordx4 v5, s[28:31], s21 offen offset:2048 sc1 lds
  buffer_load_dwordx4 v5, s[28:31], s21 offen offset:3072 sc1 lds
  s_add_u32 m0, s23, 4096
  s_nop 0
  buffer_load_dwordx4 v5, s[28:31], s47 offen offset:0 sc1 lds
  buffer_load_dwordx4 v5, s[28:31], s47 offen offset:1024 sc1 lds
  buffer_load_dwordx4 v5, s[28:31], s47 offen offset:2048 sc1 lds
  s_add_u32 s21, s21, 14336
  s_cmp_eq_u32 s23, s49
  s_cselect_b32 s44, -57344, s53
  s_add_u32 s23, s23, s44
  s_waitcnt vmcnt(7)
  s_barrier
  s_waitcnt vmcnt(25)
  s_barrier
  s_mov_b32 m0, s23
  s_add_u32 s47, s21, 4096
  buffer_load_dwordx4 v5, s[28:31], s21 offen offset:0 sc1 lds
  buffer_load_dwordx4 v5, s[28:31], s21 offen offset:1024 sc1 lds
  buffer_load_dwordx4 v5, s[28:31], s21 offen offset:2048 sc1 lds
  buffer_load_dwordx4 v5, s[28:31], s21 offen offset:3072 sc1 lds
  s_add_u32 m0, s23, 4096
  s_nop 0
  buffer_load_dwordx4 v5, s[28:31], s47 offen offset:0 sc1 lds
  buffer_load_dwordx4 v5, s[28:31], s47 offen offset:1024 sc1 lds
  buffer_load_dwordx4 v5, s[28:31], s47 offen offset:2048 sc1 lds
  s_add_u32 s21, s21, 14336
  s_cmp_eq_u32 s23, s49
  s_cselect_b32 s44, -57344, s53
  s_add_u32 s23, s23, s44
  s_waitcnt vmcnt(7)
  s_add_u32 s24, s10, 0x1530000
  s_addc_u32 s25, s11, 0
  s_mov_b32 s26, 0x118000
  s_mov_b32 s27, 0x20000
  s_mul_i32 s22, s3, 5120
  s_mul_i32 s20, s19, 143360
  s_add_u32 s21, s20, s22
  s_add_u32 s22, s22, 32768
  s_barrier
  s_add_u32 s23, s21, 75776
  s_add_u32 m0, s22, 75776
  s_nop 0
  buffer_load_dwordx4 v5, s[24:27], s23 offen offset:0 lds
  buffer_load_dwordx4 v5, s[24:27], s23 offen offset:1024 lds
  buffer_load_dwordx4 v5, s[24:27], s23 offen offset:2048 lds
  buffer_load_dwordx4 v5, s[24:27], s23 offen offset:3072 lds
  s_add_u32 s23, s21, 79872
  s_add_u32 m0, s22, 79872
  s_nop 0
  buffer_load_dwordx4 v5, s[24:27], s23 offen lds
  s_waitcnt vmcnt(26)
  s_barrier
  s_add_u32 s23, s21, 96256
  s_add_u32 m0, s22, 96256
  s_nop 0
  buffer_load_dwordx4 v5, s[24:27], s23 offen offset:0 lds
  buffer_load_dwordx4 v5, s[24:27], s23 offen offset:1024 lds
  buffer_load_dwordx4 v5, s[24:27], s23 offen offset:2048 lds
  buffer_load_dwordx4 v5, s[24:27], s23 offen offset:3072 lds
  s_add_u32 s23, s21, 100352
  s_add_u32 m0, s22, 100352
  s_nop 0
  buffer_load_dwordx4 v5, s[24:27], s23 offen lds
  s_waitcnt vmcnt(10)
  s_barrier
  s_add_u32 s23, s21, 0
  s_add_u32 m0, s22, 0
  s_nop 0
  buffer_load_dwordx4 v5, s[24:27], s23 offen offset:0 lds
  buffer_load_dwordx4 v5, s[24:27], s23 offen offset:1024 lds
  buffer_load_dwordx4 v5, s[24:27], s23 offen offset:2048 lds
  buffer_load_dwordx4 v5, s[24:27], s23 offen offset:3072 lds
  s_add_u32 s23, s21, 4096
  s_add_u32 m0, s22, 4096
  s_nop 0
  buffer_load_dwordx4 v5, s[24:27], s23 offen lds
  s_barrier
  s_add_u32 s23, s21, 20480
  s_add_u32 m0, s22, 20480
  s_nop 0
  buffer_load_dwordx4 v5, s[24:27], s23 offen offset:0 lds
  buffer_load_dwordx4 v5, s[24:27], s23 offen offset:1024 lds
  buffer_load_dwordx4 v5, s[24:27], s23 offen offset:2048 lds
  buffer_load_dwordx4 v5, s[24:27], s23 offen offset:3072 lds
  s_add_u32 s23, s21, 24576
  s_add_u32 m0, s22, 24576
  s_nop 0
  buffer_load_dwordx4 v5, s[24:27], s23 offen lds
  s_branch Lad_ltail
Lad_ltail:
  s_add_u32 s32, s10, 0x380000
  s_addc_u32 s33, s11, 0
  s_mov_b32 s34, 0x280000
  s_mov_b32 s35, 0x20000
  s_mov_b32 s40, s62
  s_mov_b32 s41, s63
  s_mov_b32 s42, 0x280000
  s_mov_b32 s43, 0x20000
  s_mov_b32 s28, s10
  s_mov_b32 s29, s11
  s_mov_b32 s30, 0x3c00
  s_mov_b32 s31, 0x20000
  s_lshl_b32 s23, s3, 6
  v_add_u32 v2, s23, v1
  v_add_u32 v3, 0, v2
  v_mul_u32_u24 v4, 6554, v3
  v_lshrrev_b32 v4, 16, v4
  v_mul_u32_u24 v6, 10, v4
  v_sub_u32 v3, v3, v6
  v_mul_u32_u24 v4, 1280, v4
  v_lshl_add_u32 v10, v3, 4, v4
  v_add_u32 v3, 256, v2
  v_mul_u32_u24 v4, 6554, v3
  v_lshrrev_b32 v4, 16, v4
  v_mul_u32_u24 v6, 10, v4
  v_sub_u32 v3, v3, v6
  v_mul_u32_u24 v4, 1280, v4
  v_lshl_add_u32 v11, v3, 4, v4
  v_add_u32 v3, 512, v2
  v_mul_u32_u24 v4, 6554, v3
  v_lshrrev_b32 v4, 16, v4
  v_mul_u32_u24 v6, 10, v4
  v_sub_u32 v3, v3, v6
  v_mul_u32_u24 v4, 1280, v4
  v_lshl_add_u32 v12, v3, 4, v4
  s_mul_i32 s44, s18, 81920
  s_mul_i32 s45, s19, 160
  s_add_u32 s44, s44, s45
  s_lshl_b32 s47, s3, 10
  s_add_u32 s47, s47, 15360
  v_add_u32 v13, s47, v5
  s_barrier
  s_add_u32 s23, s21, 107520
  s_add_u32 m0, s22, 107520
  s_nop 0
  buffer_load_dwordx4 v5, s[24:27], s23 offen offset:0 lds
  buffer_load_dwordx4 v5, s[24:27], s23 offen offset:1024 lds
  buffer_load_dwordx4 v5, s[24:27], s23 offen offset:2048 lds
  buffer_load_dwordx4 v5, s[24:27], s23 offen offset:3072 lds
  s_add_u32 s23, s21, 111616
  s_add_u32 m0, s22, 111616
  s_nop 0
  buffer_load_dwordx4 v5, s[24:27], s23 offen lds
  s_barrier
  s_add_u32 s23, s21, 40960
  s_add_u32 m0, s22, 40960
  s_nop 0
  buffer_load_dwordx4 v5, s[24:27], s23 offen offset:0 lds
  buffer_load_dwordx4 v5, s[24:27], s23 offen offset:1024 lds
  buffer_load_dwordx4 v5, s[24:27], s23 offen offset:2048 lds
  buffer_load_dwordx4 v5, s[24:27], s23 offen offset:3072 lds
  s_add_u32 s23, s21, 45056
  s_add_u32 m0, s22, 45056
  s_nop 0
  buffer_load_dwordx4 v5, s[24:27], s23 offen lds
  s_add_u32 s23, s21, 55296
  s_add_u32 m0, s22, 55296
  s_nop 0
  buffer_load_dwordx4 v5, s[24:27], s23 offen offset:0 lds
  buffer_load_dwordx4 v5, s[24:27], s23 offen offset:1024 lds
  buffer_load_dwordx4 v5, s[24:27], s23 offen offset:2048 lds
  buffer_load_dwordx4 v5, s[24:27], s23 offen offset:3072 lds
  s_add_u32 s23, s21, 59392
  s_add_u32 m0, s22, 59392
  s_nop 0
  buffer_load_dwordx4 v5, s[24:27], s23 offen lds
  s_cmp_lg_u32 s3, 3
  s_cbranch_scc1 Lad_gbdone
  s_mul_i32 s45, s19, 320
  s_add_u32 s45, s45, 12800
  s_mov_b32 m0, 160768
  s_mov_b64 exec, 0xfffff
  buffer_load_dwordx4 v5, s[28:31], s45 offen lds
  s_mov_b64 exec, -1
Lad_gbdone:
  s_lshl_b32 s22, s3, 12
  s_add_u32 s23, s20, 128000
  s_add_u32 s23, s23, s22
  s_add_u32 m0, s22, 0
  s_nop 0
  buffer_load_dwordx4 v5, s[24:27], s23 offen offset:0 lds
  buffer_load_dwordx4 v5, s[24:27], s23 offen offset:1024 lds
  buffer_load_dwordx4 v5, s[24:27], s23 offen offset:2048 lds
  s_cmp_eq_u32 s3, 3
  s_cbranch_scc1 Lad_no4
  buffer_load_dwordx4 v5, s[24:27], s23 offen offset:3072 lds
Lad_no4:
  s_add_u32 m0, s47, 0
  s_nop 0
  buffer_load_dwordx4 v10, s[32:35], s44 offen lds
  s_add_u32 m0, s47, 4096
  s_nop 0
  buffer_load_dwordx4 v11, s[32:35], s44 offen lds
  s_cmp_ge_u32 s3, 2
  s_cbranch_scc1 Lad_nox
  s_add_u32 m0, s47, 8192
  s_nop 0
  buffer_load_dwordx4 v12, s[32:35], s44 offen lds
Lad_nox:
  s_barrier
  s_waitcnt vmcnt(0)
  s_barrier
  s_barrier
  s_barrier
  s_barrier
  ds_read_b128 v[16:19], v13 offset:0
  ds_read_b128 v[20:23], v13 offset:4096
  ds_read_b128 v[24:27], v13 offset:8192
  s_waitcnt lgkmcnt(2)
  buffer_store_dwordx4 v[16:19], v10, s[40:43], s44 offen
  s_waitcnt lgkmcnt(1)
  buffer_store_dwordx4 v[20:23], v11, s[40:43], s44 offen
  s_cmp_ge_u32 s3, 2
  s_cbranch_scc1 Lad_end
  s_waitcnt lgkmcnt(0)
  buffer_store_dwordx4 v[24:27], v12, s[40:43], s44 offen
Lad_end:
  s_endpgm
.p2align 8
.type p2_tab,@object
p2_tab:
  .long 0x3f80,0x3f80,0x3f80,0x3f80,0x3f808000,0x3f808000,0x3f808000,0x3f808000
  .long 0x3f80,0x3ec43f6d,0x3f353f35,0x3f6d3ec4,0x3f808000,0x3f6dbec4,0x3f35bf35,0x3ec4bf6d
  .long 0x3f80,0x3f353f35,0x3f80248d,0x3f35bf35,0x3f808000,0x3f35bf35,0x248dbf80,0xbf35bf35
  .long 0x3f80,0x3f6d3ec4,0x3f35bf35,0xbec4bf6d,0x3f808000,0x3ec4bf6d,0xbf35bf35,0xbf6d3ec4
  .long 0x3f80,0x3f80248d,0x250dbf80,0xbf80a554,0x3f808000,0x248dbf80,0xbf80a50d,0xa5543f80
  .long 0x3f80,0x3f6dbec4,0xbf35bf35,0xbec43f6d,0x3f808000,0xbec4bf6d,0xbf353f35,0x3f6d3ec4
  .long 0x3f80,0x3f35bf35,0xbf80a554,0x3f353f35,0x3f808000,0xbf35bf35,0xa5543f80,0x3f35bf35
  .long 0x3f80,0x3ec4bf6d,0xbf353f35,0x3f6dbec4,0x3f808000,0xbf6dbec4,0x3f353f35,0xbec4bf6d
  .long 0x3f80,0x3f80,0x3f80,0x3f80,0x3f808000,0x3f808000,0x3f808000,0x3f808000
  .long 0x3f80248d,0x3f6dbec4,0x3f35bf35,0x3ec4bf6d,0x248dbf80,0xbec4bf6d,0xbf35bf35,0xbf6dbec4
  .long 0x250dbf80,0xbf35bf35,0xbf80a554,0xbf353f35,0xbf80a50d,0xbf353f35,0xa5543f80,0x3f353f35
  .long 0xbf80a554,0xbec43f6d,0x3f353f35,0x3f6dbec4,0xa5543f80,0x3f6d3ec4,0x3f35bf35,0xbec4bf6d
  .long 0x3f80,0x3f80248d,0x250dbf80,0xbf80a554,0x3f808000,0x248dbf80,0xbf80a50d,0xa5543f80
  .long 0x3f80248d,0xbec4bf6d,0xbf353f35,0x3f6d3ec4,0x248dbf80,0xbf6d3ec4,0x3f353f35,0x3ec4bf6d
  .long 0x250dbf80,0xbf353f35,0x3f80248d,0xbf35bf35,0xbf80a50d,0x3f353f35,0x248dbf80,0xbf353f35
  .long 0xbf80a554,0x3f6d3ec4,0xbf35bf35,0x3ec43f6d,0xa5543f80,0x3ec4bf6d,0xbf353f35,0x3f6dbec4
  .long 0x3f80,0x3f80,0x3f80,0x3f80,0x3f808000,0x3f808000,0x3f808000,0x3f808000
  .long 0x250dbf80,0xbec4bf6d,0xbf35bf35,0xbf6dbec4,0xbf80a50d,0xbf6d3ec4,0xbf353f35,0xbec43f6d
  .long 0x3f80,0x3f353f35,0x3f80248d,0x3f35bf35,0x3f808000,0x3f35bf35,0x248dbf80,0xbf35bf35
  .long 0x250dbf80,0xbf6dbec4,0xbf353f35,0x3ec43f6d,0xbf80a50d,0xbec43f6d,0x3f353f35,0x3f6dbec4
  .long 0x3f80,0x3f80248d,0x250dbf80,0xbf80a554,0x3f808000,0x248dbf80,0xbf80a50d,0xa5543f80
  .long 0x250dbf80,0xbf6d3ec4,0x3f353f35,0x3ec4bf6d,0xbf80a50d,0x3ec43f6d,0x3f35bf35,0xbf6dbec4
  .long 0x3f80,0x3f35bf35,0xbf80a554,0x3f353f35,0x3f808000,0xbf35bf35,0xa5543f80,0x3f35bf35
  .long 0x250dbf80,0xbec43f6d,0x3f35bf35,0xbf6d3ec4,0xbf80a50d,0x3f6d3ec4,0xbf35bf35,0x3ec43f6d
  .long 0x3f80,0x3f80,0x3f80,0x3f80,0x3f808000,0x3f808000,0x3f808000,0x3f808000
  .long 0xbf80a554,0xbf6d3ec4,0xbf353f35,0xbec43f6d,0xa5543f80,0x3ec43f6d,0x3f353f35,0x3f6d3ec4
  .long 0x250dbf80,0xbf35bf35,0xbf80a554,0xbf353f35,0xbf80a50d,0xbf353f35,0xa5543f80,0x3f353f35
  .long 0x3f80248d,0x3ec4bf6d,0xbf35bf35,0xbf6d3ec4,0x248dbf80,0xbf6dbec4,0xbf353f35,0x3ec43f6d
  .long 0x3f80,0x3f80248d,0x250dbf80,0xbf80a554,0x3f808000,0x248dbf80,0xbf80a50d,0xa5543f80
  .long 0xbf80a554,0x3ec43f6d,0x3f35bf35,0xbf6dbec4,0xa5543f80,0x3f6dbec4,0xbf35bf35,0xbec43f6d
  .long 0x250dbf80,0xbf353f35,0x3f80248d,0xbf35bf35,0xbf80a50d,0x3f353f35,0x248dbf80,0xbf353f35
  .long 0x3f80248d,0xbf6dbec4,0x3f353f35,0xbec4bf6d,0x248dbf80,0xbec43f6d,0x3f35bf35,0xbf6d3ec4
  .long 0x3f80,0x250dbf80,0x3f80,0x250dbf80,0x3f808000,0xbf80a50d,0x3f808000,0xbf80a50d
  .long 0x3f80,0xbec4bf6d,0x3f353f35,0xbf6dbec4,0x3f808000,0xbf6d3ec4,0x3f35bf35,0xbec43f6d
  .long 0x3f80,0xbf35bf35,0x3f80248d,0xbf353f35,0x3f808000,0xbf353f35,0x248dbf80,0x3f353f35
  .long 0x3f80,0xbf6dbec4,0x3f35bf35,0x3ec43f6d,0x3f808000,0xbec43f6d,0xbf35bf35,0x3f6dbec4
  .long 0x3f80,0xbf80a554,0x250dbf80,0x3f80248d,0x3f808000,0xa5543f80,0xbf80a50d,0x248dbf80
  .long 0x3f80,0xbf6d3ec4,0xbf35bf35,0x3ec4bf6d,0x3f808000,0x3ec43f6d,0xbf353f35,0xbf6dbec4
  .long 0x3f80,0xbf353f35,0xbf80a554,0xbf35bf35,0x3f808000,0x3f353f35,0xa5543f80,0xbf353f35
  .long 0x3f80,0xbec43f6d,0xbf353f35,0xbf6d3ec4,0x3f808000,0x3f6d3ec4,0x3f353f35,0x3ec43f6d
  .long 0x3f80,0x250dbf80,0x3f80,0x250dbf80,0x3f808000,0xbf80a50d,0x3f808000,0xbf80a50d
  .long 0x3f80248d,0xbf6d3ec4,0x3f35bf35,0xbec43f6d,0x248dbf80,0x3ec43f6d,0xbf35bf35,0x3f6d3ec4
  .long 0x250dbf80,0x3f353f35,0xbf80a554,0x3f35bf35,0xbf80a50d,0x3f35bf35,0xa5543f80,0xbf35bf35
  .long 0xbf80a554,0x3ec4bf6d,0x3f353f35,0xbf6d3ec4,0xa5543f80,0xbf6dbec4,0x3f35bf35,0x3ec43f6d
  .long 0x3f80,0xbf80a554,0x250dbf80,0x3f80248d,0x3f808000,0xa5543f80,0xbf80a50d,0x248dbf80
  .long 0x3f80248d,0x3ec43f6d,0xbf353f35,0xbf6dbec4,0x248dbf80,0x3f6dbec4,0x3f353f35,0xbec43f6d
  .long 0x250dbf80,0x3f35bf35,0x3f80248d,0x3f353f35,0xbf80a50d,0xbf35bf35,0x248dbf80,0x3f35bf35
  .long 0xbf80a554,0xbf6dbec4,0xbf35bf35,0xbec4bf6d,0xa5543f80,0xbec43f6d,0xbf353f35,0xbf6d3ec4
  .long 0x3f80,0x250dbf80,0x3f80,0x250dbf80,0x3f808000,0xbf80a50d,0x3f808000,0xbf80a50d
  .long 0x250dbf80,0x3ec43f6d,0xbf35bf35,0x3f6d3ec4,0xbf80a50d,0x3f6dbec4,0xbf353f35,0x3ec4bf6d
  .long 0x3f80,0xbf35bf35,0x3f80248d,0xbf353f35,0x3f808000,0xbf353f35,0x248dbf80,0x3f353f35
  .long 0x250dbf80,0x3f6d3ec4,0xbf353f35,0xbec4bf6d,0xbf80a50d,0x3ec4bf6d,0x3f353f35,0xbf6d3ec4
  .long 0x3f80,0xbf80a554,0x250dbf80,0x3f80248d,0x3f808000,0xa5543f80,0xbf80a50d,0x248dbf80
  .long 0x250dbf80,0x3f6dbec4,0x3f353f35,0xbec43f6d,0xbf80a50d,0xbec4bf6d,0x3f35bf35,0x3f6d3ec4
  .long 0x3f80,0xbf353f35,0xbf80a554,0xbf35bf35,0x3f808000,0x3f353f35,0xa5543f80,0xbf353f35
  .long 0x250dbf80,0x3ec4bf6d,0x3f35bf35,0x3f6dbec4,0xbf80a50d,0xbf6dbec4,0xbf35bf35,0xbec4bf6d
  .long 0x3f80,0x250dbf80,0x3f80,0x250dbf80,0x3f808000,0xbf80a50d,0x3f808000,0xbf80a50d
  .long 0xbf80a554,0x3f6dbec4,0xbf353f35,0x3ec4bf6d,0xa5543f80,0xbec4bf6d,0x3f353f35,0xbf6dbec4
  .long 0x250dbf80,0x3f353f35,0xbf80a554,0x3f35bf35,0xbf80a50d,0x3f35bf35,0xa5543f80,0xbf35bf35
  .long 0x3f80248d,0xbec43f6d,0xbf35bf35,0x3f6dbec4,0x248dbf80,0x3f6d3ec4,0xbf353f35,0xbec4bf6d
  .long 0x3f80,0xbf80a554,0x250dbf80,0x3f80248d,0x3f808000,0xa5543f80,0xbf80a50d,0x248dbf80
  .long 0xbf80a554,0xbec4bf6d,0x3f35bf35,0x3f6d3ec4,0xa5543f80,0xbf6d3ec4,0xbf35bf35,0x3ec4bf6d
  .long 0x250dbf80,0x3f35bf35,0x3f80248d,0x3f353f35,0xbf80a50d,0xbf35bf35,0x248dbf80,0x3f35bf35
  .long 0x3f80248d,0x3f6d3ec4,0x3f353f35,0x3ec43f6d,0x248dbf80,0x3ec4bf6d,0x3f35bf35,0x3f6dbec4
  .long 0x3f800000,0x0,0x3f800000,0x0,0x3f800000,0x0,0x3f800000,0x0
  .long 0x3f800000,0x0,0x3f800000,0x0,0x3f800000,0x0,0x3f800000,0x0
  .long 0x3f800000,0x0,0x3f800000,0x0,0x3f800000,0x0,0x3f800000,0x0
  .long 0x3f800000,0x0,0x3f800000,0x0,0x3f800000,0x0,0x3f800000,0x0
  .long 0x3f800000,0x0,0x3f7ffcd7,0x3c20d8d2,0x3f7ff35e,0x3ca0d6d6,0x3f7fe394,0x3cf13d4c
  .long 0x3f7fcd79,0x3d20cee7,0x3f7fb10f,0x3d48fb30,0x3f7f8e56,0x3d712283,0x3f7f654e,0x3d8ca1f2
  .long 0x3f7f35f9,0x3da0af2a,0x3f7f0059,0x3db4b86a,0x3f7ec46d,0x3dc8bd36,0x3f7e8238,0x3ddcbd0d
  .long 0x3f7e39bc,0x3df0b772,0x3f7deafa,0x3e0255f4,0x3f7d95f4,0x3e0c4cf7,0x3f7d3aac,0x3e164083
  .long 0x3f800000,0x0,0x3f7ff35e,0x3ca0d6d6,0x3f7fcd79,0x3d20cee7,0x3f7f8e56,0x3d712283
  .long 0x3f7f35f9,0x3da0af2a,0x3f7ec46d,0x3dc8bd36,0x3f7e39bc,0x3df0b772,0x3f7d95f4,0x3e0c4cf7
  .long 0x3f7cd925,0x3e20305b,0x3f7c0361,0x3e3403f1,0x3f7b14be,0x3e47c5c2,0x3f7a0d54,0x3e5b73dc
  .long 0x3f78ed3c,0x3e6f0c4d,0x3f77b493,0x3e814693,0x3f766377,0x3e8afa3e,0x3f74fa0b,0x3e94a031
  .long 0x3f800000,0x0,0x3f7fe394,0x3cf13d4c,0x3f7f8e56,0x3d712283,0x3f7f0059,0x3db4b86a
  .long 0x3f7e39bc,0x3df0b772,0x3f7d3aac,0x3e164083,0x3f7c0361,0x3e3403f1,0x3f7a9421,0x3e519f65
  .long 0x3f78ed3c,0x3e6f0c4d,0x3f770f11,0x3e862210,0x3f74fa0b,0x3e94a031,0x3f72ae9e,0x3ea2fd52
  .long 0x3f702d4f,0x3eb13641,0x3f6d76aa,0x3ebf47d7,0x3f6a8b4b,0x3ecd2ef3,0x3f676bd8,0x3edae880
  .long 0x3f800000,0x0,0x3f7fcd79,0x3d20cee7,0x3f7f35f9,0x3da0af2a,0x3f7e39bc,0x3df0b772
  .long 0x3f7cd925,0x3e20305b,0x3f7b14be,0x3e47c5c2,0x3f78ed3c,0x3e6f0c4d,0x3f766377,0x3e8afa3e
  .long 0x3f737871,0x3e9e377a,0x3f702d4f,0x3eb13641,0x3f6c835e,0x3ec3ef15,0x3f687c12,0x3ed65a92
  .long 0x3f641901,0x3ee87171,0x3f5f5be6,0x3efa2c90,0x3f5a46a0,0x3f05c277,0x3f54db31,0x3f0e39da
  .long 0x3f800000,0x0,0x3f7fb10f,0x3d48fb30,0x3f7ec46d,0x3dc8bd36,0x3f7d3aac,0x3e164083
  .long 0x3f7b14be,0x3e47c5c2,0x3f7853f8,0x3e78cfcc,0x3f74fa0b,0x3e94a031,0x3f710908,0x3eac7cd4
  .long 0x3f6c835e,0x3ec3ef15,0x3f676bd8,0x3edae880,0x3f61c598,0x3ef15aea,0x3f5b941a,0x3f039c3d
  .long 0x3f54db31,0x3f0e39da,0x3f4d9f02,0x3f187fc0,0x3f45e403,0x3f226799,0x3f3daef9,0x3f2beb4a
  .long 0x3f800000,0x0,0x3f7f8e56,0x3d712283,0x3f7e39bc,0x3df0b772,0x3f7c0361,0x3e3403f1
  .long 0x3f78ed3c,0x3e6f0c4d,0x3f74fa0b,0x3e94a031,0x3f702d4f,0x3eb13641,0x3f6a8b4b,0x3ecd2ef3
  .long 0x3f641901,0x3ee87171,0x3f5cdc29,0x3f0172c3,0x3f54db31,0x3f0e39da,0x3f4c1d35,0x3f1a82a4
  .long 0x3f42a9f7,0x3f26423a,0x3f3889dc,0x3f316e2c,0x3f2dc5e3,0x3f3bfc8f,0x3f226799,0x3f45e403
  .long 0x3f800000,0x0,0x3f7f654e,0x3d8ca1f2,0x3f7d95f4,0x3e0c4cf7,0x3f7a9421,0x3e519f65
  .long 0x3f766377,0x3e8afa3e,0x3f710908,0x3eac7cd4,0x3f6a8b4b,0x3ecd2ef3,0x3f62f219,0x3eece91a
  .long 0x3f5a46a0,0x3f05c277,0x3f50935b,0x3f146eba,0x3f45e403,0x3f226799,0x3f3a4582,0x3f2f9c32
  .long 0x3f2dc5e3,0x3f3bfc8f,0x3f207440,0x3f4779bc,0x3f1260b2,0x3f5205d4,0x3f039c3d,0x3f5b941a
  .long 0x3f800000,0x0,0x3f7f35f9,0x3da0af2a,0x3f7cd925,0x3e20305b,0x3f78ed3c,0x3e6f0c4d
  .long 0x3f737871,0x3e9e377a,0x3f6c835e,0x3ec3ef15,0x3f641901,0x3ee87171,0x3f5a46a0,0x3f05c277
  .long 0x3f4f1bbd,0x3f167918,0x3f42a9f7,0x3f26423a,0x3f3504f3,0x3f3504f3,0x3f26423a,0x3f42a9f7
  .long 0x3f167918,0x3f4f1bbd,0x3f05c277,0x3f5a46a0,0x3ee87171,0x3f641901,0x3ec3ef15,0x3f6c835e
  .long 0x3f800000,0x0,0x3f7f0059,0x3db4b86a,0x3f7c0361,0x3e3403f1,0x3f770f11,0x3e862210
  .long 0x3f702d4f,0x3eb13641,0x3f676bd8,0x3edae880,0x3f5cdc29,0x3f0172c3,0x3f50935b,0x3f146eba
  .long 0x3f42a9f7,0x3f26423a,0x3f333bc6,0x3f36c9a9,0x3f226799,0x3f45e403,0x3f104f0e,0x3f53731f
  .long 0x3efa2c90,0x3f5f5be6,0x3ed1c759,0x3f698690,0x3ea7bf25,0x3f71decf,0x3e78cfcc,0x3f7853f8
  .long 0x3f800000,0x0,0x3f7ec46d,0x3dc8bd36,0x3f7b14be,0x3e47c5c2,0x3f74fa0b,0x3e94a031
  .long 0x3f6c835e,0x3ec3ef15,0x3f61c598,0x3ef15aea,0x3f54db31,0x3f0e39da,0x3f45e403,0x3f226799
  .long 0x3f3504f3,0x3f3504f3,0x3f226799,0x3f45e403,0x3f0e39da,0x3f54db31,0x3ef15aea,0x3f61c598
  .long 0x3ec3ef15,0x3f6c835e,0x3e94a031,0x3f74fa0b,0x3e47c5c2,0x3f7b14be,0x3dc8bd36,0x3f7ec46d
  .long 0x3f800000,0x0,0x3f7e8238,0x3ddcbd0d,0x3f7a0d54,0x3e5b73dc,0x3f72ae9e,0x3ea2fd52
  .long 0x3f687c12,0x3ed65a92,0x3f5b941a,0x3f039c3d,0x3f4c1d35,0x3f1a82a4,0x3f3a4582,0x3f2f9c32
  .long 0x3f26423a,0x3f42a9f7,0x3f104f0e,0x3f53731f,0x3ef15aea,0x3f61c598,0x3ebf47d7,0x3f6d76aa
  .long 0x3e8afa3e,0x3f766377,0x3e2a1c3f,0x3f7c7160,0x3d712283,0x3f7f8e56,0xbd48fb30,0x3f7fb10f
  .long 0x3f800000,0x0,0x3f7e39bc,0x3df0b772,0x3f78ed3c,0x3e6f0c4d,0x3f702d4f,0x3eb13641
  .long 0x3f641901,0x3ee87171,0x3f54db31,0x3f0e39da,0x3f42a9f7,0x3f26423a,0x3f2dc5e3,0x3f3bfc8f
  .long 0x3f167918,0x3f4f1bbd,0x3efa2c90,0x3f5f5be6,0x3ec3ef15,0x3f6c835e,0x3e8afa3e,0x3f766377
  .long 0x3e20305b,0x3f7cd925,0x3d20cee7,0x3f7fcd79,0xbda0af2a,0x3f7f35f9,0xbe47c5c2,0x3f7b14be
  .long 0x3f800000,0x0,0x3f7deafa,0x3e0255f4,0x3f77b493,0x3e814693,0x3f6d76aa,0x3ebf47d7
  .long 0x3f5f5be6,0x3efa2c90,0x3f4d9f02,0x3f187fc0,0x3f3889dc,0x3f316e2c,0x3f207440,0x3f4779bc
  .long 0x3f05c277,0x3f5a46a0,0x3ed1c759,0x3f698690,0x3e94a031,0x3f74fa0b,0x3e2a1c3f,0x3f7c7160
  .long 0x3d20cee7,0x3f7fcd79,0xbdb4b86a,0x3f7f0059,0xbe5b73dc,0x3f7a0d54,0xbeac7cd4,0x3f710908
  .long 0x3f800000,0x0,0x3f7d95f4,0x3e0c4cf7,0x3f766377,0x3e8afa3e,0x3f6a8b4b,0x3ecd2ef3
  .long 0x3f5a46a0,0x3f05c277,0x3f45e403,0x3f226799,0x3f2dc5e3,0x3f3bfc8f,0x3f1260b2,0x3f5205d4
  .long 0x3ee87171,0x3f641901,0x3ea7bf25,0x3f71decf,0x3e47c5c2,0x3f7b14be,0x3d712283,0x3f7f8e56
  .long 0xbda0af2a,0x3f7f35f9,0xbe5b73dc,0x3f7a0d54,0xbeb13641,0x3f702d4f,0xbef15aea,0x3f61c598
  .long 0x3f800000,0x0,0x3f7d3aac,0x3e164083,0x3f74fa0b,0x3e94a031,0x3f676bd8,0x3edae880
  .long 0x3f54db31,0x3f0e39da,0x3f3daef9,0x3f2beb4a,0x3f226799,0x3f45e403,0x3f039c3d,0x3f5b941a
  .long 0x3ec3ef15,0x3f6c835e,0x3e78cfcc,0x3f7853f8,0x3dc8bd36,0x3f7ec46d,0xbd48fb30,0x3f7fb10f
  .long 0xbe47c5c2,0x3f7b14be,0xbeac7cd4,0x3f710908,0xbef15aea,0x3f61c598,0xbf187fc0,0x3f4d9f02
  .long 0x3f800000,0x0,0x3f7cd925,0x3e20305b,0x3f737871,0x3e9e377a,0x3f641901,0x3ee87171
  .long 0x3f4f1bbd,0x3f167918,0x3f3504f3,0x3f3504f3,0x3f167918,0x3f4f1bbd,0x3ee87171,0x3f641901
  .long 0x3e9e377a,0x3f737871,0x3e20305b,0x3f7cd925,0x248d3132,0x3f800000,0xbe20305b,0x3f7cd925
  .long 0xbe9e377a,0x3f737871,0xbee87171,0x3f641901,0xbf167918,0x3f4f1bbd,0xbf3504f3,0x3f3504f3
  .long 0x3f800000,0x0,0x3f7c7160,0x3e2a1c3f,0x3f71decf,0x3ea7bf25,0x3f609384,0x3ef5c6c5
  .long 0x3f490a88,0x3f1e7cf1,0x3f2beb4a,0x3f3daef9,0x3f0a04f8,0x3f579b8c,0x3ec8917e,0x3f6b8a3d
  .long 0x3e6f0c4d,0x3f78ed3c,0x3d8ca1f2,0x3f7f654e,0xbdc8bd36,0x3f7ec46d,0xbe862210,0x3f770f11
  .long 0xbed65a92,0x3f687c12,0xbf104f0e,0x3f53731f,0xbf316e2c,0x3f3889dc,0xbf4d9f02,0x3f187fc0
  .long 0x3f800000,0x0,0x3f7c0361,0x3e3403f1,0x3f702d4f,0x3eb13641,0x3f5cdc29,0x3f0172c3
  .long 0x3f42a9f7,0x3f26423a,0x3f226799,0x3f45e403,0x3efa2c90,0x3f5f5be6,0x3ea7bf25,0x3f71decf
  .long 0x3e20305b,0x3f7cd925,0xbca0d6d6,0x3f7ff35e,0xbe47c5c2,0x3f7b14be,0xbeba9be1,0x3f6e641a
  .long 0xbf05c277,0x3f5a46a0,0xbf2a0c73,0x3f3f5cb5,0xbf490a88,0x3f1e7cf1,0xbf61c598,0x3ef15aea
  .long 0x3f800000,0x0,0x3f7b8f2a,0x3e3de731,0x3f6e641a,0x3eba9be1,0x3f58f3c4,0x3f07e565
  .long 0x3f3bfc8f,0x3f2dc5e3,0x3f187fc0,0x3f4d9f02,0x3edf7108,0x3f6655e7,0x3e862210,0x3f770f11
  .long 0x3da0af2a,0x3f7f35f9,0xbddcbd0d,0x3f7e8238,0xbe94a031,0x3f74fa0b,0xbeece91a,0x3f62f219
  .long 0xbf1e7cf1,0x3f490a88,0xbf4105b8,0x3f28296a,0xbf5cdc29,0x3f0172c3,0xbf710908,0x3eac7cd4
  .long 0x3f800000,0x0,0x3f7b14be,0x3e47c5c2,0x3f6c835e,0x3ec3ef15,0x3f54db31,0x3f0e39da
  .long 0x3f3504f3,0x3f3504f3,0x3f0e39da,0x3f54db31,0x3ec3ef15,0x3f6c835e,0x3e47c5c2,0x3f7b14be
  .long 0x248d3132,0x3f800000,0xbe47c5c2,0x3f7b14be,0xbec3ef15,0x3f6c835e,0xbf0e39da,0x3f54db31
  .long 0xbf3504f3,0x3f3504f3,0xbf54db31,0x3f0e39da,0xbf6c835e,0x3ec3ef15,0xbf7b14be,0x3e47c5c2
  .long 0x3f800000,0x0,0x3f7a9421,0x3e519f65,0x3f6a8b4b,0x3ecd2ef3,0x3f50935b,0x3f146eba
  .long 0x3f2dc5e3,0x3f3bfc8f,0x3f039c3d,0x3f5b941a,0x3ea7bf25,0x3f71decf,0x3e0255f4,0x3f7deafa
  .long 0xbda0af2a,0x3f7f35f9,0xbe8fcefe,0x3f75b1c9,0xbef15aea,0x3f61c598,0xbf2456f1,0x3f444969
  .long 0xbf490a88,0x3f1e7cf1,0xbf653a48,0x3ee3f40d,0xbf77b493,0x3e814693,0xbf7fb10f,0x3d48fb30
  .long 0x3f800000,0x0,0x3f7a0d54,0x3e5b73dc,0x3f687c12,0x3ed65a92,0x3f4c1d35,0x3f1a82a4
  .long 0x3f26423a,0x3f42a9f7,0x3ef15aea,0x3f61c598,0x3e8afa3e,0x3f766377,0x3d712283,0x3f7f8e56
  .long 0xbe20305b,0x3f7cd925,0xbeba9be1,0x3f6e641a,0xbf0e39da,0x3f54db31,0xbf3889dc,0x3f316e2c
  .long 0xbf5a46a0,0x3f05c277,0xbf71decf,0x3ea7bf25,0xbf7e39bc,0x3df0b772,0xbf7ec46d,0xbdc8bd36
  .long 0x3f800000,0x0,0x3f79805c,0x3e6542e9,0x3f6655e7,0x3edf7108,0x3f4779bc,0x3f207440
  .long 0x3f1e7cf1,0x3f490a88,0x3edae880,0x3f676bd8,0x3e5b73dc,0x3f7a0d54,0xbc20d8d2,0x3f7ffcd7
  .long 0xbe6f0c4d,0x3f78ed3c,0xbee3f40d,0x3f653a48,0xbf226799,0x3f45e403,0xbf4a965e,0x3f1c81b9
  .long 0xbf687c12,0x3ed65a92,0xbf7a9421,0x3e519f65,0xbf7ff35e,0xbca0d6d6,0xbf7853f8,0xbe78cfcc
  .long 0x3f800000,0x0,0x3f78ed3c,0x3e6f0c4d,0x3f641901,0x3ee87171,0x3f42a9f7,0x3f26423a
  .long 0x3f167918,0x3f4f1bbd,0x3ec3ef15,0x3f6c835e,0x3e20305b,0x3f7cd925,0xbda0af2a,0x3f7f35f9
  .long 0xbe9e377a,0x3f737871,0xbf05c277,0x3f5a46a0,0xbf3504f3,0x3f3504f3,0xbf5a46a0,0x3f05c277
  .long 0xbf737871,0x3e9e377a,0xbf7f35f9,0x3da0af2a,0xbf7cd925,0xbe20305b,0xbf6c835e,0xbec3ef15
  .long 0x3f800000,0x0,0x3f7853f8,0x3e78cfcc,0x3f61c598,0x3ef15aea,0x3f3daef9,0x3f2beb4a
  .long 0x3f0e39da,0x3f54db31,0x3eac7cd4,0x3f710908,0x3dc8bd36,0x3f7ec46d,0xbe164083,0x3f7d3aac
  .long 0xbec3ef15,0x3f6c835e,0xbf187fc0,0x3f4d9f02,0xbf45e403,0x3f226799,0xbf676bd8,0x3edae880
  .long 0xbf7b14be,0x3e47c5c2,0xbf7fb10f,0xbd48fb30,0xbf74fa0b,0xbe94a031,0xbf5b941a,0xbf039c3d
  .long 0x3f800000,0x0,0x3f77b493,0x3e814693,0x3f5f5be6,0x3efa2c90,0x3f3889dc,0x3f316e2c
  .long 0x3f05c277,0x3f5a46a0,0x3e94a031,0x3f74fa0b,0x3d20cee7,0x3f7fcd79,0xbe5b73dc,0x3f7a0d54
  .long 0xbee87171,0x3f641901,0xbf2a0c73,0x3f3f5cb5,0xbf54db31,0x3f0e39da,0xbf71decf,0x3ea7bf25
  .long 0xbf7f35f9,0x3da0af2a,0xbf7c0361,0xbe3403f1,0xbf687c12,0xbed65a92,0xbf45e403,0xbf226799
  .long 0x3f800000,0x0,0x3f770f11,0x3e862210,0x3f5cdc29,0x3f0172c3,0x3f333bc6,0x3f36c9a9
  .long 0x3efa2c90,0x3f5f5be6,0x3e78cfcc,0x3f7853f8,0xbca0d6d6,0x3f7ff35e,0xbe8fcefe,0x3f75b1c9
  .long 0xbf05c277,0x3f5a46a0,0xbf3a4582,0x3f2f9c32,0xbf61c598,0x3ef15aea,0xbf79805c,0x3e6542e9
  .long 0xbf7fcd79,0xbd20cee7,0xbf743c41,0xbe996dba,0xbf579b8c,0xbf0a04f8,0xbf2beb4a,0xbf3daef9
  .long 0x3f800000,0x0,0x3f766377,0x3e8afa3e,0x3f5a46a0,0x3f05c277,0x3f2dc5e3,0x3f3bfc8f
  .long 0x3ee87171,0x3f641901,0x3e47c5c2,0x3f7b14be,0xbda0af2a,0x3f7f35f9,0xbeb13641,0x3f702d4f
  .long 0xbf167918,0x3f4f1bbd,0xbf490a88,0x3f1e7cf1,0xbf6c835e,0x3ec3ef15,0xbf7e39bc,0x3df0b772
  .long 0xbf7cd925,0xbe20305b,0xbf687c12,0xbed65a92,0xbf42a9f7,0xbf26423a,0xbf0e39da,0xbf54db31
  .long 0x3f800000,0x0,0x3f75b1c9,0x3e8fcefe,0x3f579b8c,0x3f0a04f8,0x3f28296a,0x3f4105b8
  .long 0x3ed65a92,0x3f687c12,0x3e164083,0x3f7d3aac,0xbe0c4cf7,0x3f7d95f4,0xbed1c759,0x3f698690
  .long 0xbf26423a,0x3f42a9f7,0xbf563e03,0x3f0c2124,0xbf74fa0b,0x3e94a031,0xbf7ffcd7,0x3c20d8d2
  .long 0xbf766377,0xbe8afa3e,0xbf58f3c4,0xbf07e565,0xbf2a0c73,0xbf3f5cb5,0xbedae880,0xbf676bd8
  .long 0x3f800000,0x0,0x3f74fa0b,0x3e94a031,0x3f54db31,0x3f0e39da,0x3f226799,0x3f45e403
  .long 0x3ec3ef15,0x3f6c835e,0x3dc8bd36,0x3f7ec46d,0xbe47c5c2,0x3f7b14be,0xbef15aea,0x3f61c598
  .long 0xbf3504f3,0x3f3504f3,0xbf61c598,0x3ef15aea,0xbf7b14be,0x3e47c5c2,0xbf7ec46d,0xbdc8bd36
  .long 0xbf6c835e,0xbec3ef15,0xbf45e403,0xbf226799,0xbf0e39da,0xbf54db31,0xbe94a031,0xbf74fa0b
  .long 0x3f800000,0x0,0x3f743c41,0x3e996dba,0x3f5205d4,0x3f1260b2,0x3f1c81b9,0x3f4a965e
  .long 0x3eb13641,0x3f702d4f,0x3d48fb30,0x3f7fb10f,0xbe814693,0x3f77b493,0xbf07e565,0x3f58f3c4
  .long 0xbf42a9f7,0x3f26423a,0xbf6b8a3d,0x3ec8917e,0xbf7ec46d,0x3dc8bd36,0xbf7a9421,0xbe519f65
  .long 0xbf5f5be6,0xbefa2c90,0xbf2f9c32,0xbf3a4582,0xbedf7108,0xbf6655e7,0xbe164083,0xbf7d3aac
  .long 0x3f800000,0x0,0x3f737871,0x3e9e377a,0x3f4f1bbd,0x3f167918,0x3f167918,0x3f4f1bbd
  .long 0x3e9e377a,0x3f737871,0x248d3132,0x3f800000,0xbe9e377a,0x3f737871,0xbf167918,0x3f4f1bbd
  .long 0xbf4f1bbd,0x3f167918,0xbf737871,0x3e9e377a,0xbf800000,0x250d3132,0xbf737871,0xbe9e377a
  .long 0xbf4f1bbd,0xbf167918,0xbf167918,0xbf4f1bbd,0xbe9e377a,0xbf737871,0xa553c9ca,0xbf800000
  .long 0x3f800000,0x0,0x3f72ae9e,0x3ea2fd52,0x3f4c1d35,0x3f1a82a4,0x3f104f0e,0x3f53731f
  .long 0x3e8afa3e,0x3f766377,0xbd48fb30,0x3f7fb10f,0xbeba9be1,0x3f6e641a,0xbf2456f1,0x3f444969
  .long 0xbf5a46a0,0x3f05c277,0xbf79805c,0x3e6542e9,0xbf7ec46d,0xbdc8bd36,0xbf698690,0xbed1c759
  .long 0xbf3bfc8f,0xbf2dc5e3,0xbef5c6c5,0xbf609384,0xbe3403f1,0xbf7c0361,0x3e164083,0xbf7d3aac
  .long 0x3f800000,0x0,0x3f71decf,0x3ea7bf25,0x3f490a88,0x3f1e7cf1,0x3f0a04f8,0x3f579b8c
  .long 0x3e6f0c4d,0x3f78ed3c,0xbdc8bd36,0x3f7ec46d,0xbed65a92,0x3f687c12,0xbf316e2c,0x3f3889dc
  .long 0xbf641901,0x3ee87171,0xbf7d95f4,0x3e0c4cf7,0xbf7b14be,0xbe47c5c2,0xbf5cdc29,0xbf0172c3
  .long 0xbf26423a,0xbf42a9f7,0xbeba9be1,0xbf6e641a,0xbd20cee7,0xbf7fcd79,0x3e94a031,0xbf74fa0b
  .long 0x3f800000,0x0,0x3f710908,0x3eac7cd4,0x3f45e403,0x3f226799,0x3f039c3d,0x3f5b941a
  .long 0x3e47c5c2,0x3f7b14be,0xbe164083,0x3f7d3aac,0xbef15aea,0x3f61c598,0xbf3daef9,0x3f2beb4a
  .long 0xbf6c835e,0x3ec3ef15,0xbf7fb10f,0x3d48fb30,0xbf74fa0b,0xbe94a031,0xbf4d9f02,0xbf187fc0
  .long 0xbf0e39da,0xbf54db31,0xbe78cfcc,0xbf7853f8,0x3dc8bd36,0xbf7ec46d,0x3edae880,0xbf676bd8
  .long 0x3f800000,0x0,0x3f702d4f,0x3eb13641,0x3f42a9f7,0x3f26423a,0x3efa2c90,0x3f5f5be6
  .long 0x3e20305b,0x3f7cd925,0xbe47c5c2,0x3f7b14be,0xbf05c277,0x3f5a46a0,0xbf490a88,0x3f1e7cf1
  .long 0xbf737871,0x3e9e377a,0xbf7fcd79,0xbd20cee7,0xbf6c835e,0xbec3ef15,0xbf3bfc8f,0xbf2dc5e3
  .long 0xbee87171,0xbf641901,0xbdf0b772,0xbf7e39bc,0x3e6f0c4d,0xbf78ed3c,0x3f0e39da,0xbf54db31
  .long 0x3f800000,0x0,0x3f6f4ba8,0x3eb5eb4f,0x3f3f5cb5,0x3f2a0c73,0x3eece91a,0x3f62f219
  .long 0x3df0b772,0x3f7e39bc,0xbe78cfcc,0x3f7853f8,0xbf1260b2,0x3f5205d4,0xbf53731f,0x3f104f0e
  .long 0xbf78ed3c,0x3e6f0c4d,0xbf7deafa,0xbe0255f4,0xbf61c598,0xbef15aea,0xbf28296a,0xbf4105b8
  .long 0xbeb13641,0xbf702d4f,0x3c20d8d2,0xbf7ffcd7,0x3eba9be1,0xbf6e641a,0x3f2beb4a,0xbf3daef9
  .long 0x3f800000,0x0,0x3f6e641a,0x3eba9be1,0x3f3bfc8f,0x3f2dc5e3,0x3edf7108,0x3f6655e7
  .long 0x3da0af2a,0x3f7f35f9,0xbe94a031,0x3f74fa0b,0xbf1e7cf1,0x3f490a88,0xbf5cdc29,0x3f0172c3
  .long 0xbf7cd925,0x3e20305b,0xbf7a0d54,0xbe5b73dc,0xbf54db31,0xbf0e39da,0xbf1260b2,0xbf5205d4
  .long 0xbe6f0c4d,0xbf78ed3c,0x3e0c4cf7,0xbf7d95f4,0x3efa2c90,0xbf5f5be6,0x3f45e403,0xbf226799
  .long 0x3f800000,0x0,0x3f6d76aa,0x3ebf47d7,0x3f3889dc,0x3f316e2c,0x3ed1c759,0x3f698690
  .long 0x3d20cee7,0x3f7fcd79,0xbeac7cd4,0x3f710908,0xbf2a0c73,0x3f3f5cb5,0xbf653a48,0x3ee3f40d
  .long 0xbf7f35f9,0x3da0af2a,0xbf743c41,0xbe996dba,0xbf45e403,0xbf226799,0xbef5c6c5,0xbf609384
  .long 0xbdf0b772,0xbf7e39bc,0x3e862210,0xbf770f11,0x3f1a82a4,0xbf4c1d35,0x3f5b941a,0xbf039c3d
  .long 0x3f80,0x3f80,0x3f80,0x3f80,0x3f80,0x3e203f7d,0x3e9e3f73,0x3ee83f64
  .long 0x3f80,0x3e9e3f73,0x3f163f4f,0x3f4f3f16,0x3f80,0x3ee83f64,0x3f4f3f16,0x3f7d3e20
  .long 0x3f80,0x3f163f4f,0x3f733e9e,0x3f73be9e,0x3f80,0x3f353f35,0x3f80248d,0x3f35bf35
  .long 0x3f80,0x3f4f3f16,0x3f73be9e,0x3e9ebf73,0x3f80,0x3f643ee8,0x3f4fbf16,0xbe20bf7d
  .long 0x3f80,0x3f733e9e,0x3f16bf4f,0xbf16bf4f,0x3f80,0x3f7d3e20,0x3e9ebf73,0xbf64bee8
  .long 0x3f80,0x3f80248d,0x250dbf80,0xbf80a554,0x3f80,0x3f7dbe20,0xbe9ebf73,0xbf643ee8
  .long 0x3f80,0x3f73be9e,0xbf16bf4f,0xbf163f4f,0x3f80,0x3f64bee8,0xbf4fbf16,0xbe203f7d
  .long 0x3f80,0x3f4fbf16,0xbf73be9e,0x3e9e3f73,0x3f80,0x3f35bf35,0xbf80a554,0x3f353f35
  .long 0x3f80,0x3f80,0x3f80,0x3f80,0x3f163f4f,0x3f353f35,0x3f4f3f16,0x3f643ee8
  .long 0x3f733e9e,0x3f80248d,0x3f73be9e,0x3f4fbf16,0x3f73be9e,0x3f35bf35,0x3e9ebf73,0xbe20bf7d
  .long 0x3f16bf4f,0x250dbf80,0xbf16bf4f,0xbf73be9e,0x250dbf80,0xbf35bf35,0xbf80a554,0xbf353f35
  .long 0xbf16bf4f,0xbf80a554,0xbf163f4f,0x3e9e3f73,0xbf73be9e,0xbf353f35,0x3e9e3f73,0x3f7d3e20
  .long 0xbf733e9e,0x3f80,0x3f733e9e,0x3f16bf4f,0xbf163f4f,0x3f353f35,0x3f4fbf16,0xbee8bf64
  .long 0x3f80,0x3f80248d,0x250dbf80,0xbf80a554,0x3f163f4f,0x3f35bf35,0xbf4fbf16,0xbee83f64
  .long 0x3f733e9e,0x250dbf80,0xbf733e9e,0x3f163f4f,0x3f73be9e,0xbf35bf35,0xbe9e3f73,0x3f7dbe20
  .long 0x3f16bf4f,0xbf80a554,0x3f163f4f,0x3e9ebf73,0x250dbf80,0xbf353f35,0x3f80248d,0xbf35bf35
  .long 0x3f80,0x3f80,0x3f80,0x3f80,0x3f733e9e,0x3f7d3e20,0x3f80248d,0x3f7dbe20
  .long 0x3f16bf4f,0x3e9ebf73,0x250dbf80,0xbe9ebf73,0xbf16bf4f,0xbf64bee8,0xbf80a554,0xbf643ee8
  .long 0xbf733e9e,0xbf163f4f,0x3f80,0x3f163f4f,0x3f80,0x3f353f35,0x3f80248d,0x3f35bf35
  .long 0x3f733e9e,0x3f4fbf16,0x250dbf80,0xbf4fbf16,0x3f16bf4f,0xbee8bf64,0xbf80a554,0xbee83f64
  .long 0xbf16bf4f,0xbf733e9e,0x3f80,0x3f733e9e,0xbf733e9e,0x3e203f7d,0x3f80248d,0x3e20bf7d
  .long 0x3f80,0x3f80248d,0x250dbf80,0xbf80a554,0x3f733e9e,0x3e20bf7d,0xbf80a554,0x3e203f7d
  .long 0x3f16bf4f,0xbf73be9e,0x3f80,0x3f73be9e,0xbf16bf4f,0xbee83f64,0x3f80248d,0xbee8bf64
  .long 0xbf733e9e,0x3f4f3f16,0x250dbf80,0xbf4f3f16,0x3f80,0x3f35bf35,0xbf80a554,0x3f353f35
  .long 0x3f80,0x3f80,0x3f80,0x3f80,0x3f73be9e,0x3f64bee8,0x3f4fbf16,0x3f35bf35
  .long 0xbf16bf4f,0xbf4fbf16,0xbf73be9e,0xbf80a554,0xbf163f4f,0xbe203f7d,0x3e9e3f73,0x3f353f35
  .long 0x3f733e9e,0x3f73be9e,0x3f16bf4f,0x250dbf80,0x250dbf80,0xbf35bf35,0xbf80a554,0xbf353f35
  .long 0xbf733e9e,0xbe9e3f73,0x3f163f4f,0x3f80248d,0x3f163f4f,0x3f7dbe20,0x3e9ebf73,0xbf35bf35
  .long 0x3f16bf4f,0xbf16bf4f,0xbf733e9e,0x3f80,0xbf73be9e,0xbee83f64,0x3f4f3f16,0x3f35bf35
  .long 0x3f80,0x3f80248d,0x250dbf80,0xbf80a554,0x3f73be9e,0xbee8bf64,0xbf4f3f16,0x3f353f35
  .long 0xbf16bf4f,0xbf163f4f,0x3f733e9e,0x250dbf80,0xbf163f4f,0x3f7d3e20,0xbe9ebf73,0xbf353f35
  .long 0x3f733e9e,0xbe9ebf73,0xbf163f4f,0x3f80248d,0x250dbf80,0xbf353f35,0x3f80248d,0xbf35bf35
  .long 0x3f80,0x3f80,0x3f80,0x3f80,0x3f16bf4f,0x3ee8bf64,0x3e9ebf73,0x3e20bf7d
  .long 0xbf733e9e,0xbf4f3f16,0xbf163f4f,0xbe9e3f73,0x3f733e9e,0x3f7dbe20,0x3f4fbf16,0x3ee8bf64
  .long 0xbf16bf4f,0xbf73be9e,0xbf733e9e,0xbf163f4f,0x3f80,0x3f353f35,0x3f80248d,0x3f35bf35
  .long 0x3f16bf4f,0xbe9ebf73,0xbf73be9e,0xbf4f3f16,0xbf733e9e,0xbe203f7d,0x3f4f3f16,0x3f64bee8
  .long 0x3f733e9e,0x3f16bf4f,0xbf16bf4f,0xbf733e9e,0xbf16bf4f,0xbf643ee8,0x3e9e3f73,0x3f7dbe20
  .long 0x3f80,0x3f80248d,0x250dbf80,0xbf80a554,0x3f16bf4f,0xbf64bee8,0xbe9e3f73,0x3f7d3e20
  .long 0xbf733e9e,0x3f163f4f,0x3f16bf4f,0xbf73be9e,0x3f733e9e,0xbe20bf7d,0xbf4f3f16,0x3f643ee8
  .long 0xbf16bf4f,0xbe9e3f73,0x3f73be9e,0xbf4fbf16,0x3f80,0x3f35bf35,0xbf80a554,0x3f353f35
  .long 0x3f80,0x3f80,0x3f80,0x3f80,0x250dbf80,0xbe20bf7d,0xbe9ebf73,0xbee8bf64
  .long 0x3f80,0x3e9e3f73,0x3f163f4f,0x3f4f3f16,0x250dbf80,0xbee8bf64,0xbf4fbf16,0xbf7dbe20
  .long 0x3f80,0x3f163f4f,0x3f733e9e,0x3f73be9e,0x250dbf80,0xbf35bf35,0xbf80a554,0xbf353f35
  .long 0x3f80,0x3f4f3f16,0x3f73be9e,0x3e9ebf73,0x250dbf80,0xbf64bee8,0xbf4f3f16,0x3e203f7d
  .long 0x3f80,0x3f733e9e,0x3f16bf4f,0xbf16bf4f,0x250dbf80,0xbf7dbe20,0xbe9e3f73,0x3f643ee8
  .long 0x3f80,0x3f80248d,0x250dbf80,0xbf80a554,0x250dbf80,0xbf7d3e20,0x3e9e3f73,0x3f64bee8
  .long 0x3f80,0x3f73be9e,0xbf16bf4f,0xbf163f4f,0x250dbf80,0xbf643ee8,0x3f4f3f16,0x3e20bf7d
  .long 0x3f80,0x3f4fbf16,0xbf73be9e,0x3e9e3f73,0x250dbf80,0xbf353f35,0x3f80248d,0xbf35bf35
  .long 0x3f80,0x3f80,0x3f80,0x3f80,0xbf16bf4f,0xbf35bf35,0xbf4fbf16,0xbf64bee8
  .long 0x3f733e9e,0x3f80248d,0x3f73be9e,0x3f4fbf16,0xbf733e9e,0xbf353f35,0xbe9e3f73,0x3e203f7d
  .long 0x3f16bf4f,0x250dbf80,0xbf16bf4f,0xbf73be9e,0x3f80,0x3f353f35,0x3f80248d,0x3f35bf35
  .long 0xbf16bf4f,0xbf80a554,0xbf163f4f,0x3e9e3f73,0x3f733e9e,0x3f35bf35,0xbe9ebf73,0xbf7dbe20
  .long 0xbf733e9e,0x3f80,0x3f733e9e,0x3f16bf4f,0x3f16bf4f,0xbf35bf35,0xbf4f3f16,0x3ee83f64
  .long 0x3f80,0x3f80248d,0x250dbf80,0xbf80a554,0xbf16bf4f,0xbf353f35,0x3f4f3f16,0x3ee8bf64
  .long 0x3f733e9e,0x250dbf80,0xbf733e9e,0x3f163f4f,0xbf733e9e,0x3f353f35,0x3e9ebf73,0xbf7d3e20
  .long 0x3f16bf4f,0xbf80a554,0x3f163f4f,0x3e9ebf73,0x3f80,0x3f35bf35,0xbf80a554,0x3f353f35
  .long 0x3f80,0x3f80,0x3f80,0x3f80,0xbf73be9e,0xbf7dbe20,0xbf80a554,0xbf7d3e20
  .long 0x3f16bf4f,0x3e9ebf73,0x250dbf80,0xbe9ebf73,0x3f163f4f,0x3f643ee8,0x3f80248d,0x3f64bee8
  .long 0xbf733e9e,0xbf163f4f,0x3f80,0x3f163f4f,0x250dbf80,0xbf35bf35,0xbf80a554,0xbf353f35
  .long 0x3f733e9e,0x3f4fbf16,0x250dbf80,0xbf4fbf16,0xbf163f4f,0x3ee83f64,0x3f80248d,0x3ee8bf64
  .long 0xbf16bf4f,0xbf733e9e,0x3f80,0x3f733e9e,0x3f73be9e,0xbe20bf7d,0xbf80a554,0xbe203f7d
  .long 0x3f80,0x3f80248d,0x250dbf80,0xbf80a554,0xbf73be9e,0xbe203f7d,0x3f80248d,0xbe20bf7d
  .long 0x3f16bf4f,0xbf73be9e,0x3f80,0x3f73be9e,0x3f163f4f,0x3ee8bf64,0xbf80a554,0x3ee83f64
  .long 0xbf733e9e,0x3f4f3f16,0x250dbf80,0xbf4f3f16,0x250dbf80,0xbf353f35,0x3f80248d,0xbf35bf35
  .long 0x3f80,0x3f80,0x3f80,0x3f80,0xbf733e9e,0xbf643ee8,0xbf4f3f16,0xbf353f35
  .long 0xbf16bf4f,0xbf4fbf16,0xbf73be9e,0xbf80a554,0x3f16bf4f,0x3e20bf7d,0xbe9ebf73,0xbf35bf35
  .long 0x3f733e9e,0x3f73be9e,0x3f16bf4f,0x250dbf80,0x3f80,0x3f353f35,0x3f80248d,0x3f35bf35
  .long 0xbf733e9e,0xbe9e3f73,0x3f163f4f,0x3f80248d,0xbf16bf4f,0xbf7d3e20,0xbe9e3f73,0x3f353f35
  .long 0x3f16bf4f,0xbf16bf4f,0xbf733e9e,0x3f80,0x3f733e9e,0x3ee8bf64,0xbf4fbf16,0xbf353f35
  .long 0x3f80,0x3f80248d,0x250dbf80,0xbf80a554,0xbf733e9e,0x3ee83f64,0x3f4fbf16,0xbf35bf35
  .long 0xbf16bf4f,0xbf163f4f,0x3f733e9e,0x250dbf80,0x3f16bf4f,0xbf7dbe20,0x3e9e3f73,0x3f35bf35
  .long 0x3f733e9e,0xbe9ebf73,0xbf163f4f,0x3f80248d,0x3f80,0x3f35bf35,0xbf80a554,0x3f353f35
  .long 0x3f80,0x3f80,0x3f80,0x3f80,0xbf163f4f,0xbee83f64,0xbe9e3f73,0xbe203f7d
  .long 0xbf733e9e,0xbf4f3f16,0xbf163f4f,0xbe9e3f73,0xbf73be9e,0xbf7d3e20,0xbf4f3f16,0xbee83f64
  .long 0xbf16bf4f,0xbf73be9e,0xbf733e9e,0xbf163f4f,0x250dbf80,0xbf35bf35,0xbf80a554,0xbf353f35
  .long 0x3f16bf4f,0xbe9ebf73,0xbf73be9e,0xbf4f3f16,0x3f73be9e,0x3e20bf7d,0xbf4fbf16,0xbf643ee8
  .long 0x3f733e9e,0x3f16bf4f,0xbf16bf4f,0xbf733e9e,0x3f163f4f,0x3f64bee8,0xbe9ebf73,0xbf7d3e20
  .long 0x3f80,0x3f80248d,0x250dbf80,0xbf80a554,0xbf163f4f,0x3f643ee8,0x3e9ebf73,0xbf7dbe20
  .long 0xbf733e9e,0x3f163f4f,0x3f16bf4f,0xbf73be9e,0xbf73be9e,0x3e203f7d,0x3f4fbf16,0xbf64bee8
  .long 0xbf16bf4f,0xbe9e3f73,0x3f73be9e,0xbf4fbf16,0x250dbf80,0xbf353f35,0x3f80248d,0xbf35bf35
  .long 0x0,0x0,0x0,0x0,0x0,0x0,0x0,0x0
  .long 0x0,0x0,0x0,0x0,0x0,0x0,0x0,0x0
  .long 0x0,0x0,0x0,0x0,0x0,0x0,0x0,0x0
  .long 0x0,0x0,0x0,0x0,0x0,0x0,0x0,0x0
  .long 0x0,0x0,0x0,0x0,0x0,0x0,0x0,0x0
  .long 0x0,0x0,0x0,0x0,0x0,0x0,0x0,0x0
  .long 0x0,0x0,0x0,0x0,0x0,0x0,0x0,0x0
  .long 0x0,0x0,0x0,0x0,0x0,0x0,0x0,0x0
  .long 0x0,0x0,0x0,0x0,0x0,0x0,0x0,0x0
  .long 0x0,0x0,0x0,0x0,0x0,0x0,0x0,0x0
  .long 0x0,0x0,0x0,0x0,0x0,0x0,0x0,0x0
  .long 0x0,0x0,0x0,0x0,0x0,0x0,0x0,0x0
  .long 0x0,0x0,0x0,0x0,0x0,0x0,0x0,0x0
  .long 0x0,0x0,0x0,0x0,0x0,0x0,0x0,0x0
  .long 0x0,0x0,0x0,0x0,0x0,0x0,0x0,0x0
  .long 0x0,0x0,0x0,0x0,0x0,0x0,0x0,0x0
  .long 0x3f80,0x3f16bf4f,0xbf733e9e,0x3f733e9e,0x3f80,0x3ee8bf64,0xbf4f3f16,0x3f7dbe20
  .long 0x3f80,0x3e9ebf73,0xbf163f4f,0x3f4fbf16,0x3f80,0x3e20bf7d,0xbe9e3f73,0x3ee8bf64
  .long 0x3f80,0x250dbf80,0x3f80,0x250dbf80,0x3f80,0xbe20bf7d,0x3e9e3f73,0xbee8bf64
  .long 0x3f80,0xbe9ebf73,0x3f163f4f,0xbf4fbf16,0x3f80,0xbee8bf64,0x3f4f3f16,0xbf7dbe20
  .long 0x3f80,0xbf16bf4f,0x3f733e9e,0xbf733e9e,0x3f80,0xbf35bf35,0x3f80248d,0xbf353f35
  .long 0x3f80,0xbf4fbf16,0x3f73be9e,0xbe9e3f73,0x3f80,0xbf64bee8,0x3f4fbf16,0x3e203f7d
  .long 0x3f80,0xbf73be9e,0x3f16bf4f,0x3f163f4f,0x3f80,0xbf7dbe20,0x3e9ebf73,0x3f643ee8
  .long 0x3f80,0xbf80a554,0x250dbf80,0x3f80248d,0x3f80,0xbf7d3e20,0xbe9ebf73,0x3f64bee8
  .long 0xbf16bf4f,0x3f80,0x3f16bf4f,0xbf733e9e,0xbf73be9e,0x3f353f35,0xbe9ebf73,0xbe203f7d
  .long 0xbf733e9e,0x3f80248d,0xbf73be9e,0x3f4f3f16,0xbf163f4f,0x3f35bf35,0xbf4f3f16,0x3f64bee8
  .long 0x3f80,0x250dbf80,0x3f80,0x250dbf80,0x3f163f4f,0xbf35bf35,0x3f4f3f16,0xbf64bee8
  .long 0x3f733e9e,0xbf80a554,0x3f73be9e,0xbf4f3f16,0x3f73be9e,0xbf353f35,0x3e9ebf73,0x3e203f7d
  .long 0x3f16bf4f,0x3f80,0xbf16bf4f,0x3f733e9e,0x250dbf80,0x3f353f35,0xbf80a554,0x3f35bf35
  .long 0xbf16bf4f,0x3f80248d,0xbf163f4f,0xbe9ebf73,0xbf73be9e,0x3f35bf35,0x3e9e3f73,0xbf7dbe20
  .long 0xbf733e9e,0x250dbf80,0x3f733e9e,0xbf163f4f,0xbf163f4f,0xbf35bf35,0x3f4fbf16,0x3ee83f64
  .long 0x3f80,0xbf80a554,0x250dbf80,0x3f80248d,0x3f163f4f,0xbf353f35,0xbf4fbf16,0x3ee8bf64
  .long 0x3f733e9e,0xbf16bf4f,0x3f80,0x3f16bf4f,0x3f16bf4f,0xbf643ee8,0x3f80248d,0xbf64bee8
  .long 0xbf16bf4f,0x3e9e3f73,0x250dbf80,0xbe9e3f73,0xbf733e9e,0x3f7dbe20,0xbf80a554,0x3f7d3e20
  .long 0x3f80,0x250dbf80,0x3f80,0x250dbf80,0x3f733e9e,0xbf7dbe20,0x3f80248d,0xbf7d3e20
  .long 0x3f16bf4f,0xbe9e3f73,0x250dbf80,0x3e9e3f73,0xbf16bf4f,0x3f643ee8,0xbf80a554,0x3f64bee8
  .long 0xbf733e9e,0x3f16bf4f,0x3f80,0xbf16bf4f,0x3f80,0xbf35bf35,0x3f80248d,0xbf353f35
  .long 0x3f733e9e,0xbf4f3f16,0x250dbf80,0x3f4f3f16,0x3f16bf4f,0x3ee83f64,0xbf80a554,0x3ee8bf64
  .long 0xbf16bf4f,0x3f73be9e,0x3f80,0xbf73be9e,0xbf733e9e,0xbe20bf7d,0x3f80248d,0xbe203f7d
  .long 0x3f80,0xbf80a554,0x250dbf80,0x3f80248d,0x3f733e9e,0xbe203f7d,0xbf80a554,0xbe20bf7d
  .long 0xbf733e9e,0x3f733e9e,0xbf16bf4f,0x3f80,0x3f163f4f,0xbe20bf7d,0xbe9e3f73,0x3f35bf35
  .long 0x3f16bf4f,0xbf4f3f16,0x3f73be9e,0xbf80a554,0xbf73be9e,0x3f643ee8,0xbf4fbf16,0x3f353f35
  .long 0x3f80,0x250dbf80,0x3f80,0x250dbf80,0x3f73be9e,0xbf643ee8,0x3f4fbf16,0xbf353f35
  .long 0xbf16bf4f,0x3f4f3f16,0xbf73be9e,0x3f80248d,0xbf163f4f,0x3e20bf7d,0x3e9e3f73,0xbf35bf35
  .long 0x3f733e9e,0xbf733e9e,0x3f16bf4f,0x3f80,0x250dbf80,0x3f353f35,0xbf80a554,0x3f35bf35
  .long 0xbf733e9e,0x3e9ebf73,0x3f163f4f,0xbf80a554,0x3f163f4f,0xbf7d3e20,0x3e9ebf73,0x3f353f35
  .long 0x3f16bf4f,0x3f163f4f,0xbf733e9e,0x250dbf80,0xbf73be9e,0x3ee8bf64,0x3f4f3f16,0xbf353f35
  .long 0x3f80,0xbf80a554,0x250dbf80,0x3f80248d,0x3f73be9e,0x3ee83f64,0xbf4f3f16,0xbf35bf35
  .long 0x3f16bf4f,0xbf733e9e,0x3f733e9e,0xbf16bf4f,0xbf733e9e,0x3f7d3e20,0xbf4fbf16,0x3ee83f64
  .long 0x3f733e9e,0xbf4fbf16,0x3f163f4f,0xbe9ebf73,0xbf16bf4f,0x3ee83f64,0xbe9ebf73,0x3e203f7d
  .long 0x3f80,0x250dbf80,0x3f80,0x250dbf80,0x3f16bf4f,0xbee83f64,0x3e9ebf73,0xbe203f7d
  .long 0xbf733e9e,0x3f4fbf16,0xbf163f4f,0x3e9ebf73,0x3f733e9e,0xbf7d3e20,0x3f4fbf16,0xbee83f64
  .long 0xbf16bf4f,0x3f733e9e,0xbf733e9e,0x3f16bf4f,0x3f80,0xbf35bf35,0x3f80248d,0xbf353f35
  .long 0x3f16bf4f,0x3e9e3f73,0xbf73be9e,0x3f4fbf16,0xbf733e9e,0x3e20bf7d,0x3f4f3f16,0xbf643ee8
  .long 0x3f733e9e,0xbf163f4f,0xbf16bf4f,0x3f73be9e,0xbf16bf4f,0x3f64bee8,0x3e9e3f73,0xbf7d3e20
  .long 0x3f80,0xbf80a554,0x250dbf80,0x3f80248d,0x3f16bf4f,0x3f643ee8,0xbe9e3f73,0xbf7dbe20
  .long 0x3f80,0x3f16bf4f,0xbf733e9e,0x3f733e9e,0x250dbf80,0xbee83f64,0x3f4fbf16,0xbf7d3e20
  .long 0x3f80,0x3e9ebf73,0xbf163f4f,0x3f4fbf16,0x250dbf80,0xbe203f7d,0x3e9ebf73,0xbee83f64
  .long 0x3f80,0x250dbf80,0x3f80,0x250dbf80,0x250dbf80,0x3e203f7d,0xbe9ebf73,0x3ee83f64
  .long 0x3f80,0xbe9ebf73,0x3f163f4f,0xbf4fbf16,0x250dbf80,0x3ee83f64,0xbf4fbf16,0x3f7d3e20
  .long 0x3f80,0xbf16bf4f,0x3f733e9e,0xbf733e9e,0x250dbf80,0x3f353f35,0xbf80a554,0x3f35bf35
  .long 0x3f80,0xbf4fbf16,0x3f73be9e,0xbe9e3f73,0x250dbf80,0x3f643ee8,0xbf4f3f16,0xbe20bf7d
  .long 0x3f80,0xbf73be9e,0x3f16bf4f,0x3f163f4f,0x250dbf80,0x3f7d3e20,0xbe9e3f73,0xbf64bee8
  .long 0x3f80,0xbf80a554,0x250dbf80,0x3f80248d,0x250dbf80,0x3f7dbe20,0x3e9e3f73,0xbf643ee8
  .long 0xbf16bf4f,0x3f80,0x3f16bf4f,0xbf733e9e,0x3f733e9e,0xbf35bf35,0x3e9e3f73,0x3e20bf7d
  .long 0xbf733e9e,0x3f80248d,0xbf73be9e,0x3f4f3f16,0x3f16bf4f,0xbf353f35,0x3f4fbf16,0xbf643ee8
  .long 0x3f80,0x250dbf80,0x3f80,0x250dbf80,0xbf16bf4f,0x3f353f35,0xbf4fbf16,0x3f643ee8
  .long 0x3f733e9e,0xbf80a554,0x3f73be9e,0xbf4f3f16,0xbf733e9e,0x3f35bf35,0xbe9e3f73,0xbe20bf7d
  .long 0x3f16bf4f,0x3f80,0xbf16bf4f,0x3f733e9e,0x3f80,0xbf35bf35,0x3f80248d,0xbf353f35
  .long 0xbf16bf4f,0x3f80248d,0xbf163f4f,0xbe9ebf73,0x3f733e9e,0xbf353f35,0xbe9ebf73,0x3f7d3e20
  .long 0xbf733e9e,0x250dbf80,0x3f733e9e,0xbf163f4f,0x3f16bf4f,0x3f353f35,0xbf4f3f16,0xbee8bf64
  .long 0x3f80,0xbf80a554,0x250dbf80,0x3f80248d,0xbf16bf4f,0x3f35bf35,0x3f4f3f16,0xbee83f64
  .long 0x3f733e9e,0xbf16bf4f,0x3f80,0x3f16bf4f,0xbf163f4f,0x3f64bee8,0xbf80a554,0x3f643ee8
  .long 0xbf16bf4f,0x3e9e3f73,0x250dbf80,0xbe9e3f73,0x3f73be9e,0xbf7d3e20,0x3f80248d,0xbf7dbe20
  .long 0x3f80,0x250dbf80,0x3f80,0x250dbf80,0xbf73be9e,0x3f7d3e20,0xbf80a554,0x3f7dbe20
  .long 0x3f16bf4f,0xbe9e3f73,0x250dbf80,0x3e9e3f73,0x3f163f4f,0xbf64bee8,0x3f80248d,0xbf643ee8
  .long 0xbf733e9e,0x3f16bf4f,0x3f80,0xbf16bf4f,0x250dbf80,0x3f353f35,0xbf80a554,0x3f35bf35
  .long 0x3f733e9e,0xbf4f3f16,0x250dbf80,0x3f4f3f16,0xbf163f4f,0xbee8bf64,0x3f80248d,0xbee83f64
  .long 0xbf16bf4f,0x3f73be9e,0x3f80,0xbf73be9e,0x3f73be9e,0x3e203f7d,0xbf80a554,0x3e20bf7d
  .long 0x3f80,0xbf80a554,0x250dbf80,0x3f80248d,0xbf73be9e,0x3e20bf7d,0x3f80248d,0x3e203f7d
  .long 0xbf733e9e,0x3f733e9e,0xbf16bf4f,0x3f80,0xbf16bf4f,0x3e203f7d,0x3e9ebf73,0xbf353f35
  .long 0x3f16bf4f,0xbf4f3f16,0x3f73be9e,0xbf80a554,0x3f733e9e,0xbf64bee8,0x3f4f3f16,0xbf35bf35
  .long 0x3f80,0x250dbf80,0x3f80,0x250dbf80,0xbf733e9e,0x3f64bee8,0xbf4f3f16,0x3f35bf35
  .long 0xbf16bf4f,0x3f4f3f16,0xbf73be9e,0x3f80248d,0x3f16bf4f,0xbe203f7d,0xbe9ebf73,0x3f353f35
  .long 0x3f733e9e,0xbf733e9e,0x3f16bf4f,0x3f80,0x3f80,0xbf35bf35,0x3f80248d,0xbf353f35
  .long 0xbf733e9e,0x3e9ebf73,0x3f163f4f,0xbf80a554,0xbf16bf4f,0x3f7dbe20,0xbe9e3f73,0xbf35bf35
  .long 0x3f16bf4f,0x3f163f4f,0xbf733e9e,0x250dbf80,0x3f733e9e,0xbee83f64,0xbf4fbf16,0x3f35bf35
  .long 0x3f80,0xbf80a554,0x250dbf80,0x3f80248d,0xbf733e9e,0xbee8bf64,0x3f4fbf16,0x3f353f35
  .long 0x3f16bf4f,0xbf733e9e,0x3f733e9e,0xbf16bf4f,0x3f73be9e,0xbf7dbe20,0x3f4f3f16,0xbee8bf64
  .long 0x3f733e9e,0xbf4fbf16,0x3f163f4f,0xbe9ebf73,0x3f163f4f,0xbee8bf64,0x3e9e3f73,0xbe20bf7d
  .long 0x3f80,0x250dbf80,0x3f80,0x250dbf80,0xbf163f4f,0x3ee8bf64,0xbe9e3f73,0x3e20bf7d
  .long 0xbf733e9e,0x3f4fbf16,0xbf163f4f,0x3e9ebf73,0xbf73be9e,0x3f7dbe20,0xbf4f3f16,0x3ee8bf64
  .long 0xbf16bf4f,0x3f733e9e,0xbf733e9e,0x3f16bf4f,0x250dbf80,0x3f353f35,0xbf80a554,0x3f35bf35
  .long 0x3f16bf4f,0x3e9e3f73,0xbf73be9e,0x3f4fbf16,0x3f73be9e,0xbe203f7d,0xbf4fbf16,0x3f64bee8
  .long 0x3f733e9e,0xbf163f4f,0xbf16bf4f,0x3f73be9e,0x3f163f4f,0xbf643ee8,0xbe9ebf73,0x3f7dbe20
  .long 0x3f80,0xbf80a554,0x250dbf80,0x3f80248d,0xbf163f4f,0xbf64bee8,0x3e9ebf73,0x3f7d3e20
  .long 0x0,0x0,0x0,0x0,0x0,0x0,0x0,0x0
  .long 0x0,0x0,0x0,0x0,0x0,0x0,0x0,0x0
  .long 0x0,0x0,0x0,0x0,0x0,0x0,0x0,0x0
  .long 0x0,0x0,0x0,0x0,0x0,0x0,0x0,0x0
  .long 0x0,0x0,0x0,0x0,0x0,0x0,0x0,0x0
  .long 0x0,0x0,0x0,0x0,0x0,0x0,0x0,0x0
  .long 0x0,0x0,0x0,0x0,0x0,0x0,0x0,0x0
  .long 0x0,0x0,0x0,0x0,0x0,0x0,0x0,0x0
  .long 0x0,0x0,0x0,0x0,0x0,0x0,0x0,0x0
  .long 0x0,0x0,0x0,0x0,0x0,0x0,0x0,0x0
  .long 0x0,0x0,0x0,0x0,0x0,0x0,0x0,0x0
  .long 0x0,0x0,0x0,0x0,0x0,0x0,0x0,0x0
  .long 0x0,0x0,0x0,0x0,0x0,0x0,0x0,0x0
  .long 0x0,0x0,0x0,0x0,0x0,0x0,0x0,0x0
  .long 0x0,0x0,0x0,0x0,0x0,0x0,0x0,0x0
  .long 0x0,0x0,0x0,0x0,0x0,0x0,0x0,0x0
  .long 0x3f80,0xbf733e9e,0xbf16bf4f,0x3f16bf4f,0x3f80,0xbf643ee8,0xbf4fbf16,0x3e20bf7d
  .long 0x3f80,0xbf4f3f16,0xbf73be9e,0xbe9ebf73,0x3f80,0xbf353f35,0xbf80a554,0xbf35bf35
  .long 0x3f80,0xbf163f4f,0xbf733e9e,0xbf73be9e,0x3f80,0xbee83f64,0xbf4f3f16,0xbf7d3e20
  .long 0x3f80,0xbe9e3f73,0xbf163f4f,0xbf4f3f16,0x3f80,0xbe203f7d,0xbe9e3f73,0xbee83f64
  .long 0x3f80,0x3f80,0x3f80,0x3f80,0x3f80,0x3e203f7d,0x3e9e3f73,0x3ee83f64
  .long 0x3f80,0x3e9e3f73,0x3f163f4f,0x3f4f3f16,0x3f80,0x3ee83f64,0x3f4f3f16,0x3f7d3e20
  .long 0x3f80,0x3f163f4f,0x3f733e9e,0x3f73be9e,0x3f80,0x3f353f35,0x3f80248d,0x3f35bf35
  .long 0x3f80,0x3f4f3f16,0x3f73be9e,0x3e9ebf73,0x3f80,0x3f643ee8,0x3f4fbf16,0xbe20bf7d
  .long 0x3f733e9e,0x3f80,0xbf733e9e,0xbf16bf4f,0x3f73be9e,0x3f353f35,0xbe9e3f73,0xbf7d3e20
  .long 0x3f16bf4f,0x3f80248d,0x3f163f4f,0xbe9e3f73,0x250dbf80,0x3f35bf35,0x3f80248d,0x3f353f35
  .long 0xbf16bf4f,0x250dbf80,0x3f16bf4f,0x3f73be9e,0xbf73be9e,0xbf35bf35,0xbe9ebf73,0x3e20bf7d
  .long 0xbf733e9e,0xbf80a554,0xbf73be9e,0xbf4fbf16,0xbf163f4f,0xbf353f35,0xbf4f3f16,0xbf643ee8
  .long 0x3f80,0x3f80,0x3f80,0x3f80,0x3f163f4f,0x3f353f35,0x3f4f3f16,0x3f643ee8
  .long 0x3f733e9e,0x3f80248d,0x3f73be9e,0x3f4fbf16,0x3f73be9e,0x3f35bf35,0x3e9ebf73,0xbe20bf7d
  .long 0x3f16bf4f,0x250dbf80,0xbf16bf4f,0xbf73be9e,0x250dbf80,0xbf35bf35,0xbf80a554,0xbf353f35
  .long 0xbf16bf4f,0xbf80a554,0xbf163f4f,0x3e9e3f73,0xbf73be9e,0xbf353f35,0x3e9e3f73,0x3f7d3e20
  .long 0x3f16bf4f,0x3f733e9e,0x3f80,0xbf733e9e,0xbf16bf4f,0x3ee8bf64,0x3f80248d,0x3ee83f64
  .long 0xbf733e9e,0xbf4fbf16,0x250dbf80,0x3f4fbf16,0x3f80,0xbf353f35,0xbf80a554,0xbf35bf35
  .long 0x3f733e9e,0x3f163f4f,0x3f80,0xbf163f4f,0x3f16bf4f,0x3f64bee8,0x3f80248d,0x3f643ee8
  .long 0xbf16bf4f,0xbe9ebf73,0x250dbf80,0x3e9ebf73,0xbf733e9e,0xbf7d3e20,0xbf80a554,0xbf7dbe20
  .long 0x3f80,0x3f80,0x3f80,0x3f80,0x3f733e9e,0x3f7d3e20,0x3f80248d,0x3f7dbe20
  .long 0x3f16bf4f,0x3e9ebf73,0x250dbf80,0xbe9ebf73,0xbf16bf4f,0xbf64bee8,0xbf80a554,0xbf643ee8
  .long 0xbf733e9e,0xbf163f4f,0x3f80,0x3f163f4f,0x3f80,0x3f353f35,0x3f80248d,0x3f35bf35
  .long 0x3f733e9e,0x3f4fbf16,0x250dbf80,0xbf4fbf16,0x3f16bf4f,0xbee8bf64,0xbf80a554,0xbee83f64
  .long 0xbf16bf4f,0x3f16bf4f,0x3f733e9e,0x3f80,0xbf163f4f,0xbf7dbe20,0xbe9ebf73,0x3f35bf35
  .long 0x3f733e9e,0x3e9e3f73,0xbf163f4f,0xbf80a554,0x250dbf80,0x3f35bf35,0x3f80248d,0x3f353f35
  .long 0xbf733e9e,0xbf73be9e,0xbf16bf4f,0x250dbf80,0x3f163f4f,0x3e203f7d,0xbe9e3f73,0xbf353f35
  .long 0x3f16bf4f,0x3f4fbf16,0x3f73be9e,0x3f80248d,0xbf73be9e,0xbf64bee8,0xbf4fbf16,0xbf35bf35
  .long 0x3f80,0x3f80,0x3f80,0x3f80,0x3f73be9e,0x3f64bee8,0x3f4fbf16,0x3f35bf35
  .long 0xbf16bf4f,0xbf4fbf16,0xbf73be9e,0xbf80a554,0xbf163f4f,0xbe203f7d,0x3e9e3f73,0x3f353f35
  .long 0x3f733e9e,0x3f73be9e,0x3f16bf4f,0x250dbf80,0x250dbf80,0xbf35bf35,0xbf80a554,0xbf353f35
  .long 0xbf733e9e,0xbe9e3f73,0x3f163f4f,0x3f80248d,0x3f163f4f,0x3f7dbe20,0x3e9ebf73,0xbf35bf35
  .long 0xbf733e9e,0xbf16bf4f,0x3f16bf4f,0x3f733e9e,0x3f733e9e,0x3e203f7d,0xbf4f3f16,0xbf64bee8
  .long 0xbf16bf4f,0x3e9ebf73,0x3f73be9e,0x3f4f3f16,0x3f80,0xbf353f35,0xbf80a554,0xbf35bf35
  .long 0x3f16bf4f,0x3f73be9e,0x3f733e9e,0x3f163f4f,0xbf733e9e,0xbf7dbe20,0xbf4fbf16,0xbee8bf64
  .long 0x3f733e9e,0x3f4f3f16,0x3f163f4f,0x3e9e3f73,0xbf16bf4f,0xbee8bf64,0xbe9ebf73,0xbe20bf7d
  .long 0x3f80,0x3f80,0x3f80,0x3f80,0x3f16bf4f,0x3ee8bf64,0x3e9ebf73,0x3e20bf7d
  .long 0xbf733e9e,0xbf4f3f16,0xbf163f4f,0xbe9e3f73,0x3f733e9e,0x3f7dbe20,0x3f4fbf16,0x3ee8bf64
  .long 0xbf16bf4f,0xbf73be9e,0xbf733e9e,0xbf163f4f,0x3f80,0x3f353f35,0x3f80248d,0x3f35bf35
  .long 0x3f16bf4f,0xbe9ebf73,0xbf73be9e,0xbf4f3f16,0xbf733e9e,0xbe203f7d,0x3f4f3f16,0x3f64bee8
  .long 0x3f80,0xbf733e9e,0xbf16bf4f,0x3f16bf4f,0x250dbf80,0x3f64bee8,0x3f4f3f16,0xbe203f7d
  .long 0x3f80,0xbf4f3f16,0xbf73be9e,0xbe9ebf73,0x250dbf80,0x3f35bf35,0x3f80248d,0x3f353f35
  .long 0x3f80,0xbf163f4f,0xbf733e9e,0xbf73be9e,0x250dbf80,0x3ee8bf64,0x3f4fbf16,0x3f7dbe20
  .long 0x3f80,0xbe9e3f73,0xbf163f4f,0xbf4f3f16,0x250dbf80,0x3e20bf7d,0x3e9ebf73,0x3ee8bf64
  .long 0x3f80,0x3f80,0x3f80,0x3f80,0x250dbf80,0xbe20bf7d,0xbe9ebf73,0xbee8bf64
  .long 0x3f80,0x3e9e3f73,0x3f163f4f,0x3f4f3f16,0x250dbf80,0xbee8bf64,0xbf4fbf16,0xbf7dbe20
  .long 0x3f80,0x3f163f4f,0x3f733e9e,0x3f73be9e,0x250dbf80,0xbf35bf35,0xbf80a554,0xbf353f35
  .long 0x3f80,0x3f4f3f16,0x3f73be9e,0x3e9ebf73,0x250dbf80,0xbf64bee8,0xbf4f3f16,0x3e203f7d
  .long 0x3f733e9e,0x3f80,0xbf733e9e,0xbf16bf4f,0xbf733e9e,0xbf35bf35,0x3e9ebf73,0x3f7dbe20
  .long 0x3f16bf4f,0x3f80248d,0x3f163f4f,0xbe9e3f73,0x3f80,0xbf353f35,0xbf80a554,0xbf35bf35
  .long 0xbf16bf4f,0x250dbf80,0x3f16bf4f,0x3f73be9e,0x3f733e9e,0x3f353f35,0x3e9e3f73,0xbe203f7d
  .long 0xbf733e9e,0xbf80a554,0xbf73be9e,0xbf4fbf16,0x3f16bf4f,0x3f35bf35,0x3f4fbf16,0x3f64bee8
  .long 0x3f80,0x3f80,0x3f80,0x3f80,0xbf16bf4f,0xbf35bf35,0xbf4fbf16,0xbf64bee8
  .long 0x3f733e9e,0x3f80248d,0x3f73be9e,0x3f4fbf16,0xbf733e9e,0xbf353f35,0xbe9e3f73,0x3e203f7d
  .long 0x3f16bf4f,0x250dbf80,0xbf16bf4f,0xbf73be9e,0x3f80,0x3f353f35,0x3f80248d,0x3f35bf35
  .long 0xbf16bf4f,0xbf80a554,0xbf163f4f,0x3e9e3f73,0x3f733e9e,0x3f35bf35,0xbe9ebf73,0xbf7dbe20
  .long 0x3f16bf4f,0x3f733e9e,0x3f80,0xbf733e9e,0x3f163f4f,0xbee83f64,0xbf80a554,0xbee8bf64
  .long 0xbf733e9e,0xbf4fbf16,0x250dbf80,0x3f4fbf16,0x250dbf80,0x3f35bf35,0x3f80248d,0x3f353f35
  .long 0x3f733e9e,0x3f163f4f,0x3f80,0xbf163f4f,0xbf163f4f,0xbf643ee8,0xbf80a554,0xbf64bee8
  .long 0xbf16bf4f,0xbe9ebf73,0x250dbf80,0x3e9ebf73,0x3f73be9e,0x3f7dbe20,0x3f80248d,0x3f7d3e20
  .long 0x3f80,0x3f80,0x3f80,0x3f80,0xbf73be9e,0xbf7dbe20,0xbf80a554,0xbf7d3e20
  .long 0x3f16bf4f,0x3e9ebf73,0x250dbf80,0xbe9ebf73,0x3f163f4f,0x3f643ee8,0x3f80248d,0x3f64bee8
  .long 0xbf733e9e,0xbf163f4f,0x3f80,0x3f163f4f,0x250dbf80,0xbf35bf35,0xbf80a554,0xbf353f35
  .long 0x3f733e9e,0x3f4fbf16,0x250dbf80,0xbf4fbf16,0xbf163f4f,0x3ee83f64,0x3f80248d,0x3ee8bf64
  .long 0xbf16bf4f,0x3f16bf4f,0x3f733e9e,0x3f80,0x3f16bf4f,0x3f7d3e20,0x3e9e3f73,0xbf353f35
  .long 0x3f733e9e,0x3e9e3f73,0xbf163f4f,0xbf80a554,0x3f80,0xbf353f35,0xbf80a554,0xbf35bf35
  .long 0xbf733e9e,0xbf73be9e,0xbf16bf4f,0x250dbf80,0xbf16bf4f,0xbe20bf7d,0x3e9ebf73,0x3f35bf35
  .long 0x3f16bf4f,0x3f4fbf16,0x3f73be9e,0x3f80248d,0x3f733e9e,0x3f643ee8,0x3f4f3f16,0x3f353f35
  .long 0x3f80,0x3f80,0x3f80,0x3f80,0xbf733e9e,0xbf643ee8,0xbf4f3f16,0xbf353f35
  .long 0xbf16bf4f,0xbf4fbf16,0xbf73be9e,0xbf80a554,0x3f16bf4f,0x3e20bf7d,0xbe9ebf73,0xbf35bf35
  .long 0x3f733e9e,0x3f73be9e,0x3f16bf4f,0x250dbf80,0x3f80,0x3f353f35,0x3f80248d,0x3f35bf35
  .long 0xbf733e9e,0xbe9e3f73,0x3f163f4f,0x3f80248d,0xbf16bf4f,0xbf7d3e20,0xbe9e3f73,0x3f353f35
  .long 0xbf733e9e,0xbf16bf4f,0x3f16bf4f,0x3f733e9e,0xbf73be9e,0xbe20bf7d,0x3f4fbf16,0x3f643ee8
  .long 0xbf16bf4f,0x3e9ebf73,0x3f73be9e,0x3f4f3f16,0x250dbf80,0x3f35bf35,0x3f80248d,0x3f353f35
  .long 0x3f16bf4f,0x3f73be9e,0x3f733e9e,0x3f163f4f,0x3f73be9e,0x3f7d3e20,0x3f4f3f16,0x3ee83f64
  .long 0x3f733e9e,0x3f4f3f16,0x3f163f4f,0x3e9e3f73,0x3f163f4f,0x3ee83f64,0x3e9e3f73,0x3e203f7d
  .long 0x3f80,0x3f80,0x3f80,0x3f80,0xbf163f4f,0xbee83f64,0xbe9e3f73,0xbe203f7d
  .long 0xbf733e9e,0xbf4f3f16,0xbf163f4f,0xbe9e3f73,0xbf73be9e,0xbf7d3e20,0xbf4f3f16,0xbee83f64
  .long 0xbf16bf4f,0xbf73be9e,0xbf733e9e,0xbf163f4f,0x250dbf80,0xbf35bf35,0xbf80a554,0xbf353f35
  .long 0x3f16bf4f,0xbe9ebf73,0xbf73be9e,0xbf4f3f16,0x3f73be9e,0x3e20bf7d,0xbf4fbf16,0xbf643ee8
  .long 0x0,0x0,0x0,0x0,0x0,0x0,0x0,0x0
  .long 0x0,0x0,0x0,0x0,0x0,0x0,0x0,0x0
  .long 0x0,0x0,0x0,0x0,0x0,0x0,0x0,0x0
  .long 0x0,0x0,0x0,0x0,0x0,0x0,0x0,0x0
  .long 0x0,0x0,0x0,0x0,0x0,0x0,0x0,0x0
  .long 0x0,0x0,0x0,0x0,0x0,0x0,0x0,0x0
  .long 0x0,0x0,0x0,0x0,0x0,0x0,0x0,0x0
  .long 0x0,0x0,0x0,0x0,0x0,0x0,0x0,0x0
  .long 0x0,0x0,0x0,0x0,0x0,0x0,0x0,0x0
  .long 0x0,0x0,0x0,0x0,0x0,0x0,0x0,0x0
  .long 0x0,0x0,0x0,0x0,0x0,0x0,0x0,0x0
  .long 0x0,0x0,0x0,0x0,0x0,0x0,0x0,0x0
  .long 0x0,0x0,0x0,0x0,0x0,0x0,0x0,0x0
  .long 0x0,0x0,0x0,0x0,0x0,0x0,0x0,0x0
  .long 0x0,0x0,0x0,0x0,0x0,0x0,0x0,0x0
  .long 0x0,0x0,0x0,0x0,0x0,0x0,0x0,0x0
.size p2_tab, 16384
code_end:
.section .rodata,"a"
.p2align 6
.amdhsa_kernel adaLN_cond__spectral_fnet__mixer_gmlp__prompt_kernel
  .amdhsa_next_free_vgpr 168
  .amdhsa_next_free_sgpr 64
  .amdhsa_accum_offset 168
  .amdhsa_group_segment_fixed_size 0
  .amdhsa_kernarg_size 120
  .amdhsa_user_sgpr_count 2
  .amdhsa_user_sgpr_kernarg_segment_ptr 1
  .amdhsa_system_sgpr_workgroup_id_x 1
.end_amdhsa_kernel
```
